```python
import torch

def _softmax(x, axis=-1):
    return torch.softmax(x, dim=axis)
def _gelu(x):
    return torch.nn.functional.gelu(x, approximate="tanh")
def _silu(x):
    return torch.nn.functional.silu(x)
def _sigmoid(x):
    return torch.sigmoid(x)
def _layernorm(x, axis=-1, eps=1e-5):
    m = x.mean(dim=axis, keepdim=True)
    v = x.var(dim=axis, keepdim=True, unbiased=False)
    return (x - m) / torch.sqrt(v + eps)
def _scatter_add(tgt, idx, src, axis=0):
    return tgt.clone().index_add_(axis, idx, src)
def _segment_sum(src, seg, n):
    out = torch.zeros((n,) + src.shape[1:], dtype=src.dtype)
    return out.index_add_(0, seg, src)
def _pad(x, pw):
    flat = tuple(v for pair in reversed(pw) for v in pair)
    return torch.nn.functional.pad(x, flat)

kernel_name = 'gated_mix__ssm_conv_h3__glu_gated_bilinear__prompt'

def setup_inputs():

    _w = (lambda a: (lambda t: t.to(torch.bfloat16) if t.is_floating_point() else t)(torch.as_tensor(a)))
    def _A_setup():
        B, S, D = 1, 2048, 640
        ks = 4
        return {
            "q": _w((lambda *s: torch.randn(*s, dtype=torch.bfloat16) * 0.05)(B, S, D)),
            "k": _w((lambda *s: torch.randn(*s, dtype=torch.bfloat16) * 0.05)(B, S, D)),
            "v": _w((lambda *s: torch.randn(*s, dtype=torch.bfloat16) * 0.05)(B, S, D)),
            "shift_k": _w((lambda *s: torch.randn(*s, dtype=torch.bfloat16) * 0.05)(D, ks) * 0.5),
            "ssm_k": _w((lambda *s: torch.randn(*s, dtype=torch.bfloat16) * 0.1)(D, S) * (1.0 / S ** 0.5)),
            "ssm_D": _w((lambda *s: torch.randn(*s, dtype=torch.bfloat16) * 0.05)(D)),
        }
    _A_in = _A_setup()

    def _B_setup():
        B, S, D, F = 1, 2048, 640, 1536
        return {
            "x": _w((lambda *s: torch.randn(*s, dtype=torch.bfloat16) * 0.05)(B, S, D)),
            "w_gate": _w((lambda *s: torch.randn(*s, dtype=torch.bfloat16) * 0.1)(D, F) * (D ** -0.5)),
            "w_up": _w((lambda *s: torch.randn(*s, dtype=torch.bfloat16) * 0.1)(D, F) * (D ** -0.5)),
            "w_down": _w((lambda *s: torch.randn(*s, dtype=torch.bfloat16) * 0.1)(F, D) * (F ** -0.5)),
        }
    _B_in = _B_setup()

    return {
        "A_q": _A_in["q"],
        "A_k": _A_in["k"],
        "A_v": _A_in["v"],
        "A_shift_k": _A_in["shift_k"],
        "A_ssm_k": _A_in["ssm_k"],
        "A_ssm_D": _A_in["ssm_D"],
        "B_x": _B_in["x"],
        "B_w_gate": _B_in["w_gate"],
        "B_w_up": _B_in["w_up"],
        "B_w_down": _B_in["w_down"],
        "gate_w": _w((lambda *s: torch.randn(*s, dtype=torch.bfloat16) * 0.05)(640) * 16.0),
    }

def reference(A_q, A_k, A_v, A_shift_k, A_ssm_k, A_ssm_D, B_x, B_w_gate, B_w_up, B_w_down, gate_w):
    def _A_ref(q, k, v, shift_k, ssm_k, ssm_D):
        B, S, D = q.shape
        ks = shift_k.shape[-1]
        k_pad = _pad(k, ((0, 0), (ks - 1, 0), (0, 0)))
        k_shift = torch.zeros_like(k)
        for t in range(ks):
            k_shift = k_shift + k_pad[:, t:t + S, :] * shift_k[:, ks - 1 - t][None, None, :]
        kv = k_shift * v
        L = 2 * S
        kv_pad = _pad(kv, ((0, 0), (0, S), (0, 0)))
        kf_pad = _pad(ssm_k, ((0, 0), (0, S)))
        kv_f = (lambda x, axes=(-2,-1): torch.fft.rfft2(x.float(), dim=axes))(kv_pad[:, None, :, :], axes=(1, 2))
        kf_f = (lambda x, axes=(-2,-1): torch.fft.rfft2(x.float(), dim=axes))(kf_pad[:, None, :], axes=(1, 2))
        kf_f = (lambda x, *d: x.permute(*d))(kf_f, 1, 2, 0)
        y_f = kv_f * kf_f[None, :, :, :]
        y = (lambda x, s, axes=(-2,-1): torch.fft.irfft2(x, s=s, dim=axes).to(torch.bfloat16))(y_f, (1, L), axes=(1, 2))[:, 0, :S, :]
        y = y + kv * ssm_D[None, None, :]
        return q * y

    def _B_ref(x, w_gate, w_up, w_down):
        g = torch.einsum("bsd,df->bsf", x, w_gate)
        u = torch.einsum("bsd,df->bsf", x, w_up)
        h = g * u
        return torch.einsum("bsf,fd->bsd", h, w_down)

    x = A_q
    g = _sigmoid((x * gate_w).sum(-1, keepdims=True))
    a = _A_ref(x, A_k, A_v, A_shift_k, A_ssm_k, A_ssm_D)
    b = _B_ref(x, B_w_gate, B_w_up, B_w_down)
    return g * a + (1 - g) * b
```

```asm
; @launch grid=(256,1,1) block=(512,1,1) lds=160768
.amdgcn_target "amdgcn-amd-amdhsa--gfx950"
.text
.globl gated_mix__ssm_conv_h3__glu_gated_bilinear__prompt_kernel
.p2align 8
.type gated_mix__ssm_conv_h3__glu_gated_bilinear__prompt_kernel,@function
gated_mix__ssm_conv_h3__glu_gated_bilinear__prompt_kernel:
    s_cmp_ge_u32 s2, 256
    s_cbranch_scc1 Ldone
    s_load_dwordx2 s[44:45], s[0:1], 0
    s_load_dwordx2 s[48:49], s[0:1], 56
    s_load_dwordx2 s[52:53], s[0:1], 64
    s_load_dwordx8 s[16:23], s[0:1], 0
    s_load_dwordx4 s[24:27], s[0:1], 32
    s_load_dwordx8 s[32:39], s[0:1], 64
    s_load_dwordx4 s[40:43], s[0:1], 96
    v_lshrrev_b32 v2, 6, v0
    v_and_b32 v1, 63, v0
    v_readfirstlane_b32 s3, v2
    s_and_b32 s4, s2, 7
    s_lshr_b32 s5, s2, 3
    s_lshr_b32 s6, s4, 1
    s_mul_i32 s9, s5, 13108
    s_lshr_b32 s9, s9, 16
    s_mul_i32 s7, s9, 5
    s_sub_u32 s7, s5, s7
    s_and_b32 s8, s4, 1
    s_mul_i32 s10, s8, 5
    s_add_u32 s7, s7, s10
    s_lshl_b32 s10, s8, 1
    s_mul_i32 s8, s6, 6
    s_add_u32 s8, s8, s9
    s_lshl_b32 s11, s6, 2
    s_add_u32 s10, s10, s11
    s_add_u32 s10, s10, s5
    s_sub_u32 s10, s10, 30
    s_cmp_ge_u32 s5, 30
    s_cselect_b32 s8, s10, s8
    s_cselect_b32 s7, 15, s7
    s_cmp_lt_u32 s3, 4
    s_cbranch_scc1 Lcwave
    s_setprio 2
    s_and_b32 s10, s3, 3
    s_cmp_ge_u32 s5, 30
    s_cbranch_scc1 LLodd
    v_lshrrev_b32 v9, 3, v1
    v_and_b32 v10, 7, v1
    v_lshrrev_b32 v11, 1, v9
    v_xor_b32 v4, v10, v11
    v_lshlrev_b32 v4, 4, v4
    s_mov_b32 s12, 81920
    v_mul_lo_u32 v3, v9, s12
    v_add_u32 v2, v3, v4
    v_xor_b32 v4, 64, v4
    v_add_u32 v3, v3, v4
    v_and_b32 v11, 1, v11
    v_lshlrev_b32 v11, 1, v11
    v_xor_b32 v10, v10, v11
    v_mul_u32_u24 v9, 3072, v9
    v_lshl_add_u32 v4, v10, 4, v9
    v_add_u32 v5, 23552, v4
    v_xor_b32 v6, 64, v4
    v_xor_b32 v7, 64, v5
    s_mul_i32 s12, s10, 6
    s_mul_i32 s13, s7, 3
    v_add_u32 v9, s12, v1
    v_lshrrev_b32 v10, 3, v9
    v_add_u32 v10, s13, v10
    v_and_b32 v9, 7, v9
    v_and_b32 v11, 7, v10
    v_lshl_add_u32 v9, v11, 3, v9
    v_lshrrev_b32 v10, 3, v10
    v_lshl_add_u32 v9, v10, 9, v9
    v_mul_u32_u24 v9, 1280, v9
    v_subrev_u32 v10, 3, v1
    v_min_u32 v10, v10, v1
    v_lshlrev_b32 v10, 10, v10
    v_sub_u32 v8, v9, v10
    s_mul_i32 s13, s10, 49152
    s_lshl_b32 s14, s8, 7
    s_add_u32 s13, s13, s14
    s_mul_i32 s14, s10, 6144
    s_lshl_b32 s15, s10, 11
    s_and_b32 s9, s4, 1
    s_mul_i32 s9, s9, 10
    s_mul_i32 s96, s6, 5
    s_add_u32 s9, s9, s96
    s_lshr_b32 s9, s9, 1
    s_cmp_ge_u32 s9, 10
    s_cselect_b32 s96, 10, 0
    s_sub_u32 s9, s9, s96
    s_lshl_b32 s96, s9, 7
    v_add_u32 v2, s96, v2
    v_add_u32 v3, s96, v3
    s_mul_i32 s96, s9, 196608
    s_add_u32 s13, s13, s96
    s_mov_b32 s46, 0x280000
    s_mov_b32 s47, 0x00020000
    s_mov_b32 s50, 0x1e0000
    s_mov_b32 s51, 0x00020000
    s_mov_b32 s54, 0x1e0000
    s_mov_b32 s55, 0x00020000
    v_readlane_b32 s28, v8, 0
    v_readlane_b32 s29, v8, 1
    v_readlane_b32 s30, v8, 2
    v_readlane_b32 s31, v8, 3
    v_readlane_b32 s7, v8, 4
    v_readlane_b32 s8, v8, 5
    s_waitcnt lgkmcnt(0)
    s_add_u32 m0, s14, 0
    s_nop 0
    buffer_load_dwordx4 v2, s[44:47], s28 offen offset:0 lds
    buffer_load_dwordx4 v3, s[44:47], s29 offen offset:1024 lds
    buffer_load_dwordx4 v2, s[44:47], s30 offen offset:2048 lds
    s_add_u32 m0, s14, 3072
    s_nop 0
    buffer_load_dwordx4 v3, s[44:47], s31 offen offset:0 lds
    buffer_load_dwordx4 v2, s[44:47], s7 offen offset:1024 lds
    buffer_load_dwordx4 v3, s[44:47], s8 offen offset:2048 lds
    s_add_u32 m0, s15, 24576
    s_nop 0
    buffer_load_dwordx4 v4, s[48:51], s13 offen offset:0 lds
    buffer_load_dwordx4 v5, s[48:51], s13 offen offset:1024 lds
    s_add_u32 m0, s15, 32768
    s_nop 0
    buffer_load_dwordx4 v6, s[52:55], s13 offen offset:0 lds
    buffer_load_dwordx4 v7, s[52:55], s13 offen offset:1024 lds
    v_add_u32 v2, 0x80, v2
    v_add_u32 v3, 0x80, v3
    s_add_u32 s13, s13, 196608
    s_add_u32 s9, s9, 1
    s_cmp_eq_u32 s9, 10
    s_cselect_b32 s96, 1280, 0
    s_cselect_b32 s97, 1966080, 0
    s_sub_u32 s13, s13, s97
    v_subrev_u32 v2, s96, v2
    v_subrev_u32 v3, s96, v3
    s_add_u32 s72, s42, 0xce4000
    s_addc_u32 s73, s43, 0
    s_mov_b32 s74, 0x4e00
    s_mov_b32 s75, 0x00020000
    v_cmp_eq_u32 vcc, 0, v1
    v_mov_b32 v248, 0x80000000
    s_nop 0
    v_cndmask_b32 v248, v248, 0, vcc
    s_lshl_b32 s76, s2, 2
    s_add_u32 s76, s76, s10
    s_cmp_lg_u32 s76, 0
    s_cbranch_scc1 Lno_nonce
    s_memrealtime s[76:77]
    s_mov_b32 s68, s40
    s_mov_b32 s69, s41
    s_mov_b32 s70, 0x100
    s_mov_b32 s71, 0x00020000
    s_waitcnt lgkmcnt(0)
    s_or_b32 s76, s76, 1
    v_mov_b32 v20, s76
    buffer_store_dword v20, v248, s[68:71], 0 offen sc1
    s_waitcnt vmcnt(0)
Lno_nonce:
    s_add_u32 m0, s14, 41088
    s_nop 0
    buffer_load_dwordx4 v2, s[44:47], s28 offen offset:0 lds
    buffer_load_dwordx4 v3, s[44:47], s29 offen offset:1024 lds
    buffer_load_dwordx4 v2, s[44:47], s30 offen offset:2048 lds
    s_add_u32 m0, s14, 44160
    s_nop 0
    buffer_load_dwordx4 v3, s[44:47], s31 offen offset:0 lds
    buffer_load_dwordx4 v2, s[44:47], s7 offen offset:1024 lds
    buffer_load_dwordx4 v3, s[44:47], s8 offen offset:2048 lds
    s_add_u32 m0, s15, 65664
    s_nop 0
    buffer_load_dwordx4 v4, s[48:51], s13 offen offset:0 lds
    buffer_load_dwordx4 v5, s[48:51], s13 offen offset:1024 lds
    s_add_u32 m0, s15, 73856
    s_nop 0
    buffer_load_dwordx4 v6, s[52:55], s13 offen offset:0 lds
    buffer_load_dwordx4 v7, s[52:55], s13 offen offset:1024 lds
    v_add_u32 v2, 0x80, v2
    v_add_u32 v3, 0x80, v3
    s_add_u32 s13, s13, 196608
    s_add_u32 s9, s9, 1
    s_cmp_eq_u32 s9, 10
    s_cselect_b32 s96, 1280, 0
    s_cselect_b32 s97, 1966080, 0
    s_sub_u32 s13, s13, s97
    v_subrev_u32 v2, s96, v2
    v_subrev_u32 v3, s96, v3
    s_lshl_b32 s84, s4, 2
    s_and_b32 s85, s5, 3
    s_add_u32 s84, s84, s85
    s_lshr_b32 s85, s5, 2
    s_mul_i32 s82, s10, 5120
    s_add_u32 s82, s82, 123264
    s_mul_i32 s83, s10, 4224
    s_add_u32 s83, s83, 143744
    s_mul_i32 s88, s85, 48
    s_mul_i32 s96, s10, 12
    s_add_u32 s88, s88, s96
    s_mul_i32 s0, s88, 5120
    s_mov_b32 s95, 0
    s_lshl_b32 s88, s88, 2
    s_add_u32 s88, s88, 14848
    s_mul_i32 s1, s10, 10240
    v_lshlrev_b32 v241, 4, v1
    v_add_u32 v245, 4096, v241
    s_cmp_ge_u32 s5, 20
    s_cbranch_scc1 LtypeB
    s_mov_b32 s56, s18
    s_mov_b32 s57, s19
    s_mov_b32 s58, 0x280000
    s_mov_b32 s59, 0x00020000
    s_mov_b32 s60, s20
    s_mov_b32 s61, s21
    s_mov_b32 s62, 0x280000
    s_mov_b32 s63, 0x00020000
    s_mov_b32 s64, s22
    s_mov_b32 s65, s23
    s_mov_b32 s66, 0x1400
    s_mov_b32 s67, 0x00020000
    s_cmp_ge_u32 s5, 10
    s_cselect_b32 s76, 1, 0
    s_cselect_b32 s77, 10, 0
    s_sub_u32 s77, s5, s77
    s_lshl_b32 s78, s4, 1
    s_add_u32 s76, s76, s78
    s_lshl_b32 s87, s77, 2
    s_add_u32 s87, s87, s10
    s_lshl_b32 s89, s87, 4
    s_add_u32 s89, s89, s76
    s_lshl_b32 s89, s89, 2
    s_lshl_b32 s87, s87, 16
    s_lshl_b32 s78, s76, 8
    s_add_u32 s87, s87, s78
    s_lshl_b32 s76, s76, 7
    s_lshl_b32 s78, s10, 5
    s_add_u32 s76, s76, s78
    v_lshrrev_b32 v9, 3, v1
    v_and_b32 v10, 7, v1
    s_lshl_b32 s78, s10, 3
    v_add_u32 v22, s78, v9
    v_lshlrev_b32 v11, 1, v10
    v_xor_b32 v22, v22, v11
    v_lshlrev_b32 v22, 3, v22
    v_lshl_add_u32 v22, v10, 11, v22
    v_add_u32 v22, 123264, v22
    v_lshlrev_b32 v9, 2, v9
    v_add_u32 v9, s76, v9
    v_mul_u32_u24 v232, 1280, v9
    v_lshl_add_u32 v232, v10, 4, v232
    s_lshl_b32 s78, s77, 7
    v_add_u32 v232, s78, v232
    v_subrev_u32 v233, 3840, v232
    v_subrev_u32 v234, 2560, v232
    v_subrev_u32 v235, 1280, v232
    s_lshl_b32 s78, s77, 9
    v_lshlrev_b32 v236, 6, v10
    v_add_u32 v236, s78, v236
    s_mul_i32 s11, s4, 20
    s_add_u32 s11, s11, s5
    s_lshl_b32 s11, s11, 2
    s_add_u32 s11, s11, s10
    s_lshl_b32 s81, s11, 12
    s_lshl_b32 s80, s11, 2
    s_add_u32 s80, s80, 17408
    s_lshr_b32 s76, s11, 4
    s_lshl_b32 s76, s76, 6
    s_sub_u32 s77, s88, 64
    v_min_u32 v240, 31, v1
    v_lshlrev_b32 v240, 2, v240
    v_mov_b32 v9, s76
    v_mov_b32 v10, s77
    s_lshl_b32 s78, s5, 2
    s_add_u32 s78, s78, s10
    s_lshl_b32 s78, s78, 2
    s_mul_i32 s78, s78, 9363
    s_lshr_b32 s78, s78, 16
    s_lshl_b32 s79, s4, 6
    s_add_u32 s78, s78, s79
    s_lshl_b32 s78, s78, 2
    s_add_u32 s78, s78, 17296
    v_min_u32 v240, 29, v1
    v_lshlrev_b32 v240, 2, v240
    v_mov_b32 v11, s78
    v_cmp_gt_u32 vcc, 28, v1
    s_nop 1
    v_cndmask_b32 v10, v11, v10, vcc
    v_cmp_gt_u32 vcc, 16, v1
    s_nop 1
    v_cndmask_b32 v9, v10, v9, vcc
    v_add_u32 v240, v240, v9
    s_and_b32 s86, s11, 0xfffffffe
    s_lshl_b32 s86, s86, 1
    s_load_dword s86, s[26:27], s86
    s_mov_b32 s87, s87
    v_bfe_u32 v26, v1, 4, 1
    v_bfe_u32 v27, v1, 2, 2
    v_and_b32 v28, 3, v1
    v_lshrrev_b32 v29, 5, v1
    v_add_u32 v30, v28, v27
    v_lshlrev_b32 v30, 3, v30
    v_lshl_add_u32 v30, v26, 5, v30
    v_lshl_add_u32 v30, v29, 6, v30
    s_add_u32 s96, s83, 8
    v_add_u32 v23, s96, v30
    s_add_u32 s96, s83, 64
    v_lshlrev_b32 v30, 1, v1
    v_add_u32 v242, s96, v30
    v_lshlrev_b32 v30, 7, v26
    v_lshl_add_u32 v30, v28, 5, v30
    v_lshlrev_b32 v31, 5, v29
    v_sub_u32 v30, v30, v31
    v_lshlrev_b32 v31, 2, v27
    v_sub_u32 v30, v30, v31
    v_add_u32 v31, 284, v30
    v_bfe_u32 v36, v31, 7, 1
    v_lshlrev_b32 v36, 4, v36
    v_xor_b32 v31, v31, v36
    v_lshlrev_b32 v31, 1, v31
    v_add_u32 v14, s82, v31
    v_add_u32 v31, 268, v30
    v_bfe_u32 v36, v31, 7, 1
    v_lshlrev_b32 v36, 4, v36
    v_xor_b32 v31, v31, v36
    v_lshlrev_b32 v31, 1, v31
    v_add_u32 v15, s82, v31
    v_add_u32 v31, 220, v30
    v_bfe_u32 v36, v31, 7, 1
    v_lshlrev_b32 v36, 4, v36
    v_xor_b32 v31, v31, v36
    v_lshlrev_b32 v31, 1, v31
    v_add_u32 v16, s82, v31
    v_add_u32 v31, 204, v30
    v_bfe_u32 v36, v31, 7, 1
    v_lshlrev_b32 v36, 4, v36
    v_xor_b32 v31, v31, v36
    v_lshlrev_b32 v31, 1, v31
    v_add_u32 v17, s82, v31
    v_add_u32 v31, 156, v30
    v_bfe_u32 v36, v31, 7, 1
    v_lshlrev_b32 v36, 4, v36
    v_xor_b32 v31, v31, v36
    v_lshlrev_b32 v31, 1, v31
    v_add_u32 v18, s82, v31
    v_add_u32 v31, 140, v30
    v_bfe_u32 v36, v31, 7, 1
    v_lshlrev_b32 v36, 4, v36
    v_xor_b32 v31, v31, v36
    v_lshlrev_b32 v31, 1, v31
    v_add_u32 v19, s82, v31
    v_add_u32 v31, 92, v30
    v_bfe_u32 v36, v31, 7, 1
    v_lshlrev_b32 v36, 4, v36
    v_xor_b32 v31, v31, v36
    v_lshlrev_b32 v31, 1, v31
    v_add_u32 v20, s82, v31
    v_add_u32 v31, 76, v30
    v_bfe_u32 v36, v31, 7, 1
    v_lshlrev_b32 v36, 4, v36
    v_xor_b32 v31, v31, v36
    v_lshlrev_b32 v31, 1, v31
    v_add_u32 v21, s82, v31
    v_mov_b32 v204, 0
    v_mov_b32 v205, 0
    v_mov_b32 v206, 0
    v_mov_b32 v208, 0
    v_mov_b32 v209, 0
    v_mov_b32 v210, 0
    v_mov_b32 v211, 0
    v_mov_b32 v212, 0
    v_mov_b32 v213, 0
    v_mov_b32 v214, 0
    v_mov_b32 v215, 0
    s_mov_b32 s90, 0
    s_mov_b32 s91, 0x80000000
    s_waitcnt vmcnt(10)
    s_barrier
    s_add_u32 m0, s14, 82176
    s_nop 0
    buffer_load_dwordx4 v2, s[44:47], s28 offen offset:0 lds
    buffer_load_dwordx4 v3, s[44:47], s29 offen offset:1024 lds
    buffer_load_dwordx4 v2, s[44:47], s30 offen offset:2048 lds
    s_add_u32 m0, s14, 85248
    s_nop 0
    buffer_load_dwordx4 v3, s[44:47], s31 offen offset:0 lds
    buffer_load_dwordx4 v2, s[44:47], s7 offen offset:1024 lds
    buffer_load_dwordx4 v3, s[44:47], s8 offen offset:2048 lds
    s_add_u32 m0, s15, 106752
    s_nop 0
    buffer_load_dwordx4 v4, s[48:51], s13 offen offset:0 lds
    buffer_load_dwordx4 v5, s[48:51], s13 offen offset:1024 lds
    s_add_u32 m0, s15, 114944
    s_nop 0
    buffer_load_dwordx4 v6, s[52:55], s13 offen offset:0 lds
    buffer_load_dwordx4 v7, s[52:55], s13 offen offset:1024 lds
    v_add_u32 v2, 0x80, v2
    v_add_u32 v3, 0x80, v3
    s_add_u32 s13, s13, 196608
    s_add_u32 s9, s9, 1
    s_cmp_eq_u32 s9, 10
    s_cselect_b32 s96, 1280, 0
    s_cselect_b32 s97, 1966080, 0
    s_sub_u32 s13, s13, s97
    v_subrev_u32 v2, s96, v2
    v_subrev_u32 v3, s96, v3
    buffer_load_dwordx4 v[44:47], v232, s[56:59], 0 offen offset:0
    buffer_load_dwordx4 v[48:51], v232, s[56:59], 0 offen offset:1280
    buffer_load_dwordx4 v[52:55], v232, s[56:59], 0 offen offset:2560
    buffer_load_dwordx4 v[56:59], v232, s[56:59], 0 offen offset:3840
    buffer_load_dwordx4 v[60:63], v232, s[60:63], 0 offen offset:0
    buffer_load_dwordx4 v[64:67], v232, s[60:63], 0 offen offset:1280
    buffer_load_dwordx4 v[68:71], v232, s[60:63], 0 offen offset:2560
    buffer_load_dwordx4 v[72:75], v232, s[60:63], 0 offen offset:3840
    buffer_load_dwordx4 v[32:35], v233, s[56:59], 0 offen
    buffer_load_dwordx4 v[36:39], v234, s[56:59], 0 offen
    buffer_load_dwordx4 v[40:43], v235, s[56:59], 0 offen
    buffer_load_dwordx4 v[76:79], v236, s[64:67], 0 offen offset:0
    buffer_load_dwordx4 v[80:83], v236, s[64:67], 0 offen offset:16
    buffer_load_dwordx4 v[84:87], v236, s[64:67], 0 offen offset:32
    buffer_load_dwordx4 v[88:91], v236, s[64:67], 0 offen offset:48
    s_waitcnt vmcnt(25)
    s_barrier
    s_add_u32 m0, s14, 0
    s_nop 0
    buffer_load_dwordx4 v2, s[44:47], s28 offen offset:0 lds
    buffer_load_dwordx4 v3, s[44:47], s29 offen offset:1024 lds
    buffer_load_dwordx4 v2, s[44:47], s30 offen offset:2048 lds
    s_add_u32 m0, s14, 3072
    s_nop 0
    buffer_load_dwordx4 v3, s[44:47], s31 offen offset:0 lds
    buffer_load_dwordx4 v2, s[44:47], s7 offen offset:1024 lds
    buffer_load_dwordx4 v3, s[44:47], s8 offen offset:2048 lds
    s_add_u32 m0, s15, 24576
    s_nop 0
    buffer_load_dwordx4 v4, s[48:51], s13 offen offset:0 lds
    buffer_load_dwordx4 v5, s[48:51], s13 offen offset:1024 lds
    s_add_u32 m0, s15, 32768
    s_nop 0
    buffer_load_dwordx4 v6, s[52:55], s13 offen offset:0 lds
    buffer_load_dwordx4 v7, s[52:55], s13 offen offset:1024 lds
    v_add_u32 v2, 0x80, v2
    v_add_u32 v3, 0x80, v3
    s_add_u32 s13, s13, 196608
    s_add_u32 s9, s9, 1
    s_cmp_eq_u32 s9, 10
    s_cselect_b32 s96, 1280, 0
    s_cselect_b32 s97, 1966080, 0
    s_sub_u32 s13, s13, s97
    v_subrev_u32 v2, s96, v2
    v_subrev_u32 v3, s96, v3
    s_waitcnt vmcnt(25)
    s_barrier
    s_waitcnt vmcnt(10)
    v_lshlrev_b32 v92, 16, v32
    v_and_b32 v93, 0xffff0000, v32
    v_lshlrev_b32 v94, 16, v36
    v_and_b32 v95, 0xffff0000, v36
    v_lshlrev_b32 v96, 16, v40
    v_and_b32 v97, 0xffff0000, v40
    v_lshlrev_b32 v98, 16, v44
    v_and_b32 v99, 0xffff0000, v44
    v_lshlrev_b32 v100, 16, v48
    v_and_b32 v101, 0xffff0000, v48
    v_lshlrev_b32 v102, 16, v52
    v_and_b32 v103, 0xffff0000, v52
    v_lshlrev_b32 v104, 16, v56
    v_and_b32 v105, 0xffff0000, v56
    v_lshlrev_b32 v106, 16, v60
    v_and_b32 v107, 0xffff0000, v60
    v_lshlrev_b32 v108, 16, v64
    v_and_b32 v109, 0xffff0000, v64
    v_lshlrev_b32 v110, 16, v68
    v_and_b32 v111, 0xffff0000, v68
    v_lshlrev_b32 v112, 16, v72
    v_and_b32 v113, 0xffff0000, v72
    v_lshlrev_b32 v114, 16, v76
    v_and_b32 v116, 0xffff0000, v76
    v_lshlrev_b32 v118, 16, v77
    v_and_b32 v120, 0xffff0000, v77
    v_lshlrev_b32 v115, 16, v78
    v_and_b32 v117, 0xffff0000, v78
    v_lshlrev_b32 v119, 16, v79
    v_and_b32 v121, 0xffff0000, v79
    v_mul_f32 v122, v92, v120
    v_mul_f32 v123, v93, v121
    v_mul_f32 v124, v94, v120
    v_mul_f32 v125, v95, v121
    v_mul_f32 v126, v96, v120
    v_mul_f32 v127, v97, v121
    v_mul_f32 v128, v98, v120
    v_mul_f32 v129, v99, v121
    v_fmac_f32 v122, v94, v118
    v_fmac_f32 v123, v95, v119
    v_fmac_f32 v124, v96, v118
    v_fmac_f32 v125, v97, v119
    v_fmac_f32 v126, v98, v118
    v_fmac_f32 v127, v99, v119
    v_fmac_f32 v128, v100, v118
    v_fmac_f32 v129, v101, v119
    v_fmac_f32 v122, v96, v116
    v_fmac_f32 v123, v97, v117
    v_fmac_f32 v124, v98, v116
    v_fmac_f32 v125, v99, v117
    v_fmac_f32 v126, v100, v116
    v_fmac_f32 v127, v101, v117
    v_fmac_f32 v128, v102, v116
    v_fmac_f32 v129, v103, v117
    v_fmac_f32 v122, v98, v114
    v_fmac_f32 v123, v99, v115
    v_fmac_f32 v124, v100, v114
    v_fmac_f32 v125, v101, v115
    v_fmac_f32 v126, v102, v114
    v_fmac_f32 v127, v103, v115
    v_fmac_f32 v128, v104, v114
    v_fmac_f32 v129, v105, v115
    v_mul_f32 v122, v122, v106
    v_mul_f32 v123, v123, v107
    v_mul_f32 v124, v124, v108
    v_mul_f32 v125, v125, v109
    v_mul_f32 v126, v126, v110
    v_mul_f32 v127, v127, v111
    v_mul_f32 v128, v128, v112
    v_mul_f32 v129, v129, v113
    v_cvt_pk_bf16_f32 v24, v122, v124
    v_cvt_pk_bf16_f32 v25, v126, v128
    v_cvt_pk_bf16_f32 v26, v123, v125
    v_cvt_pk_bf16_f32 v27, v127, v129
    ds_write_b64 v22, v[24:25] offset:0
    ds_write_b64 v22, v[26:27] offset:256
    s_add_u32 m0, s14, 41088
    s_nop 0
    buffer_load_dwordx4 v2, s[44:47], s28 offen offset:0 lds
    buffer_load_dwordx4 v3, s[44:47], s29 offen offset:1024 lds
    buffer_load_dwordx4 v2, s[44:47], s30 offen offset:2048 lds
    s_add_u32 m0, s14, 44160
    s_nop 0
    buffer_load_dwordx4 v3, s[44:47], s31 offen offset:0 lds
    buffer_load_dwordx4 v2, s[44:47], s7 offen offset:1024 lds
    buffer_load_dwordx4 v3, s[44:47], s8 offen offset:2048 lds
    s_add_u32 m0, s15, 65664
    s_nop 0
    buffer_load_dwordx4 v4, s[48:51], s13 offen offset:0 lds
    buffer_load_dwordx4 v5, s[48:51], s13 offen offset:1024 lds
    s_add_u32 m0, s15, 73856
    s_nop 0
    buffer_load_dwordx4 v6, s[52:55], s13 offen offset:0 lds
    buffer_load_dwordx4 v7, s[52:55], s13 offen offset:1024 lds
    v_add_u32 v2, 0x80, v2
    v_add_u32 v3, 0x80, v3
    s_add_u32 s13, s13, 196608
    s_add_u32 s9, s9, 1
    s_cmp_eq_u32 s9, 10
    s_cselect_b32 s96, 1280, 0
    s_cselect_b32 s97, 1966080, 0
    s_sub_u32 s13, s13, s97
    v_subrev_u32 v2, s96, v2
    v_subrev_u32 v3, s96, v3
    v_lshlrev_b32 v92, 16, v33
    v_and_b32 v93, 0xffff0000, v33
    v_lshlrev_b32 v94, 16, v37
    v_and_b32 v95, 0xffff0000, v37
    v_lshlrev_b32 v96, 16, v41
    v_and_b32 v97, 0xffff0000, v41
    v_lshlrev_b32 v98, 16, v45
    v_and_b32 v99, 0xffff0000, v45
    v_lshlrev_b32 v100, 16, v49
    v_and_b32 v101, 0xffff0000, v49
    v_lshlrev_b32 v102, 16, v53
    v_and_b32 v103, 0xffff0000, v53
    v_lshlrev_b32 v104, 16, v57
    v_and_b32 v105, 0xffff0000, v57
    v_lshlrev_b32 v106, 16, v61
    v_and_b32 v107, 0xffff0000, v61
    v_lshlrev_b32 v108, 16, v65
    v_and_b32 v109, 0xffff0000, v65
    v_lshlrev_b32 v110, 16, v69
    v_and_b32 v111, 0xffff0000, v69
    v_lshlrev_b32 v112, 16, v73
    v_and_b32 v113, 0xffff0000, v73
    v_lshlrev_b32 v114, 16, v80
    v_and_b32 v116, 0xffff0000, v80
    v_lshlrev_b32 v118, 16, v81
    v_and_b32 v120, 0xffff0000, v81
    v_lshlrev_b32 v115, 16, v82
    v_and_b32 v117, 0xffff0000, v82
    v_lshlrev_b32 v119, 16, v83
    v_and_b32 v121, 0xffff0000, v83
    v_mul_f32 v122, v92, v120
    v_mul_f32 v123, v93, v121
    v_mul_f32 v124, v94, v120
    v_mul_f32 v125, v95, v121
    v_mul_f32 v126, v96, v120
    v_mul_f32 v127, v97, v121
    v_mul_f32 v128, v98, v120
    v_mul_f32 v129, v99, v121
    v_fmac_f32 v122, v94, v118
    v_fmac_f32 v123, v95, v119
    v_fmac_f32 v124, v96, v118
    v_fmac_f32 v125, v97, v119
    v_fmac_f32 v126, v98, v118
    v_fmac_f32 v127, v99, v119
    v_fmac_f32 v128, v100, v118
    v_fmac_f32 v129, v101, v119
    v_fmac_f32 v122, v96, v116
    v_fmac_f32 v123, v97, v117
    v_fmac_f32 v124, v98, v116
    v_fmac_f32 v125, v99, v117
    v_fmac_f32 v126, v100, v116
    v_fmac_f32 v127, v101, v117
    v_fmac_f32 v128, v102, v116
    v_fmac_f32 v129, v103, v117
    v_fmac_f32 v122, v98, v114
    v_fmac_f32 v123, v99, v115
    v_fmac_f32 v124, v100, v114
    v_fmac_f32 v125, v101, v115
    v_fmac_f32 v126, v102, v114
    v_fmac_f32 v127, v103, v115
    v_fmac_f32 v128, v104, v114
    v_fmac_f32 v129, v105, v115
    v_mul_f32 v122, v122, v106
    v_mul_f32 v123, v123, v107
    v_mul_f32 v124, v124, v108
    v_mul_f32 v125, v125, v109
    v_mul_f32 v126, v126, v110
    v_mul_f32 v127, v127, v111
    v_mul_f32 v128, v128, v112
    v_mul_f32 v129, v129, v113
    v_cvt_pk_bf16_f32 v28, v122, v124
    v_cvt_pk_bf16_f32 v29, v126, v128
    v_cvt_pk_bf16_f32 v30, v123, v125
    v_cvt_pk_bf16_f32 v31, v127, v129
    ds_write_b64 v22, v[28:29] offset:512
    ds_write_b64 v22, v[30:31] offset:768
    s_waitcnt vmcnt(10)
    s_waitcnt lgkmcnt(0)
    s_barrier
    v_lshlrev_b32 v92, 16, v34
    v_and_b32 v93, 0xffff0000, v34
    v_lshlrev_b32 v94, 16, v38
    v_and_b32 v95, 0xffff0000, v38
    v_lshlrev_b32 v96, 16, v42
    v_and_b32 v97, 0xffff0000, v42
    v_lshlrev_b32 v98, 16, v46
    v_and_b32 v99, 0xffff0000, v46
    v_lshlrev_b32 v100, 16, v50
    v_and_b32 v101, 0xffff0000, v50
    v_lshlrev_b32 v102, 16, v54
    v_and_b32 v103, 0xffff0000, v54
    v_lshlrev_b32 v104, 16, v58
    v_and_b32 v105, 0xffff0000, v58
    v_lshlrev_b32 v106, 16, v62
    v_and_b32 v107, 0xffff0000, v62
    v_lshlrev_b32 v108, 16, v66
    v_and_b32 v109, 0xffff0000, v66
    v_lshlrev_b32 v110, 16, v70
    v_and_b32 v111, 0xffff0000, v70
    v_lshlrev_b32 v112, 16, v74
    v_and_b32 v113, 0xffff0000, v74
    v_lshlrev_b32 v114, 16, v84
    v_and_b32 v116, 0xffff0000, v84
    v_lshlrev_b32 v118, 16, v85
    v_and_b32 v120, 0xffff0000, v85
    v_lshlrev_b32 v115, 16, v86
    v_and_b32 v117, 0xffff0000, v86
    v_lshlrev_b32 v119, 16, v87
    v_and_b32 v121, 0xffff0000, v87
    v_mul_f32 v122, v92, v120
    v_mul_f32 v123, v93, v121
    v_mul_f32 v124, v94, v120
    v_mul_f32 v125, v95, v121
    v_mul_f32 v126, v96, v120
    v_mul_f32 v127, v97, v121
    v_mul_f32 v128, v98, v120
    v_mul_f32 v129, v99, v121
    v_fmac_f32 v122, v94, v118
    v_fmac_f32 v123, v95, v119
    v_fmac_f32 v124, v96, v118
    v_fmac_f32 v125, v97, v119
    v_fmac_f32 v126, v98, v118
    v_fmac_f32 v127, v99, v119
    v_fmac_f32 v128, v100, v118
    v_fmac_f32 v129, v101, v119
    v_fmac_f32 v122, v96, v116
    v_fmac_f32 v123, v97, v117
    v_fmac_f32 v124, v98, v116
    v_fmac_f32 v125, v99, v117
    v_fmac_f32 v126, v100, v116
    v_fmac_f32 v127, v101, v117
    v_fmac_f32 v128, v102, v116
    v_fmac_f32 v129, v103, v117
    v_fmac_f32 v122, v98, v114
    v_fmac_f32 v123, v99, v115
    v_fmac_f32 v124, v100, v114
    v_fmac_f32 v125, v101, v115
    v_fmac_f32 v126, v102, v114
    v_fmac_f32 v127, v103, v115
    v_fmac_f32 v128, v104, v114
    v_fmac_f32 v129, v105, v115
    v_mul_f32 v122, v122, v106
    v_mul_f32 v123, v123, v107
    v_mul_f32 v124, v124, v108
    v_mul_f32 v125, v125, v109
    v_mul_f32 v126, v126, v110
    v_mul_f32 v127, v127, v111
    v_mul_f32 v128, v128, v112
    v_mul_f32 v129, v129, v113
    v_cvt_pk_bf16_f32 v24, v122, v124
    v_cvt_pk_bf16_f32 v25, v126, v128
    v_cvt_pk_bf16_f32 v26, v123, v125
    v_cvt_pk_bf16_f32 v27, v127, v129
    ds_write_b64 v22, v[24:25] offset:1024
    ds_write_b64 v22, v[26:27] offset:1280
    s_add_u32 m0, s14, 82176
    s_nop 0
    buffer_load_dwordx4 v2, s[44:47], s28 offen offset:0 lds
    buffer_load_dwordx4 v3, s[44:47], s29 offen offset:1024 lds
    buffer_load_dwordx4 v2, s[44:47], s30 offen offset:2048 lds
    s_add_u32 m0, s14, 85248
    s_nop 0
    buffer_load_dwordx4 v3, s[44:47], s31 offen offset:0 lds
    buffer_load_dwordx4 v2, s[44:47], s7 offen offset:1024 lds
    buffer_load_dwordx4 v3, s[44:47], s8 offen offset:2048 lds
    s_add_u32 m0, s15, 106752
    s_nop 0
    buffer_load_dwordx4 v4, s[48:51], s13 offen offset:0 lds
    buffer_load_dwordx4 v5, s[48:51], s13 offen offset:1024 lds
    s_add_u32 m0, s15, 114944
    s_nop 0
    buffer_load_dwordx4 v6, s[52:55], s13 offen offset:0 lds
    buffer_load_dwordx4 v7, s[52:55], s13 offen offset:1024 lds
    v_add_u32 v2, 0x80, v2
    v_add_u32 v3, 0x80, v3
    s_add_u32 s13, s13, 196608
    s_add_u32 s9, s9, 1
    s_cmp_eq_u32 s9, 10
    s_cselect_b32 s96, 1280, 0
    s_cselect_b32 s97, 1966080, 0
    s_sub_u32 s13, s13, s97
    v_subrev_u32 v2, s96, v2
    v_subrev_u32 v3, s96, v3
    v_lshlrev_b32 v92, 16, v35
    v_and_b32 v93, 0xffff0000, v35
    v_lshlrev_b32 v94, 16, v39
    v_and_b32 v95, 0xffff0000, v39
    v_lshlrev_b32 v96, 16, v43
    v_and_b32 v97, 0xffff0000, v43
    v_lshlrev_b32 v98, 16, v47
    v_and_b32 v99, 0xffff0000, v47
    v_lshlrev_b32 v100, 16, v51
    v_and_b32 v101, 0xffff0000, v51
    v_lshlrev_b32 v102, 16, v55
    v_and_b32 v103, 0xffff0000, v55
    v_lshlrev_b32 v104, 16, v59
    v_and_b32 v105, 0xffff0000, v59
    v_lshlrev_b32 v106, 16, v63
    v_and_b32 v107, 0xffff0000, v63
    v_lshlrev_b32 v108, 16, v67
    v_and_b32 v109, 0xffff0000, v67
    v_lshlrev_b32 v110, 16, v71
    v_and_b32 v111, 0xffff0000, v71
    v_lshlrev_b32 v112, 16, v75
    v_and_b32 v113, 0xffff0000, v75
    v_lshlrev_b32 v114, 16, v88
    v_and_b32 v116, 0xffff0000, v88
    v_lshlrev_b32 v118, 16, v89
    v_and_b32 v120, 0xffff0000, v89
    v_lshlrev_b32 v115, 16, v90
    v_and_b32 v117, 0xffff0000, v90
    v_lshlrev_b32 v119, 16, v91
    v_and_b32 v121, 0xffff0000, v91
    v_mul_f32 v122, v92, v120
    v_mul_f32 v123, v93, v121
    v_mul_f32 v124, v94, v120
    v_mul_f32 v125, v95, v121
    v_mul_f32 v126, v96, v120
    v_mul_f32 v127, v97, v121
    v_mul_f32 v128, v98, v120
    v_mul_f32 v129, v99, v121
    v_fmac_f32 v122, v94, v118
    v_fmac_f32 v123, v95, v119
    v_fmac_f32 v124, v96, v118
    v_fmac_f32 v125, v97, v119
    v_fmac_f32 v126, v98, v118
    v_fmac_f32 v127, v99, v119
    v_fmac_f32 v128, v100, v118
    v_fmac_f32 v129, v101, v119
    v_fmac_f32 v122, v96, v116
    v_fmac_f32 v123, v97, v117
    v_fmac_f32 v124, v98, v116
    v_fmac_f32 v125, v99, v117
    v_fmac_f32 v126, v100, v116
    v_fmac_f32 v127, v101, v117
    v_fmac_f32 v128, v102, v116
    v_fmac_f32 v129, v103, v117
    v_fmac_f32 v122, v98, v114
    v_fmac_f32 v123, v99, v115
    v_fmac_f32 v124, v100, v114
    v_fmac_f32 v125, v101, v115
    v_fmac_f32 v126, v102, v114
    v_fmac_f32 v127, v103, v115
    v_fmac_f32 v128, v104, v114
    v_fmac_f32 v129, v105, v115
    v_mul_f32 v122, v122, v106
    v_mul_f32 v123, v123, v107
    v_mul_f32 v124, v124, v108
    v_mul_f32 v125, v125, v109
    v_mul_f32 v126, v126, v110
    v_mul_f32 v127, v127, v111
    v_mul_f32 v128, v128, v112
    v_mul_f32 v129, v129, v113
    v_cvt_pk_bf16_f32 v28, v122, v124
    v_cvt_pk_bf16_f32 v29, v126, v128
    v_cvt_pk_bf16_f32 v30, v123, v125
    v_cvt_pk_bf16_f32 v31, v127, v129
    ds_write_b64 v22, v[28:29] offset:1536
    ds_write_b64 v22, v[30:31] offset:1792
    s_load_dword s92, s[40:41], 0
    s_waitcnt vmcnt(10)
    s_waitcnt lgkmcnt(0)
    s_barrier
    s_add_u32 m0, s14, 0
    s_nop 0
    buffer_load_dwordx4 v2, s[44:47], s28 offen offset:0 lds
    buffer_load_dwordx4 v3, s[44:47], s29 offen offset:1024 lds
    buffer_load_dwordx4 v2, s[44:47], s30 offen offset:2048 lds
    s_add_u32 m0, s14, 3072
    s_nop 0
    buffer_load_dwordx4 v3, s[44:47], s31 offen offset:0 lds
    buffer_load_dwordx4 v2, s[44:47], s7 offen offset:1024 lds
    buffer_load_dwordx4 v3, s[44:47], s8 offen offset:2048 lds
    s_add_u32 m0, s15, 24576
    s_nop 0
    buffer_load_dwordx4 v4, s[48:51], s13 offen offset:0 lds
    buffer_load_dwordx4 v5, s[48:51], s13 offen offset:1024 lds
    s_add_u32 m0, s15, 32768
    s_nop 0
    buffer_load_dwordx4 v6, s[52:55], s13 offen offset:0 lds
    buffer_load_dwordx4 v7, s[52:55], s13 offen offset:1024 lds
    v_add_u32 v2, 0x80, v2
    v_add_u32 v3, 0x80, v3
    s_add_u32 s13, s13, 196608
    s_add_u32 s9, s9, 1
    s_cmp_eq_u32 s9, 10
    s_cselect_b32 s96, 1280, 0
    s_cselect_b32 s97, 1966080, 0
    s_sub_u32 s13, s13, s97
    v_subrev_u32 v2, s96, v2
    v_subrev_u32 v3, s96, v3
    s_add_u32 s56, s42, 0x7e0000
    s_addc_u32 s57, s43, 0
    s_mov_b32 s58, 0x280000
    s_mov_b32 s59, 0x00020000
    v_lshrrev_b32 v9, 4, v1
    v_and_b32 v10, 15, v1
    v_lshlrev_b32 v11, 12, v9
    v_lshl_add_u32 v11, v10, 4, v11
    s_lshl_b32 s76, s10, 1
    s_lshl_b32 s77, s10, 12
    s_add_u32 s77, s77, 123264
    s_add_u32 s78, s76, 0
    v_xor_b32 v12, s78, v10
    v_lshlrev_b32 v12, 4, v12
    v_lshl_add_u32 v12, v9, 8, v12
    v_add_u32 v24, s77, v12
    s_add_u32 s78, s76, 1
    v_xor_b32 v12, s78, v10
    v_lshlrev_b32 v12, 4, v12
    v_lshl_add_u32 v12, v9, 8, v12
    v_add_u32 v25, s77, v12
    ds_read_b128 v[40:43], v24 offset:0
    ds_read_b128 v[44:47], v24 offset:1024
    ds_read_b128 v[48:51], v25 offset:2048
    ds_read_b128 v[52:55], v25 offset:3072
    s_waitcnt lgkmcnt(3)
    s_add_u32 s76, s87, 0
    buffer_store_dwordx4 v[40:43], v11, s[56:59], s76 offen sc1
    s_waitcnt lgkmcnt(2)
    s_add_u32 s76, s87, 16384
    buffer_store_dwordx4 v[44:47], v11, s[56:59], s76 offen sc1
    s_waitcnt lgkmcnt(1)
    s_add_u32 s76, s87, 32768
    buffer_store_dwordx4 v[48:51], v11, s[56:59], s76 offen sc1
    s_waitcnt lgkmcnt(0)
    s_add_u32 s76, s87, 49152
    buffer_store_dwordx4 v[52:55], v11, s[56:59], s76 offen sc1
    s_waitcnt vmcnt(14)
    s_barrier
    s_waitcnt lgkmcnt(0)
    s_cmp_lg_u32 s92, 0
    s_cbranch_scc1 Ln_ok_2
    s_mov_b32 s94, 200000
    s_mov_b32 s68, s40
    s_mov_b32 s69, s41
    s_mov_b32 s70, 0x100
    s_mov_b32 s71, 0x00020000
    v_mov_b32 v249, 0
Ln_1:
    buffer_load_dword v250, v249, s[68:71], 0 offen sc1
    s_waitcnt vmcnt(0)
    v_readfirstlane_b32 s92, v250
    s_nop 0
    s_cmp_lg_u32 s92, 0
    s_cbranch_scc1 Ln_ok_2
    s_sleep 8
    s_sub_u32 s94, s94, 1
    s_cmp_lg_u32 s94, 0
    s_cbranch_scc1 Ln_1
Ln_ok_2:
    s_nop 1
    v_mov_b32 v250, s92
    v_mov_b32 v9, 160672
    ds_write_b32 v9, v250
    s_and_b32 s96, s11, 1
    s_lshl_b32 s96, s96, 4
    s_lshr_b32 s86, s86, s96
    s_lshl_b32 s86, s86, 16
    s_add_u32 m0, s14, 41088
    s_nop 0
    buffer_load_dwordx4 v2, s[44:47], s28 offen offset:0 lds
    buffer_load_dwordx4 v3, s[44:47], s29 offen offset:1024 lds
    buffer_load_dwordx4 v2, s[44:47], s30 offen offset:2048 lds
    s_add_u32 m0, s14, 44160
    s_nop 0
    buffer_load_dwordx4 v3, s[44:47], s31 offen offset:0 lds
    buffer_load_dwordx4 v2, s[44:47], s7 offen offset:1024 lds
    buffer_load_dwordx4 v3, s[44:47], s8 offen offset:2048 lds
    s_add_u32 m0, s15, 65664
    s_nop 0
    buffer_load_dwordx4 v4, s[48:51], s13 offen offset:0 lds
    buffer_load_dwordx4 v5, s[48:51], s13 offen offset:1024 lds
    s_add_u32 m0, s15, 73856
    s_nop 0
    buffer_load_dwordx4 v6, s[52:55], s13 offen offset:0 lds
    buffer_load_dwordx4 v7, s[52:55], s13 offen offset:1024 lds
    v_add_u32 v2, 0x80, v2
    v_add_u32 v3, 0x80, v3
    s_add_u32 s13, s13, 196608
    s_add_u32 s9, s9, 1
    s_cmp_eq_u32 s9, 10
    s_cselect_b32 s96, 1280, 0
    s_cselect_b32 s97, 1966080, 0
    s_sub_u32 s13, s13, s97
    v_subrev_u32 v2, s96, v2
    v_subrev_u32 v3, s96, v3
    s_waitcnt vmcnt(10)
    buffer_store_dword v250, v248, s[72:75], s89 offen sc1
    s_waitcnt lgkmcnt(0)
    s_barrier
    v_mov_b32 v32, 0
    v_mov_b32 v33, 0
    v_mov_b32 v34, 0
    v_mov_b32 v35, 0
    v_and_b32 v10, 31, v1
    v_lshlrev_b32 v10, 4, v10
    v_add_u32 v10, s82, v10
    ds_write_b128 v10, v[32:35]
    v_and_b32 v10, 3, v1
    v_lshlrev_b32 v10, 4, v10
    v_add_u32 v10, s83, v10
    ds_write_b128 v10, v[32:35]
    s_add_u32 m0, s14, 82176
    s_nop 0
    buffer_load_dwordx4 v2, s[44:47], s28 offen offset:0 lds
    buffer_load_dwordx4 v3, s[44:47], s29 offen offset:1024 lds
    buffer_load_dwordx4 v2, s[44:47], s30 offen offset:2048 lds
    s_add_u32 m0, s14, 85248
    s_nop 0
    buffer_load_dwordx4 v3, s[44:47], s31 offen offset:0 lds
    buffer_load_dwordx4 v2, s[44:47], s7 offen offset:1024 lds
    buffer_load_dwordx4 v3, s[44:47], s8 offen offset:2048 lds
    s_add_u32 m0, s15, 106752
    s_nop 0
    buffer_load_dwordx4 v4, s[48:51], s13 offen offset:0 lds
    buffer_load_dwordx4 v5, s[48:51], s13 offen offset:1024 lds
    s_add_u32 m0, s15, 114944
    s_nop 0
    buffer_load_dwordx4 v6, s[52:55], s13 offen offset:0 lds
    buffer_load_dwordx4 v7, s[52:55], s13 offen offset:1024 lds
    v_add_u32 v2, 0x80, v2
    v_add_u32 v3, 0x80, v3
    s_add_u32 s13, s13, 196608
    s_add_u32 s9, s9, 1
    s_cmp_eq_u32 s9, 10
    s_cselect_b32 s96, 1280, 0
    s_cselect_b32 s97, 1966080, 0
    s_sub_u32 s13, s13, s97
    v_subrev_u32 v2, s96, v2
    v_subrev_u32 v3, s96, v3
    s_waitcnt vmcnt(11)
    s_waitcnt lgkmcnt(0)
    s_barrier
    s_add_u32 m0, s14, 0
    s_nop 0
    buffer_load_dwordx4 v2, s[44:47], s28 offen offset:0 lds
    buffer_load_dwordx4 v3, s[44:47], s29 offen offset:1024 lds
    buffer_load_dwordx4 v2, s[44:47], s30 offen offset:2048 lds
    s_add_u32 m0, s14, 3072
    s_nop 0
    buffer_load_dwordx4 v3, s[44:47], s31 offen offset:0 lds
    buffer_load_dwordx4 v2, s[44:47], s7 offen offset:1024 lds
    buffer_load_dwordx4 v3, s[44:47], s8 offen offset:2048 lds
    s_add_u32 m0, s15, 24576
    s_nop 0
    buffer_load_dwordx4 v4, s[48:51], s13 offen offset:0 lds
    buffer_load_dwordx4 v5, s[48:51], s13 offen offset:1024 lds
    s_add_u32 m0, s15, 32768
    s_nop 0
    buffer_load_dwordx4 v6, s[52:55], s13 offen offset:0 lds
    buffer_load_dwordx4 v7, s[52:55], s13 offen offset:1024 lds
    v_add_u32 v2, 0x80, v2
    v_add_u32 v3, 0x80, v3
    s_add_u32 s13, s13, 196608
    s_add_u32 s9, s9, 1
    s_cmp_eq_u32 s9, 10
    s_cselect_b32 s96, 1280, 0
    s_cselect_b32 s97, 1966080, 0
    s_sub_u32 s13, s13, s97
    v_subrev_u32 v2, s96, v2
    v_subrev_u32 v3, s96, v3
    s_add_u32 s48, s42, 0x600000
    s_addc_u32 s49, s43, 0
    s_mov_b32 s50, 0x1e0000
    s_mov_b32 s51, 0x00020000
    s_add_u32 s52, s42, 0xce0000
    s_addc_u32 s53, s43, 0
    s_mov_b32 s54, 0x4000
    s_mov_b32 s55, 0x00020000
    s_add_u32 s64, s42, 0xa60000
    s_addc_u32 s65, s43, 0
    s_mov_b32 s66, 0x280000
    s_mov_b32 s67, 0x00020000
    s_waitcnt vmcnt(10)
    s_barrier
    buffer_load_dword v243, v240, s[72:75], 0 offen sc1
    s_mov_b32 s60, s24
    s_mov_b32 s61, s25
    s_mov_b32 s62, 0x280000
    s_mov_b32 s63, 0x00020000
    v_bfe_u32 v9, v1, 4, 1
    v_lshlrev_b32 v9, 1, v9
    v_xor_b32 v9, v9, v1
    v_lshlrev_b32 v9, 4, v9
    s_add_u32 m0, s82, 512
    s_nop 0
    buffer_load_dwordx4 v9, s[60:63], s81 offen offset:0 lds
    buffer_load_dwordx4 v9, s[60:63], s81 offen offset:1024 lds
    buffer_load_dwordx4 v9, s[60:63], s81 offen offset:2048 lds
    buffer_load_dwordx4 v9, s[60:63], s81 offen offset:3072 lds
    s_waitcnt vmcnt(4)
    s_mov_b32 s94, 200000
Lp_3:
    v_cmp_ne_u32 vcc, s92, v243
    s_nop 1
    s_cbranch_vccz Lp_ok_4
    s_sleep 4
    buffer_load_dword v243, v240, s[72:75], 0 offen sc1
    s_waitcnt vmcnt(0)
    s_sub_u32 s94, s94, 1
    s_cmp_lg_u32 s94, 0
    s_cbranch_scc1 Lp_3
Lp_ok_4:
    s_add_u32 m0, s83, 64
    s_nop 0
    buffer_load_dwordx4 v241, s[56:59], s81 offen offset:0 sc1 lds
    buffer_load_dwordx4 v241, s[56:59], s81 offen offset:1024 sc1 lds
    buffer_load_dwordx4 v241, s[56:59], s81 offen offset:2048 sc1 lds
    buffer_load_dwordx4 v241, s[56:59], s81 offen offset:3072 sc1 lds
    s_lshl_b32 s96, s10, 2
    s_add_u32 s96, s96, 160688
    v_mov_b32 v236, s96
    v_mov_b32 v237, 1
    ds_write_b32 v236, v237
    s_waitcnt lgkmcnt(0)
    s_barrier
    s_setprio 1
    s_waitcnt vmcnt(0)
    ds_read_b64_tr_b16 v[24:25], v23 offset:0
    ds_read_b64_tr_b16 v[26:27], v23 offset:32
    ds_read_b64_tr_b16 v[184:185], v14 offset:512
    ds_read_b64_tr_b16 v[186:187], v15 offset:512
    ds_read_b64_tr_b16 v[28:29], v23 offset:128
    ds_read_b64_tr_b16 v[30:31], v23 offset:160
    ds_read_b64_tr_b16 v[188:189], v16 offset:512
    ds_read_b64_tr_b16 v[190:191], v17 offset:512
    ds_read_b64_tr_b16 v[32:33], v23 offset:256
    ds_read_b64_tr_b16 v[34:35], v23 offset:288
    ds_read_b64_tr_b16 v[192:193], v18 offset:512
    ds_read_b64_tr_b16 v[194:195], v19 offset:512
    s_waitcnt lgkmcnt(8)
    v_mfma_f32_32x32x16_bf16 v[136:151], v[184:187], v[24:27], 0
    ds_read_b64_tr_b16 v[36:37], v23 offset:384
    ds_read_b64_tr_b16 v[38:39], v23 offset:416
    ds_read_b64_tr_b16 v[196:197], v20 offset:512
    ds_read_b64_tr_b16 v[198:199], v21 offset:512
    s_waitcnt lgkmcnt(8)
    v_mfma_f32_32x32x16_bf16 v[136:151], v[188:191], v[28:31], v[136:151]
    ds_read_b64_tr_b16 v[40:41], v23 offset:512
    ds_read_b64_tr_b16 v[42:43], v23 offset:544
    ds_read_b64_tr_b16 v[200:201], v14 offset:0
    ds_read_b64_tr_b16 v[202:203], v15 offset:0
    s_waitcnt lgkmcnt(8)
    v_mfma_f32_32x32x16_bf16 v[136:151], v[192:195], v[32:35], v[136:151]
    ds_read_b64_tr_b16 v[44:45], v23 offset:640
    ds_read_b64_tr_b16 v[46:47], v23 offset:672
    ds_read_b64_tr_b16 v[184:185], v16 offset:0
    ds_read_b64_tr_b16 v[186:187], v17 offset:0
    s_waitcnt lgkmcnt(8)
    v_mfma_f32_32x32x16_bf16 v[136:151], v[196:199], v[36:39], v[136:151]
    ds_read_b64_tr_b16 v[48:49], v23 offset:768
    ds_read_b64_tr_b16 v[50:51], v23 offset:800
    ds_read_b64_tr_b16 v[188:189], v18 offset:0
    ds_read_b64_tr_b16 v[190:191], v19 offset:0
    s_waitcnt lgkmcnt(8)
    v_mfma_f32_32x32x16_bf16 v[136:151], v[200:203], v[40:43], v[136:151]
    ds_read_b64_tr_b16 v[52:53], v23 offset:896
    ds_read_b64_tr_b16 v[54:55], v23 offset:928
    ds_read_b64_tr_b16 v[192:193], v20 offset:0
    ds_read_b64_tr_b16 v[194:195], v21 offset:0
    v_mfma_f32_32x32x16_bf16 v[120:135], v[200:203], v[24:27], 0
    s_waitcnt lgkmcnt(8)
    v_mfma_f32_32x32x16_bf16 v[136:151], v[184:187], v[44:47], v[136:151]
    ds_read_b64_tr_b16 v[196:197], v14 offset:1536
    ds_read_b64_tr_b16 v[198:199], v15 offset:1536
    v_mfma_f32_32x32x16_bf16 v[120:135], v[184:187], v[28:31], v[120:135]
    s_waitcnt lgkmcnt(6)
    v_mfma_f32_32x32x16_bf16 v[136:151], v[188:191], v[48:51], v[136:151]
    ds_read_b64_tr_b16 v[200:201], v16 offset:1536
    ds_read_b64_tr_b16 v[202:203], v17 offset:1536
    v_mfma_f32_32x32x16_bf16 v[120:135], v[188:191], v[32:35], v[120:135]
    s_waitcnt lgkmcnt(4)
    v_mfma_f32_32x32x16_bf16 v[136:151], v[192:195], v[52:55], v[136:151]
    ds_read_b64_tr_b16 v[184:185], v18 offset:1536
    ds_read_b64_tr_b16 v[186:187], v19 offset:1536
    v_mfma_f32_32x32x16_bf16 v[120:135], v[192:195], v[36:39], v[120:135]
    s_waitcnt lgkmcnt(4)
    v_mfma_f32_32x32x16_bf16 v[168:183], v[196:199], v[24:27], 0
    ds_read_b64_tr_b16 v[188:189], v20 offset:1536
    ds_read_b64_tr_b16 v[190:191], v21 offset:1536
    s_waitcnt lgkmcnt(4)
    v_mfma_f32_32x32x16_bf16 v[168:183], v[200:203], v[28:31], v[168:183]
    ds_read_b64_tr_b16 v[192:193], v14 offset:1024
    ds_read_b64_tr_b16 v[194:195], v15 offset:1024
    s_waitcnt lgkmcnt(4)
    v_mfma_f32_32x32x16_bf16 v[168:183], v[184:187], v[32:35], v[168:183]
    ds_read_b64_tr_b16 v[196:197], v16 offset:1024
    ds_read_b64_tr_b16 v[198:199], v17 offset:1024
    ds_read_u16_d16_hi v208, v242 offset:0
    ds_read_u16_d16_hi v209, v242 offset:128
    ds_read_u16_d16_hi v210, v242 offset:256
    s_waitcnt lgkmcnt(7)
    v_mfma_f32_32x32x16_bf16 v[168:183], v[188:191], v[36:39], v[168:183]
    ds_read_b64_tr_b16 v[200:201], v18 offset:1024
    ds_read_b64_tr_b16 v[202:203], v19 offset:1024
    ds_read_u16_d16_hi v211, v242 offset:384
    ds_read_u16_d16_hi v212, v242 offset:512
    ds_read_u16_d16_hi v213, v242 offset:640
    s_waitcnt lgkmcnt(10)
    v_mfma_f32_32x32x16_bf16 v[168:183], v[192:195], v[40:43], v[168:183]
    ds_read_b64_tr_b16 v[184:185], v20 offset:1024
    ds_read_b64_tr_b16 v[186:187], v21 offset:1024
    ds_read_u16_d16_hi v214, v242 offset:768
    ds_read_u16_d16_hi v215, v242 offset:896
    v_cndmask_b32 v216, v123, v204, s[90:91]
    v_mfma_f32_32x32x16_bf16 v[152:167], v[192:195], v[24:27], 0
    v_cndmask_b32 v217, v127, v123, s[90:91]
    v_cndmask_b32 v218, v131, v127, s[90:91]
    v_cndmask_b32 v219, v135, v131, s[90:91]
    v_add_f32_dpp v122, v216, v122 wave_ror:1 row_mask:0xf bank_mask:0xf
    s_waitcnt lgkmcnt(12)
    v_mfma_f32_32x32x16_bf16 v[168:183], v[196:199], v[44:47], v[168:183]
    ds_read_b64_tr_b16 v[56:57], v23 offset:1024
    ds_read_b64_tr_b16 v[58:59], v23 offset:1056
    ds_read_b64_tr_b16 v[188:189], v14 offset:512
    ds_read_b64_tr_b16 v[190:191], v15 offset:512
    v_add_f32_dpp v126, v217, v126 wave_ror:1 row_mask:0xf bank_mask:0xf
    v_add_f32_dpp v130, v218, v130 wave_ror:1 row_mask:0xf bank_mask:0xf
    v_add_f32_dpp v134, v219, v134 wave_ror:1 row_mask:0xf bank_mask:0xf
    v_mfma_f32_32x32x16_bf16 v[152:167], v[196:199], v[28:31], v[152:167]
    v_cndmask_b32 v216, v122, v205, s[90:91]
    v_cndmask_b32 v217, v126, v122, s[90:91]
    v_cndmask_b32 v218, v130, v126, s[90:91]
    v_cndmask_b32 v219, v134, v130, s[90:91]
    s_waitcnt lgkmcnt(11)
    v_mfma_f32_32x32x16_bf16 v[168:183], v[200:203], v[48:51], v[168:183]
    ds_read_b64_tr_b16 v[60:61], v23 offset:1152
    ds_read_b64_tr_b16 v[62:63], v23 offset:1184
    ds_read_b64_tr_b16 v[192:193], v16 offset:512
    ds_read_b64_tr_b16 v[194:195], v17 offset:512
    v_add_f32_dpp v121, v216, v121 wave_ror:1 row_mask:0xf bank_mask:0xf
    v_add_f32_dpp v125, v217, v125 wave_ror:1 row_mask:0xf bank_mask:0xf
    v_add_f32_dpp v129, v218, v129 wave_ror:1 row_mask:0xf bank_mask:0xf
    v_mfma_f32_32x32x16_bf16 v[152:167], v[200:203], v[32:35], v[152:167]
    v_add_f32_dpp v133, v219, v133 wave_ror:1 row_mask:0xf bank_mask:0xf
    v_cndmask_b32 v216, v121, v206, s[90:91]
    v_cndmask_b32 v217, v125, v121, s[90:91]
    v_cndmask_b32 v218, v129, v125, s[90:91]
    s_waitcnt lgkmcnt(10)
    v_mfma_f32_32x32x16_bf16 v[168:183], v[184:187], v[52:55], v[168:183]
    ds_read_b64_tr_b16 v[64:65], v23 offset:1280
    ds_read_b64_tr_b16 v[66:67], v23 offset:1312
    ds_read_b64_tr_b16 v[196:197], v18 offset:512
    ds_read_b64_tr_b16 v[198:199], v19 offset:512
    v_cndmask_b32 v219, v133, v129, s[90:91]
    v_add_f32_dpp v120, v216, v120 wave_ror:1 row_mask:0xf bank_mask:0xf
    v_add_f32_dpp v124, v217, v124 wave_ror:1 row_mask:0xf bank_mask:0xf
    v_mfma_f32_32x32x16_bf16 v[152:167], v[184:187], v[36:39], v[152:167]
    v_add_f32_dpp v128, v218, v128 wave_ror:1 row_mask:0xf bank_mask:0xf
    v_add_f32_dpp v132, v219, v132 wave_ror:1 row_mask:0xf bank_mask:0xf
    v_cndmask_b32 v216, v139, v135, s[90:91]
    v_cndmask_b32 v217, v143, v139, s[90:91]
    s_waitcnt lgkmcnt(8)
    v_mfma_f32_32x32x16_bf16 v[168:183], v[188:191], v[56:59], v[168:183]
    ds_read_b64_tr_b16 v[68:69], v23 offset:1408
    ds_read_b64_tr_b16 v[70:71], v23 offset:1440
    ds_read_b64_tr_b16 v[200:201], v20 offset:512
    ds_read_b64_tr_b16 v[202:203], v21 offset:512
    v_cndmask_b32 v218, v147, v143, s[90:91]
    v_cndmask_b32 v219, v151, v147, s[90:91]
    v_mov_b32 v204, v151
    v_mfma_f32_32x32x16_bf16 v[152:167], v[188:191], v[40:43], v[152:167]
    v_add_f32_dpp v138, v216, v138 wave_ror:1 row_mask:0xf bank_mask:0xf
    v_add_f32_dpp v142, v217, v142 wave_ror:1 row_mask:0xf bank_mask:0xf
    v_add_f32_dpp v146, v218, v146 wave_ror:1 row_mask:0xf bank_mask:0xf
    v_add_f32_dpp v150, v219, v150 wave_ror:1 row_mask:0xf bank_mask:0xf
    s_waitcnt lgkmcnt(8)
    v_mfma_f32_32x32x16_bf16 v[168:183], v[192:195], v[60:63], v[168:183]
    ds_read_b64_tr_b16 v[72:73], v23 offset:1536
    ds_read_b64_tr_b16 v[74:75], v23 offset:1568
    ds_read_b64_tr_b16 v[184:185], v14 offset:0
    ds_read_b64_tr_b16 v[186:187], v15 offset:0
    v_cndmask_b32 v216, v138, v134, s[90:91]
    v_cndmask_b32 v217, v142, v138, s[90:91]
    v_cndmask_b32 v218, v146, v142, s[90:91]
    v_mfma_f32_32x32x16_bf16 v[152:167], v[192:195], v[44:47], v[152:167]
    v_cndmask_b32 v219, v150, v146, s[90:91]
    v_mov_b32 v205, v150
    v_add_f32_dpp v137, v216, v137 wave_ror:1 row_mask:0xf bank_mask:0xf
    v_add_f32_dpp v141, v217, v141 wave_ror:1 row_mask:0xf bank_mask:0xf
    s_waitcnt lgkmcnt(8)
    v_mfma_f32_32x32x16_bf16 v[168:183], v[196:199], v[64:67], v[168:183]
    ds_read_b64_tr_b16 v[76:77], v23 offset:1664
    ds_read_b64_tr_b16 v[78:79], v23 offset:1696
    ds_read_b64_tr_b16 v[188:189], v16 offset:0
    ds_read_b64_tr_b16 v[190:191], v17 offset:0
    v_add_f32_dpp v145, v218, v145 wave_ror:1 row_mask:0xf bank_mask:0xf
    v_add_f32_dpp v149, v219, v149 wave_ror:1 row_mask:0xf bank_mask:0xf
    v_cndmask_b32 v216, v137, v133, s[90:91]
    v_mfma_f32_32x32x16_bf16 v[152:167], v[196:199], v[48:51], v[152:167]
    v_cndmask_b32 v217, v141, v137, s[90:91]
    v_cndmask_b32 v218, v145, v141, s[90:91]
    v_cndmask_b32 v219, v149, v145, s[90:91]
    v_mov_b32 v206, v149
    s_waitcnt lgkmcnt(8)
    v_mfma_f32_32x32x16_bf16 v[168:183], v[200:203], v[68:71], v[168:183]
    ds_read_b64_tr_b16 v[80:81], v23 offset:1792
    ds_read_b64_tr_b16 v[82:83], v23 offset:1824
    ds_read_b64_tr_b16 v[192:193], v18 offset:0
    ds_read_b64_tr_b16 v[194:195], v19 offset:0
    v_add_f32_dpp v136, v216, v136 wave_ror:1 row_mask:0xf bank_mask:0xf
    v_add_f32_dpp v140, v217, v140 wave_ror:1 row_mask:0xf bank_mask:0xf
    v_add_f32_dpp v144, v218, v144 wave_ror:1 row_mask:0xf bank_mask:0xf
    v_mfma_f32_32x32x16_bf16 v[152:167], v[200:203], v[52:55], v[152:167]
    v_add_f32_dpp v148, v219, v148 wave_ror:1 row_mask:0xf bank_mask:0xf
    v_fma_f32 v120, s86, v208, v120
    v_fma_f32 v124, s86, v209, v124
    v_cvt_pk_bf16_f32 v220, v120, v124
    s_waitcnt lgkmcnt(8)
    v_mfma_f32_32x32x16_bf16 v[168:183], v[184:187], v[72:75], v[168:183]
    ds_read_b64_tr_b16 v[84:85], v23 offset:1920
    ds_read_b64_tr_b16 v[86:87], v23 offset:1952
    ds_read_b64_tr_b16 v[196:197], v20 offset:0
    ds_read_b64_tr_b16 v[198:199], v21 offset:0
    v_min_u32 v220, -2, v220
    v_fma_f32 v128, s86, v210, v128
    v_fma_f32 v132, s86, v211, v132
    v_mfma_f32_32x32x16_bf16 v[152:167], v[184:187], v[56:59], v[152:167]
    v_cvt_pk_bf16_f32 v221, v128, v132
    v_min_u32 v221, -2, v221
    v_fma_f32 v136, s86, v212, v136
    v_fma_f32 v140, s86, v213, v140
    s_waitcnt lgkmcnt(8)
    v_mfma_f32_32x32x16_bf16 v[168:183], v[188:191], v[76:79], v[168:183]
    ds_read_b64_tr_b16 v[200:201], v14 offset:2560
    ds_read_b64_tr_b16 v[202:203], v15 offset:2560
    v_cvt_pk_bf16_f32 v222, v136, v140
    v_min_u32 v222, -2, v222
    v_fma_f32 v144, s86, v214, v144
    v_mfma_f32_32x32x16_bf16 v[152:167], v[188:191], v[60:63], v[152:167]
    v_fma_f32 v148, s86, v215, v148
    v_cvt_pk_bf16_f32 v223, v144, v148
    v_min_u32 v223, -2, v223
    s_waitcnt lgkmcnt(6)
    v_mfma_f32_32x32x16_bf16 v[168:183], v[192:195], v[80:83], v[168:183]
    ds_read_b64_tr_b16 v[184:185], v16 offset:2560
    ds_read_b64_tr_b16 v[186:187], v17 offset:2560
    v_mfma_f32_32x32x16_bf16 v[152:167], v[192:195], v[64:67], v[152:167]
    s_waitcnt lgkmcnt(4)
    v_mfma_f32_32x32x16_bf16 v[168:183], v[196:199], v[84:87], v[168:183]
    ds_read_b64_tr_b16 v[188:189], v18 offset:2560
    ds_read_b64_tr_b16 v[190:191], v19 offset:2560
    v_mfma_f32_32x32x16_bf16 v[152:167], v[196:199], v[68:71], v[152:167]
    s_waitcnt lgkmcnt(4)
    v_mfma_f32_32x32x16_bf16 v[136:151], v[200:203], v[24:27], 0
    ds_read_b64_tr_b16 v[192:193], v20 offset:2560
    ds_read_b64_tr_b16 v[194:195], v21 offset:2560
    s_waitcnt lgkmcnt(4)
    v_mfma_f32_32x32x16_bf16 v[136:151], v[184:187], v[28:31], v[136:151]
    ds_read_b64_tr_b16 v[196:197], v14 offset:2048
    ds_read_b64_tr_b16 v[198:199], v15 offset:2048
    s_waitcnt lgkmcnt(4)
    v_mfma_f32_32x32x16_bf16 v[136:151], v[188:191], v[32:35], v[136:151]
    ds_read_b64_tr_b16 v[200:201], v16 offset:2048
    ds_read_b64_tr_b16 v[202:203], v17 offset:2048
    ds_read_u16_d16_hi v208, v242 offset:1024
    ds_read_u16_d16_hi v209, v242 offset:1152
    ds_read_u16_d16_hi v210, v242 offset:1280
    s_waitcnt lgkmcnt(7)
    v_mfma_f32_32x32x16_bf16 v[136:151], v[192:195], v[36:39], v[136:151]
    ds_read_b64_tr_b16 v[184:185], v18 offset:2048
    ds_read_b64_tr_b16 v[186:187], v19 offset:2048
    ds_read_u16_d16_hi v211, v242 offset:1408
    ds_read_u16_d16_hi v212, v242 offset:1536
    ds_read_u16_d16_hi v213, v242 offset:1664
    s_waitcnt lgkmcnt(10)
    v_mfma_f32_32x32x16_bf16 v[136:151], v[196:199], v[40:43], v[136:151]
    ds_read_b64_tr_b16 v[188:189], v20 offset:2048
    ds_read_b64_tr_b16 v[190:191], v21 offset:2048
    ds_read_u16_d16_hi v214, v242 offset:1792
    ds_read_u16_d16_hi v215, v242 offset:1920
    v_cndmask_b32 v216, v155, v204, s[90:91]
    v_mfma_f32_32x32x16_bf16 v[120:135], v[196:199], v[24:27], 0
    v_cndmask_b32 v217, v159, v155, s[90:91]
    v_cndmask_b32 v218, v163, v159, s[90:91]
    v_cndmask_b32 v219, v167, v163, s[90:91]
    v_add_f32_dpp v154, v216, v154 wave_ror:1 row_mask:0xf bank_mask:0xf
    s_waitcnt lgkmcnt(12)
    v_mfma_f32_32x32x16_bf16 v[136:151], v[200:203], v[44:47], v[136:151]
    ds_read_b64_tr_b16 v[192:193], v14 offset:1536
    ds_read_b64_tr_b16 v[194:195], v15 offset:1536
    v_add_f32_dpp v158, v217, v158 wave_ror:1 row_mask:0xf bank_mask:0xf
    v_add_f32_dpp v162, v218, v162 wave_ror:1 row_mask:0xf bank_mask:0xf
    v_add_f32_dpp v166, v219, v166 wave_ror:1 row_mask:0xf bank_mask:0xf
    v_mfma_f32_32x32x16_bf16 v[120:135], v[200:203], v[28:31], v[120:135]
    v_cndmask_b32 v216, v154, v205, s[90:91]
    v_cndmask_b32 v217, v158, v154, s[90:91]
    v_cndmask_b32 v218, v162, v158, s[90:91]
    v_cndmask_b32 v219, v166, v162, s[90:91]
    s_waitcnt lgkmcnt(9)
    v_mfma_f32_32x32x16_bf16 v[136:151], v[184:187], v[48:51], v[136:151]
    ds_read_b64_tr_b16 v[196:197], v16 offset:1536
    ds_read_b64_tr_b16 v[198:199], v17 offset:1536
    v_add_f32_dpp v153, v216, v153 wave_ror:1 row_mask:0xf bank_mask:0xf
    v_add_f32_dpp v157, v217, v157 wave_ror:1 row_mask:0xf bank_mask:0xf
    v_add_f32_dpp v161, v218, v161 wave_ror:1 row_mask:0xf bank_mask:0xf
    v_mfma_f32_32x32x16_bf16 v[120:135], v[184:187], v[32:35], v[120:135]
    v_add_f32_dpp v165, v219, v165 wave_ror:1 row_mask:0xf bank_mask:0xf
    v_cndmask_b32 v216, v153, v206, s[90:91]
    v_cndmask_b32 v217, v157, v153, s[90:91]
    v_cndmask_b32 v218, v161, v157, s[90:91]
    s_waitcnt lgkmcnt(6)
    v_mfma_f32_32x32x16_bf16 v[136:151], v[188:191], v[52:55], v[136:151]
    ds_read_b64_tr_b16 v[200:201], v18 offset:1536
    ds_read_b64_tr_b16 v[202:203], v19 offset:1536
    v_cndmask_b32 v219, v165, v161, s[90:91]
    v_add_f32_dpp v152, v216, v152 wave_ror:1 row_mask:0xf bank_mask:0xf
    v_add_f32_dpp v156, v217, v156 wave_ror:1 row_mask:0xf bank_mask:0xf
    v_mfma_f32_32x32x16_bf16 v[120:135], v[188:191], v[36:39], v[120:135]
    v_add_f32_dpp v160, v218, v160 wave_ror:1 row_mask:0xf bank_mask:0xf
    v_add_f32_dpp v164, v219, v164 wave_ror:1 row_mask:0xf bank_mask:0xf
    v_cndmask_b32 v216, v171, v167, s[90:91]
    v_cndmask_b32 v217, v175, v171, s[90:91]
    s_waitcnt lgkmcnt(4)
    v_mfma_f32_32x32x16_bf16 v[136:151], v[192:195], v[56:59], v[136:151]
    ds_read_b64_tr_b16 v[184:185], v20 offset:1536
    ds_read_b64_tr_b16 v[186:187], v21 offset:1536
    v_cndmask_b32 v218, v179, v175, s[90:91]
    v_cndmask_b32 v219, v183, v179, s[90:91]
    v_mov_b32 v204, v183
    v_mfma_f32_32x32x16_bf16 v[120:135], v[192:195], v[40:43], v[120:135]
    v_add_f32_dpp v170, v216, v170 wave_ror:1 row_mask:0xf bank_mask:0xf
    v_add_f32_dpp v174, v217, v174 wave_ror:1 row_mask:0xf bank_mask:0xf
    v_add_f32_dpp v178, v218, v178 wave_ror:1 row_mask:0xf bank_mask:0xf
    v_add_f32_dpp v182, v219, v182 wave_ror:1 row_mask:0xf bank_mask:0xf
    s_waitcnt lgkmcnt(4)
    v_mfma_f32_32x32x16_bf16 v[136:151], v[196:199], v[60:63], v[136:151]
    ds_read_b64_tr_b16 v[188:189], v14 offset:1024
    ds_read_b64_tr_b16 v[190:191], v15 offset:1024
    v_cndmask_b32 v216, v170, v166, s[90:91]
    v_cndmask_b32 v217, v174, v170, s[90:91]
    v_cndmask_b32 v218, v178, v174, s[90:91]
    v_mfma_f32_32x32x16_bf16 v[120:135], v[196:199], v[44:47], v[120:135]
    v_cndmask_b32 v219, v182, v178, s[90:91]
    v_mov_b32 v205, v182
    v_add_f32_dpp v169, v216, v169 wave_ror:1 row_mask:0xf bank_mask:0xf
    v_add_f32_dpp v173, v217, v173 wave_ror:1 row_mask:0xf bank_mask:0xf
    s_waitcnt lgkmcnt(4)
    v_mfma_f32_32x32x16_bf16 v[136:151], v[200:203], v[64:67], v[136:151]
    ds_read_b64_tr_b16 v[192:193], v16 offset:1024
    ds_read_b64_tr_b16 v[194:195], v17 offset:1024
    v_add_f32_dpp v177, v218, v177 wave_ror:1 row_mask:0xf bank_mask:0xf
    v_add_f32_dpp v181, v219, v181 wave_ror:1 row_mask:0xf bank_mask:0xf
    v_cndmask_b32 v216, v169, v165, s[90:91]
    v_mfma_f32_32x32x16_bf16 v[120:135], v[200:203], v[48:51], v[120:135]
    v_cndmask_b32 v217, v173, v169, s[90:91]
    v_cndmask_b32 v218, v177, v173, s[90:91]
    v_cndmask_b32 v219, v181, v177, s[90:91]
    v_mov_b32 v206, v181
    s_waitcnt lgkmcnt(4)
    v_mfma_f32_32x32x16_bf16 v[136:151], v[184:187], v[68:71], v[136:151]
    ds_read_b64_tr_b16 v[196:197], v18 offset:1024
    ds_read_b64_tr_b16 v[198:199], v19 offset:1024
    v_add_f32_dpp v168, v216, v168 wave_ror:1 row_mask:0xf bank_mask:0xf
    v_add_f32_dpp v172, v217, v172 wave_ror:1 row_mask:0xf bank_mask:0xf
    v_add_f32_dpp v176, v218, v176 wave_ror:1 row_mask:0xf bank_mask:0xf
    v_mfma_f32_32x32x16_bf16 v[120:135], v[184:187], v[52:55], v[120:135]
    v_add_f32_dpp v180, v219, v180 wave_ror:1 row_mask:0xf bank_mask:0xf
    v_fma_f32 v152, s86, v208, v152
    v_fma_f32 v156, s86, v209, v156
    v_cvt_pk_bf16_f32 v224, v152, v156
    s_waitcnt lgkmcnt(4)
    v_mfma_f32_32x32x16_bf16 v[136:151], v[188:191], v[72:75], v[136:151]
    ds_read_b64_tr_b16 v[200:201], v20 offset:1024
    ds_read_b64_tr_b16 v[202:203], v21 offset:1024
    v_min_u32 v224, -2, v224
    v_fma_f32 v160, s86, v210, v160
    v_fma_f32 v164, s86, v211, v164
    v_mfma_f32_32x32x16_bf16 v[120:135], v[188:191], v[56:59], v[120:135]
    v_cvt_pk_bf16_f32 v225, v160, v164
    v_min_u32 v225, -2, v225
    v_fma_f32 v168, s86, v212, v168
    v_fma_f32 v172, s86, v213, v172
    s_waitcnt lgkmcnt(4)
    v_mfma_f32_32x32x16_bf16 v[136:151], v[192:195], v[76:79], v[136:151]
    ds_read_b64_tr_b16 v[88:89], v23 offset:2048
    ds_read_b64_tr_b16 v[90:91], v23 offset:2080
    ds_read_b64_tr_b16 v[184:185], v14 offset:512
    ds_read_b64_tr_b16 v[186:187], v15 offset:512
    v_cvt_pk_bf16_f32 v226, v168, v172
    v_min_u32 v226, -2, v226
    v_fma_f32 v176, s86, v214, v176
    v_mfma_f32_32x32x16_bf16 v[120:135], v[192:195], v[60:63], v[120:135]
    v_fma_f32 v180, s86, v215, v180
    v_cvt_pk_bf16_f32 v227, v176, v180
    v_min_u32 v227, -2, v227
    s_waitcnt lgkmcnt(6)
    v_mfma_f32_32x32x16_bf16 v[136:151], v[196:199], v[80:83], v[136:151]
    ds_read_b64_tr_b16 v[92:93], v23 offset:2176
    ds_read_b64_tr_b16 v[94:95], v23 offset:2208
    ds_read_b64_tr_b16 v[188:189], v16 offset:512
    ds_read_b64_tr_b16 v[190:191], v17 offset:512
    v_mfma_f32_32x32x16_bf16 v[120:135], v[196:199], v[64:67], v[120:135]
    s_waitcnt lgkmcnt(8)
    v_mfma_f32_32x32x16_bf16 v[136:151], v[200:203], v[84:87], v[136:151]
    ds_read_b64_tr_b16 v[96:97], v23 offset:2304
    ds_read_b64_tr_b16 v[98:99], v23 offset:2336
    ds_read_b64_tr_b16 v[192:193], v18 offset:512
    ds_read_b64_tr_b16 v[194:195], v19 offset:512
    v_mfma_f32_32x32x16_bf16 v[120:135], v[200:203], v[68:71], v[120:135]
    s_waitcnt lgkmcnt(8)
    v_mfma_f32_32x32x16_bf16 v[136:151], v[184:187], v[88:91], v[136:151]
    ds_read_b64_tr_b16 v[100:101], v23 offset:2432
    ds_read_b64_tr_b16 v[102:103], v23 offset:2464
    ds_read_b64_tr_b16 v[196:197], v20 offset:512
    ds_read_b64_tr_b16 v[198:199], v21 offset:512
    v_mfma_f32_32x32x16_bf16 v[120:135], v[184:187], v[72:75], v[120:135]
    s_waitcnt lgkmcnt(8)
    v_mfma_f32_32x32x16_bf16 v[136:151], v[188:191], v[92:95], v[136:151]
    ds_read_b64_tr_b16 v[104:105], v23 offset:2560
    ds_read_b64_tr_b16 v[106:107], v23 offset:2592
    ds_read_b64_tr_b16 v[200:201], v14 offset:0
    ds_read_b64_tr_b16 v[202:203], v15 offset:0
    v_mfma_f32_32x32x16_bf16 v[120:135], v[188:191], v[76:79], v[120:135]
    s_waitcnt lgkmcnt(8)
    v_mfma_f32_32x32x16_bf16 v[136:151], v[192:195], v[96:99], v[136:151]
    ds_read_b64_tr_b16 v[108:109], v23 offset:2688
    ds_read_b64_tr_b16 v[110:111], v23 offset:2720
    ds_read_b64_tr_b16 v[184:185], v16 offset:0
    ds_read_b64_tr_b16 v[186:187], v17 offset:0
    v_mfma_f32_32x32x16_bf16 v[120:135], v[192:195], v[80:83], v[120:135]
    s_waitcnt lgkmcnt(8)
    v_mfma_f32_32x32x16_bf16 v[136:151], v[196:199], v[100:103], v[136:151]
    ds_read_b64_tr_b16 v[112:113], v23 offset:2816
    ds_read_b64_tr_b16 v[114:115], v23 offset:2848
    ds_read_b64_tr_b16 v[188:189], v18 offset:0
    ds_read_b64_tr_b16 v[190:191], v19 offset:0
    v_mfma_f32_32x32x16_bf16 v[120:135], v[196:199], v[84:87], v[120:135]
    s_waitcnt lgkmcnt(8)
    v_mfma_f32_32x32x16_bf16 v[136:151], v[200:203], v[104:107], v[136:151]
    ds_read_b64_tr_b16 v[116:117], v23 offset:2944
    ds_read_b64_tr_b16 v[118:119], v23 offset:2976
    ds_read_b64_tr_b16 v[192:193], v20 offset:0
    ds_read_b64_tr_b16 v[194:195], v21 offset:0
    v_mfma_f32_32x32x16_bf16 v[120:135], v[200:203], v[88:91], v[120:135]
    s_waitcnt lgkmcnt(8)
    v_mfma_f32_32x32x16_bf16 v[136:151], v[184:187], v[108:111], v[136:151]
    ds_read_b64_tr_b16 v[196:197], v14 offset:3584
    ds_read_b64_tr_b16 v[198:199], v15 offset:3584
    v_mfma_f32_32x32x16_bf16 v[120:135], v[184:187], v[92:95], v[120:135]
    s_waitcnt lgkmcnt(6)
    v_mfma_f32_32x32x16_bf16 v[136:151], v[188:191], v[112:115], v[136:151]
    ds_read_b64_tr_b16 v[200:201], v16 offset:3584
    ds_read_b64_tr_b16 v[202:203], v17 offset:3584
    v_mfma_f32_32x32x16_bf16 v[120:135], v[188:191], v[96:99], v[120:135]
    s_waitcnt lgkmcnt(4)
    v_mfma_f32_32x32x16_bf16 v[136:151], v[192:195], v[116:119], v[136:151]
    ds_read_b64_tr_b16 v[184:185], v18 offset:3584
    ds_read_b64_tr_b16 v[186:187], v19 offset:3584
    v_mfma_f32_32x32x16_bf16 v[120:135], v[192:195], v[100:103], v[120:135]
    s_waitcnt lgkmcnt(4)
    v_mfma_f32_32x32x16_bf16 v[168:183], v[196:199], v[24:27], 0
    ds_read_b64_tr_b16 v[188:189], v20 offset:3584
    ds_read_b64_tr_b16 v[190:191], v21 offset:3584
    s_waitcnt lgkmcnt(4)
    v_mfma_f32_32x32x16_bf16 v[168:183], v[200:203], v[28:31], v[168:183]
    ds_read_b64_tr_b16 v[192:193], v14 offset:3072
    ds_read_b64_tr_b16 v[194:195], v15 offset:3072
    s_waitcnt lgkmcnt(4)
    v_mfma_f32_32x32x16_bf16 v[168:183], v[184:187], v[32:35], v[168:183]
    ds_read_b64_tr_b16 v[196:197], v16 offset:3072
    ds_read_b64_tr_b16 v[198:199], v17 offset:3072
    ds_read_u16_d16_hi v208, v242 offset:2048
    ds_read_u16_d16_hi v209, v242 offset:2176
    ds_read_u16_d16_hi v210, v242 offset:2304
    s_waitcnt lgkmcnt(7)
    v_mfma_f32_32x32x16_bf16 v[168:183], v[188:191], v[36:39], v[168:183]
    ds_read_b64_tr_b16 v[200:201], v18 offset:3072
    ds_read_b64_tr_b16 v[202:203], v19 offset:3072
    ds_read_u16_d16_hi v211, v242 offset:2432
    ds_read_u16_d16_hi v212, v242 offset:2560
    ds_read_u16_d16_hi v213, v242 offset:2688
    s_waitcnt lgkmcnt(10)
    v_mfma_f32_32x32x16_bf16 v[168:183], v[192:195], v[40:43], v[168:183]
    ds_read_b64_tr_b16 v[184:185], v20 offset:3072
    ds_read_b64_tr_b16 v[186:187], v21 offset:3072
    ds_read_u16_d16_hi v214, v242 offset:2816
    ds_read_u16_d16_hi v215, v242 offset:2944
    v_cndmask_b32 v216, v123, v204, s[90:91]
    v_mfma_f32_32x32x16_bf16 v[152:167], v[192:195], v[24:27], 0
    v_cndmask_b32 v217, v127, v123, s[90:91]
    v_cndmask_b32 v218, v131, v127, s[90:91]
    v_cndmask_b32 v219, v135, v131, s[90:91]
    v_add_f32_dpp v122, v216, v122 wave_ror:1 row_mask:0xf bank_mask:0xf
    s_waitcnt lgkmcnt(12)
    v_mfma_f32_32x32x16_bf16 v[168:183], v[196:199], v[44:47], v[168:183]
    ds_read_b64_tr_b16 v[188:189], v14 offset:2560
    ds_read_b64_tr_b16 v[190:191], v15 offset:2560
    v_add_f32_dpp v126, v217, v126 wave_ror:1 row_mask:0xf bank_mask:0xf
    v_add_f32_dpp v130, v218, v130 wave_ror:1 row_mask:0xf bank_mask:0xf
    v_add_f32_dpp v134, v219, v134 wave_ror:1 row_mask:0xf bank_mask:0xf
    v_mfma_f32_32x32x16_bf16 v[152:167], v[196:199], v[28:31], v[152:167]
    v_cndmask_b32 v216, v122, v205, s[90:91]
    v_cndmask_b32 v217, v126, v122, s[90:91]
    v_cndmask_b32 v218, v130, v126, s[90:91]
    v_cndmask_b32 v219, v134, v130, s[90:91]
    s_waitcnt lgkmcnt(9)
    v_mfma_f32_32x32x16_bf16 v[168:183], v[200:203], v[48:51], v[168:183]
    ds_read_b64_tr_b16 v[192:193], v16 offset:2560
    ds_read_b64_tr_b16 v[194:195], v17 offset:2560
    v_add_f32_dpp v121, v216, v121 wave_ror:1 row_mask:0xf bank_mask:0xf
    v_add_f32_dpp v125, v217, v125 wave_ror:1 row_mask:0xf bank_mask:0xf
    v_add_f32_dpp v129, v218, v129 wave_ror:1 row_mask:0xf bank_mask:0xf
    v_mfma_f32_32x32x16_bf16 v[152:167], v[200:203], v[32:35], v[152:167]
    v_add_f32_dpp v133, v219, v133 wave_ror:1 row_mask:0xf bank_mask:0xf
    v_cndmask_b32 v216, v121, v206, s[90:91]
    v_cndmask_b32 v217, v125, v121, s[90:91]
    v_cndmask_b32 v218, v129, v125, s[90:91]
    s_waitcnt lgkmcnt(6)
    v_mfma_f32_32x32x16_bf16 v[168:183], v[184:187], v[52:55], v[168:183]
    ds_read_b64_tr_b16 v[196:197], v18 offset:2560
    ds_read_b64_tr_b16 v[198:199], v19 offset:2560
    v_cndmask_b32 v219, v133, v129, s[90:91]
    v_add_f32_dpp v120, v216, v120 wave_ror:1 row_mask:0xf bank_mask:0xf
    v_add_f32_dpp v124, v217, v124 wave_ror:1 row_mask:0xf bank_mask:0xf
    v_mfma_f32_32x32x16_bf16 v[152:167], v[184:187], v[36:39], v[152:167]
    v_add_f32_dpp v128, v218, v128 wave_ror:1 row_mask:0xf bank_mask:0xf
    v_add_f32_dpp v132, v219, v132 wave_ror:1 row_mask:0xf bank_mask:0xf
    v_cndmask_b32 v216, v139, v135, s[90:91]
    v_cndmask_b32 v217, v143, v139, s[90:91]
    s_waitcnt lgkmcnt(4)
    v_mfma_f32_32x32x16_bf16 v[168:183], v[188:191], v[56:59], v[168:183]
    ds_read_b64_tr_b16 v[200:201], v20 offset:2560
    ds_read_b64_tr_b16 v[202:203], v21 offset:2560
    v_cndmask_b32 v218, v147, v143, s[90:91]
    v_cndmask_b32 v219, v151, v147, s[90:91]
    v_mov_b32 v204, v151
    v_mfma_f32_32x32x16_bf16 v[152:167], v[188:191], v[40:43], v[152:167]
    v_add_f32_dpp v138, v216, v138 wave_ror:1 row_mask:0xf bank_mask:0xf
    v_add_f32_dpp v142, v217, v142 wave_ror:1 row_mask:0xf bank_mask:0xf
    v_add_f32_dpp v146, v218, v146 wave_ror:1 row_mask:0xf bank_mask:0xf
    v_add_f32_dpp v150, v219, v150 wave_ror:1 row_mask:0xf bank_mask:0xf
    s_waitcnt lgkmcnt(4)
    v_mfma_f32_32x32x16_bf16 v[168:183], v[192:195], v[60:63], v[168:183]
    ds_read_b64_tr_b16 v[184:185], v14 offset:2048
    ds_read_b64_tr_b16 v[186:187], v15 offset:2048
    v_cndmask_b32 v216, v138, v134, s[90:91]
    v_cndmask_b32 v217, v142, v138, s[90:91]
    v_cndmask_b32 v218, v146, v142, s[90:91]
    v_mfma_f32_32x32x16_bf16 v[152:167], v[192:195], v[44:47], v[152:167]
    v_cndmask_b32 v219, v150, v146, s[90:91]
    v_mov_b32 v205, v150
    v_add_f32_dpp v137, v216, v137 wave_ror:1 row_mask:0xf bank_mask:0xf
    v_add_f32_dpp v141, v217, v141 wave_ror:1 row_mask:0xf bank_mask:0xf
    s_waitcnt lgkmcnt(4)
    v_mfma_f32_32x32x16_bf16 v[168:183], v[196:199], v[64:67], v[168:183]
    ds_read_b64_tr_b16 v[188:189], v16 offset:2048
    ds_read_b64_tr_b16 v[190:191], v17 offset:2048
    v_add_f32_dpp v145, v218, v145 wave_ror:1 row_mask:0xf bank_mask:0xf
    v_add_f32_dpp v149, v219, v149 wave_ror:1 row_mask:0xf bank_mask:0xf
    v_cndmask_b32 v216, v137, v133, s[90:91]
    v_mfma_f32_32x32x16_bf16 v[152:167], v[196:199], v[48:51], v[152:167]
    v_cndmask_b32 v217, v141, v137, s[90:91]
    v_cndmask_b32 v218, v145, v141, s[90:91]
    v_cndmask_b32 v219, v149, v145, s[90:91]
    v_mov_b32 v206, v149
    s_waitcnt lgkmcnt(4)
    v_mfma_f32_32x32x16_bf16 v[168:183], v[200:203], v[68:71], v[168:183]
    ds_read_b64_tr_b16 v[192:193], v18 offset:2048
    ds_read_b64_tr_b16 v[194:195], v19 offset:2048
    v_add_f32_dpp v136, v216, v136 wave_ror:1 row_mask:0xf bank_mask:0xf
    v_add_f32_dpp v140, v217, v140 wave_ror:1 row_mask:0xf bank_mask:0xf
    v_add_f32_dpp v144, v218, v144 wave_ror:1 row_mask:0xf bank_mask:0xf
    v_mfma_f32_32x32x16_bf16 v[152:167], v[200:203], v[52:55], v[152:167]
    v_add_f32_dpp v148, v219, v148 wave_ror:1 row_mask:0xf bank_mask:0xf
    v_fma_f32 v120, s86, v208, v120
    v_fma_f32 v124, s86, v209, v124
    v_cvt_pk_bf16_f32 v228, v120, v124
    s_waitcnt lgkmcnt(4)
    v_mfma_f32_32x32x16_bf16 v[168:183], v[184:187], v[72:75], v[168:183]
    ds_read_b64_tr_b16 v[196:197], v20 offset:2048
    ds_read_b64_tr_b16 v[198:199], v21 offset:2048
    v_min_u32 v228, -2, v228
    v_fma_f32 v128, s86, v210, v128
    v_fma_f32 v132, s86, v211, v132
    v_mfma_f32_32x32x16_bf16 v[152:167], v[184:187], v[56:59], v[152:167]
    v_cvt_pk_bf16_f32 v229, v128, v132
    v_min_u32 v229, -2, v229
    v_fma_f32 v136, s86, v212, v136
    v_fma_f32 v140, s86, v213, v140
    s_waitcnt lgkmcnt(4)
    v_mfma_f32_32x32x16_bf16 v[168:183], v[188:191], v[76:79], v[168:183]
    ds_read_b64_tr_b16 v[200:201], v14 offset:1536
    ds_read_b64_tr_b16 v[202:203], v15 offset:1536
    v_cvt_pk_bf16_f32 v230, v136, v140
    v_min_u32 v230, -2, v230
    v_fma_f32 v144, s86, v214, v144
    v_mfma_f32_32x32x16_bf16 v[152:167], v[188:191], v[60:63], v[152:167]
    v_fma_f32 v148, s86, v215, v148
    v_cvt_pk_bf16_f32 v231, v144, v148
    v_min_u32 v231, -2, v231
    s_waitcnt lgkmcnt(4)
    v_mfma_f32_32x32x16_bf16 v[168:183], v[192:195], v[80:83], v[168:183]
    ds_read_b64_tr_b16 v[184:185], v16 offset:1536
    ds_read_b64_tr_b16 v[186:187], v17 offset:1536
    v_mfma_f32_32x32x16_bf16 v[152:167], v[192:195], v[64:67], v[152:167]
    s_waitcnt lgkmcnt(4)
    v_mfma_f32_32x32x16_bf16 v[168:183], v[196:199], v[84:87], v[168:183]
    ds_read_b64_tr_b16 v[188:189], v18 offset:1536
    ds_read_b64_tr_b16 v[190:191], v19 offset:1536
    v_mfma_f32_32x32x16_bf16 v[152:167], v[196:199], v[68:71], v[152:167]
    s_waitcnt lgkmcnt(4)
    v_mfma_f32_32x32x16_bf16 v[168:183], v[200:203], v[88:91], v[168:183]
    ds_read_b64_tr_b16 v[192:193], v20 offset:1536
    ds_read_b64_tr_b16 v[194:195], v21 offset:1536
    v_mfma_f32_32x32x16_bf16 v[152:167], v[200:203], v[72:75], v[152:167]
    s_waitcnt lgkmcnt(4)
    v_mfma_f32_32x32x16_bf16 v[168:183], v[184:187], v[92:95], v[168:183]
    ds_read_b64_tr_b16 v[196:197], v14 offset:1024
    ds_read_b64_tr_b16 v[198:199], v15 offset:1024
    v_mfma_f32_32x32x16_bf16 v[152:167], v[184:187], v[76:79], v[152:167]
    s_waitcnt lgkmcnt(4)
    v_mfma_f32_32x32x16_bf16 v[168:183], v[188:191], v[96:99], v[168:183]
    ds_read_b64_tr_b16 v[200:201], v16 offset:1024
    ds_read_b64_tr_b16 v[202:203], v17 offset:1024
    v_mfma_f32_32x32x16_bf16 v[152:167], v[188:191], v[80:83], v[152:167]
    s_waitcnt lgkmcnt(4)
    v_mfma_f32_32x32x16_bf16 v[168:183], v[192:195], v[100:103], v[168:183]
    ds_read_b64_tr_b16 v[184:185], v18 offset:1024
    ds_read_b64_tr_b16 v[186:187], v19 offset:1024
    v_mfma_f32_32x32x16_bf16 v[152:167], v[192:195], v[84:87], v[152:167]
    s_waitcnt lgkmcnt(4)
    v_mfma_f32_32x32x16_bf16 v[168:183], v[196:199], v[104:107], v[168:183]
    ds_read_b64_tr_b16 v[188:189], v20 offset:1024
    ds_read_b64_tr_b16 v[190:191], v21 offset:1024
    v_mfma_f32_32x32x16_bf16 v[152:167], v[196:199], v[88:91], v[152:167]
    s_waitcnt lgkmcnt(4)
    v_mfma_f32_32x32x16_bf16 v[168:183], v[200:203], v[108:111], v[168:183]
    ds_read_b64_tr_b16 v[120:121], v23 offset:3072
    ds_read_b64_tr_b16 v[122:123], v23 offset:3104
    ds_read_b64_tr_b16 v[192:193], v14 offset:512
    ds_read_b64_tr_b16 v[194:195], v15 offset:512
    v_mfma_f32_32x32x16_bf16 v[152:167], v[200:203], v[92:95], v[152:167]
    s_waitcnt lgkmcnt(6)
    v_mfma_f32_32x32x16_bf16 v[168:183], v[184:187], v[112:115], v[168:183]
    ds_read_b64_tr_b16 v[124:125], v23 offset:3200
    ds_read_b64_tr_b16 v[126:127], v23 offset:3232
    ds_read_b64_tr_b16 v[196:197], v16 offset:512
    ds_read_b64_tr_b16 v[198:199], v17 offset:512
    v_mfma_f32_32x32x16_bf16 v[152:167], v[184:187], v[96:99], v[152:167]
    s_waitcnt lgkmcnt(8)
    v_mfma_f32_32x32x16_bf16 v[168:183], v[188:191], v[116:119], v[168:183]
    ds_read_b64_tr_b16 v[128:129], v23 offset:3328
    ds_read_b64_tr_b16 v[130:131], v23 offset:3360
    ds_read_b64_tr_b16 v[200:201], v18 offset:512
    ds_read_b64_tr_b16 v[202:203], v19 offset:512
    v_mfma_f32_32x32x16_bf16 v[152:167], v[188:191], v[100:103], v[152:167]
    s_waitcnt lgkmcnt(8)
    v_mfma_f32_32x32x16_bf16 v[168:183], v[192:195], v[120:123], v[168:183]
    ds_read_b64_tr_b16 v[132:133], v23 offset:3456
    ds_read_b64_tr_b16 v[134:135], v23 offset:3488
    ds_read_b64_tr_b16 v[184:185], v20 offset:512
    ds_read_b64_tr_b16 v[186:187], v21 offset:512
    v_mfma_f32_32x32x16_bf16 v[152:167], v[192:195], v[104:107], v[152:167]
    s_waitcnt lgkmcnt(8)
    v_mfma_f32_32x32x16_bf16 v[168:183], v[196:199], v[124:127], v[168:183]
    ds_read_b64_tr_b16 v[136:137], v23 offset:3584
    ds_read_b64_tr_b16 v[138:139], v23 offset:3616
    ds_read_b64_tr_b16 v[188:189], v14 offset:0
    ds_read_b64_tr_b16 v[190:191], v15 offset:0
    v_mfma_f32_32x32x16_bf16 v[152:167], v[196:199], v[108:111], v[152:167]
    s_waitcnt lgkmcnt(8)
    v_mfma_f32_32x32x16_bf16 v[168:183], v[200:203], v[128:131], v[168:183]
    ds_read_b64_tr_b16 v[140:141], v23 offset:3712
    ds_read_b64_tr_b16 v[142:143], v23 offset:3744
    ds_read_b64_tr_b16 v[192:193], v16 offset:0
    ds_read_b64_tr_b16 v[194:195], v17 offset:0
    v_mfma_f32_32x32x16_bf16 v[152:167], v[200:203], v[112:115], v[152:167]
    s_waitcnt lgkmcnt(8)
    v_mfma_f32_32x32x16_bf16 v[168:183], v[184:187], v[132:135], v[168:183]
    ds_read_b64_tr_b16 v[144:145], v23 offset:3840
    ds_read_b64_tr_b16 v[146:147], v23 offset:3872
    ds_read_b64_tr_b16 v[196:197], v18 offset:0
    ds_read_b64_tr_b16 v[198:199], v19 offset:0
    v_mfma_f32_32x32x16_bf16 v[152:167], v[184:187], v[116:119], v[152:167]
    s_waitcnt lgkmcnt(8)
    v_mfma_f32_32x32x16_bf16 v[168:183], v[188:191], v[136:139], v[168:183]
    ds_read_b64_tr_b16 v[148:149], v23 offset:3968
    ds_read_b64_tr_b16 v[150:151], v23 offset:4000
    ds_read_b64_tr_b16 v[200:201], v20 offset:0
    ds_read_b64_tr_b16 v[202:203], v21 offset:0
    v_mfma_f32_32x32x16_bf16 v[152:167], v[188:191], v[120:123], v[152:167]
    s_waitcnt lgkmcnt(8)
    v_mfma_f32_32x32x16_bf16 v[168:183], v[192:195], v[140:143], v[168:183]
    v_mfma_f32_32x32x16_bf16 v[152:167], v[192:195], v[124:127], v[152:167]
    s_waitcnt lgkmcnt(4)
    v_mfma_f32_32x32x16_bf16 v[168:183], v[196:199], v[144:147], v[168:183]
    v_mfma_f32_32x32x16_bf16 v[152:167], v[196:199], v[128:131], v[152:167]
    s_waitcnt lgkmcnt(0)
    v_mfma_f32_32x32x16_bf16 v[168:183], v[200:203], v[148:151], v[168:183]
    v_mfma_f32_32x32x16_bf16 v[152:167], v[200:203], v[132:135], v[152:167]
    buffer_store_dwordx4 v[220:223], v241, s[64:67], s81 offen offset:0 sc1
    buffer_store_dwordx4 v[224:227], v241, s[64:67], s81 offen offset:1024 sc1
    buffer_store_dwordx4 v[228:231], v241, s[64:67], s81 offen offset:2048 sc1
    ds_read_u16_d16_hi v208, v242 offset:3072
    ds_read_u16_d16_hi v209, v242 offset:3200
    ds_read_u16_d16_hi v210, v242 offset:3328
    ds_read_u16_d16_hi v211, v242 offset:3456
    ds_read_u16_d16_hi v212, v242 offset:3584
    ds_read_u16_d16_hi v213, v242 offset:3712
    ds_read_u16_d16_hi v214, v242 offset:3840
    ds_read_u16_d16_hi v215, v242 offset:3968
    s_nop 0
    v_cndmask_b32 v216, v155, v204, s[90:91]
    v_cndmask_b32 v217, v159, v155, s[90:91]
    v_cndmask_b32 v218, v163, v159, s[90:91]
    v_cndmask_b32 v219, v167, v163, s[90:91]
    v_add_f32_dpp v154, v216, v154 wave_ror:1 row_mask:0xf bank_mask:0xf
    v_add_f32_dpp v158, v217, v158 wave_ror:1 row_mask:0xf bank_mask:0xf
    v_add_f32_dpp v162, v218, v162 wave_ror:1 row_mask:0xf bank_mask:0xf
    v_add_f32_dpp v166, v219, v166 wave_ror:1 row_mask:0xf bank_mask:0xf
    v_cndmask_b32 v216, v154, v205, s[90:91]
    v_cndmask_b32 v217, v158, v154, s[90:91]
    v_cndmask_b32 v218, v162, v158, s[90:91]
    v_cndmask_b32 v219, v166, v162, s[90:91]
    v_add_f32_dpp v153, v216, v153 wave_ror:1 row_mask:0xf bank_mask:0xf
    v_add_f32_dpp v157, v217, v157 wave_ror:1 row_mask:0xf bank_mask:0xf
    v_add_f32_dpp v161, v218, v161 wave_ror:1 row_mask:0xf bank_mask:0xf
    v_add_f32_dpp v165, v219, v165 wave_ror:1 row_mask:0xf bank_mask:0xf
    v_cndmask_b32 v216, v153, v206, s[90:91]
    v_cndmask_b32 v217, v157, v153, s[90:91]
    v_cndmask_b32 v218, v161, v157, s[90:91]
    v_cndmask_b32 v219, v165, v161, s[90:91]
    v_add_f32_dpp v152, v216, v152 wave_ror:1 row_mask:0xf bank_mask:0xf
    v_add_f32_dpp v156, v217, v156 wave_ror:1 row_mask:0xf bank_mask:0xf
    v_add_f32_dpp v160, v218, v160 wave_ror:1 row_mask:0xf bank_mask:0xf
    v_add_f32_dpp v164, v219, v164 wave_ror:1 row_mask:0xf bank_mask:0xf
    v_cndmask_b32 v216, v171, v167, s[90:91]
    v_cndmask_b32 v217, v175, v171, s[90:91]
    v_cndmask_b32 v218, v179, v175, s[90:91]
    v_cndmask_b32 v219, v183, v179, s[90:91]
    v_mov_b32 v204, v183
    v_add_f32_dpp v170, v216, v170 wave_ror:1 row_mask:0xf bank_mask:0xf
    v_add_f32_dpp v174, v217, v174 wave_ror:1 row_mask:0xf bank_mask:0xf
    v_add_f32_dpp v178, v218, v178 wave_ror:1 row_mask:0xf bank_mask:0xf
    v_add_f32_dpp v182, v219, v182 wave_ror:1 row_mask:0xf bank_mask:0xf
    v_cndmask_b32 v216, v170, v166, s[90:91]
    v_cndmask_b32 v217, v174, v170, s[90:91]
    v_cndmask_b32 v218, v178, v174, s[90:91]
    v_cndmask_b32 v219, v182, v178, s[90:91]
    v_mov_b32 v205, v182
    v_add_f32_dpp v169, v216, v169 wave_ror:1 row_mask:0xf bank_mask:0xf
    v_add_f32_dpp v173, v217, v173 wave_ror:1 row_mask:0xf bank_mask:0xf
    v_add_f32_dpp v177, v218, v177 wave_ror:1 row_mask:0xf bank_mask:0xf
    v_add_f32_dpp v181, v219, v181 wave_ror:1 row_mask:0xf bank_mask:0xf
    v_cndmask_b32 v216, v169, v165, s[90:91]
    v_cndmask_b32 v217, v173, v169, s[90:91]
    v_cndmask_b32 v218, v177, v173, s[90:91]
    v_cndmask_b32 v219, v181, v177, s[90:91]
    v_mov_b32 v206, v181
    v_add_f32_dpp v168, v216, v168 wave_ror:1 row_mask:0xf bank_mask:0xf
    v_add_f32_dpp v172, v217, v172 wave_ror:1 row_mask:0xf bank_mask:0xf
    v_add_f32_dpp v176, v218, v176 wave_ror:1 row_mask:0xf bank_mask:0xf
    v_add_f32_dpp v180, v219, v180 wave_ror:1 row_mask:0xf bank_mask:0xf
    s_waitcnt lgkmcnt(6)
    v_fma_f32 v152, s86, v208, v152
    v_fma_f32 v156, s86, v209, v156
    v_cvt_pk_bf16_f32 v232, v152, v156
    v_min_u32 v232, -2, v232
    s_waitcnt lgkmcnt(4)
    v_fma_f32 v160, s86, v210, v160
    v_fma_f32 v164, s86, v211, v164
    v_cvt_pk_bf16_f32 v233, v160, v164
    v_min_u32 v233, -2, v233
    s_waitcnt lgkmcnt(2)
    v_fma_f32 v168, s86, v212, v168
    v_fma_f32 v172, s86, v213, v172
    v_cvt_pk_bf16_f32 v234, v168, v172
    v_min_u32 v234, -2, v234
    s_waitcnt lgkmcnt(0)
    v_fma_f32 v176, s86, v214, v176
    v_fma_f32 v180, s86, v215, v180
    v_cvt_pk_bf16_f32 v235, v176, v180
    v_min_u32 v235, -2, v235
    buffer_store_dwordx4 v[232:235], v241, s[64:67], s81 offen offset:3072 sc1
    s_lshr_b32 s97, s84, 3
    s_lshl_b32 s97, s97, 9
    s_and_b32 s96, s84, 7
    s_lshl_b32 s96, s96, 3
    s_add_u32 s97, s97, s96
    s_lshl_b32 s96, s10, 1
    s_add_u32 s97, s97, s96
    s_mul_i32 s97, s97, 1280
    s_mul_i32 s96, s85, 160
    s_add_u32 s97, s97, s96
    v_add_u32 v2, 0, v1
    v_mul_u32_u24 v3, 6554, v2
    v_lshrrev_b32 v3, 16, v3
    v_mul_u32_u24 v4, 10, v3
    v_sub_u32 v4, v2, v4
    v_and_b32 v5, 7, v3
    v_lshlrev_b32 v5, 6, v5
    v_lshrrev_b32 v3, 3, v3
    v_add_u32 v3, v3, v5
    v_mul_u32_u24 v3, 1280, v3
    v_lshl_add_u32 v3, v4, 4, v3
    s_add_u32 m0, s83, 0
    s_nop 0
    buffer_load_dwordx4 v3, s[44:47], s97 offen lds
    v_add_u32 v2, 64, v1
    v_mul_u32_u24 v3, 6554, v2
    v_lshrrev_b32 v3, 16, v3
    v_mul_u32_u24 v4, 10, v3
    v_sub_u32 v4, v2, v4
    v_and_b32 v5, 7, v3
    v_lshlrev_b32 v5, 6, v5
    v_lshrrev_b32 v3, 3, v3
    v_add_u32 v3, v3, v5
    v_mul_u32_u24 v3, 1280, v3
    v_lshl_add_u32 v3, v4, 4, v3
    s_add_u32 m0, s83, 1024
    s_nop 0
    buffer_load_dwordx4 v3, s[44:47], s97 offen lds
    v_add_u32 v2, 128, v1
    v_mul_u32_u24 v3, 6554, v2
    v_lshrrev_b32 v3, 16, v3
    v_mul_u32_u24 v4, 10, v3
    v_sub_u32 v4, v2, v4
    v_and_b32 v5, 7, v3
    v_lshlrev_b32 v5, 6, v5
    v_lshrrev_b32 v3, 3, v3
    v_add_u32 v3, v3, v5
    v_mul_u32_u24 v3, 1280, v3
    v_lshl_add_u32 v3, v4, 4, v3
    v_cmp_gt_u32 vcc, 32, v1
    v_mov_b32 v4, 0x80000000
    s_nop 0
    v_cndmask_b32 v3, v4, v3, vcc
    s_add_u32 m0, s83, 2048
    s_nop 0
    buffer_load_dwordx4 v3, s[44:47], s97 offen lds
    s_lshl_b32 s89, s85, 8
    s_add_u32 s89, s89, 17408
    v_min_u32 v247, 47, v1
    v_lshlrev_b32 v247, 2, v247
    buffer_load_dword v239, v247, s[72:75], s89 offen sc1
    s_waitcnt vmcnt(0)
    s_mov_b32 s94, 200000
Lp_5:
    v_cmp_ne_u32 vcc, s92, v239
    s_nop 1
    s_cbranch_vccz Lp_ok_6
    s_sleep 4
    buffer_load_dword v239, v247, s[72:75], s89 offen sc1
    s_waitcnt vmcnt(0)
    s_sub_u32 s94, s94, 1
    s_cmp_lg_u32 s94, 0
    s_cbranch_scc1 Lp_5
Lp_ok_6:
    s_setprio 0
    s_branch Lfetch
LtypeB:
    s_mov_b32 s56, s34
    s_mov_b32 s57, s35
    s_mov_b32 s58, 0x1e0000
    s_mov_b32 s59, 0x00020000
    s_mov_b32 s68, s36
    s_mov_b32 s69, s37
    s_mov_b32 s70, 0x500
    s_mov_b32 s71, 0x00020000
    s_mul_i32 s78, s4, 12
    s_add_u32 s78, s78, s5
    s_sub_u32 s78, s78, 20
    s_lshl_b32 s78, s78, 2
    s_add_u32 s78, s78, s10
    s_lshr_b32 s79, s78, 3
    s_and_b32 s78, s78, 7
    s_mul_i32 s89, s78, 48
    s_add_u32 s89, s89, s79
    s_lshl_b32 s89, s89, 2
    s_add_u32 s89, s89, 14848
    s_mul_i32 s80, s79, 40960
    s_mul_i32 s77, s78, 160
    s_add_u32 s80, s80, s77
    s_mul_i32 s81, s78, 245760
    s_mul_i32 s77, s79, 5120
    s_add_u32 s81, s81, s77
    v_min_u32 v240, 11, v1
    v_lshlrev_b32 v240, 2, v240
    s_waitcnt vmcnt(10)
    s_barrier
    s_add_u32 m0, s14, 82176
    s_nop 0
    buffer_load_dwordx4 v2, s[44:47], s28 offen offset:0 lds
    buffer_load_dwordx4 v3, s[44:47], s29 offen offset:1024 lds
    buffer_load_dwordx4 v2, s[44:47], s30 offen offset:2048 lds
    s_add_u32 m0, s14, 85248
    s_nop 0
    buffer_load_dwordx4 v3, s[44:47], s31 offen offset:0 lds
    buffer_load_dwordx4 v2, s[44:47], s7 offen offset:1024 lds
    buffer_load_dwordx4 v3, s[44:47], s8 offen offset:2048 lds
    s_add_u32 m0, s15, 106752
    s_nop 0
    buffer_load_dwordx4 v4, s[48:51], s13 offen offset:0 lds
    buffer_load_dwordx4 v5, s[48:51], s13 offen offset:1024 lds
    s_add_u32 m0, s15, 114944
    s_nop 0
    buffer_load_dwordx4 v6, s[52:55], s13 offen offset:0 lds
    buffer_load_dwordx4 v7, s[52:55], s13 offen offset:1024 lds
    v_add_u32 v2, 0x80, v2
    v_add_u32 v3, 0x80, v3
    s_add_u32 s13, s13, 196608
    s_add_u32 s9, s9, 1
    s_cmp_eq_u32 s9, 10
    s_cselect_b32 s96, 1280, 0
    s_cselect_b32 s97, 1966080, 0
    s_sub_u32 s13, s13, s97
    v_subrev_u32 v2, s96, v2
    v_subrev_u32 v3, s96, v3
    s_add_u32 s64, s42, 0xa60000
    s_addc_u32 s65, s43, 0
    s_mov_b32 s66, 0x280000
    s_mov_b32 s67, 0x00020000
    s_sub_u32 s76, s5, 20
    s_lshl_b32 s76, s76, 2
    s_add_u32 s76, s76, s10
    s_lshl_b32 s77, s4, 6
    s_add_u32 s87, s76, s77
    s_lshl_b32 s87, s87, 2
    s_add_u32 s87, s87, 17408
    s_mul_i32 s76, s76, 7
    v_mov_b32 v232, -1
    v_mov_b32 v233, -1
    v_mov_b32 v234, -1
    v_mov_b32 v235, -1
    s_add_u32 s77, s76, 0
    s_cmp_ge_u32 s77, 320
    s_cselect_b32 s78, 0x40000000, 0
    s_lshl_b32 s77, s77, 10
    s_mul_i32 s79, s4, 327680
    s_add_u32 s77, s77, s79
    s_or_b32 s77, s77, s78
    buffer_store_dwordx4 v[232:235], v241, s[64:67], s77 offen sc1
    s_add_u32 s77, s76, 1
    s_cmp_ge_u32 s77, 320
    s_cselect_b32 s78, 0x40000000, 0
    s_lshl_b32 s77, s77, 10
    s_mul_i32 s79, s4, 327680
    s_add_u32 s77, s77, s79
    s_or_b32 s77, s77, s78
    buffer_store_dwordx4 v[232:235], v241, s[64:67], s77 offen sc1
    s_add_u32 s77, s76, 2
    s_cmp_ge_u32 s77, 320
    s_cselect_b32 s78, 0x40000000, 0
    s_lshl_b32 s77, s77, 10
    s_mul_i32 s79, s4, 327680
    s_add_u32 s77, s77, s79
    s_or_b32 s77, s77, s78
    buffer_store_dwordx4 v[232:235], v241, s[64:67], s77 offen sc1
    s_add_u32 s77, s76, 3
    s_cmp_ge_u32 s77, 320
    s_cselect_b32 s78, 0x40000000, 0
    s_lshl_b32 s77, s77, 10
    s_mul_i32 s79, s4, 327680
    s_add_u32 s77, s77, s79
    s_or_b32 s77, s77, s78
    buffer_store_dwordx4 v[232:235], v241, s[64:67], s77 offen sc1
    s_add_u32 s77, s76, 4
    s_cmp_ge_u32 s77, 320
    s_cselect_b32 s78, 0x40000000, 0
    s_lshl_b32 s77, s77, 10
    s_mul_i32 s79, s4, 327680
    s_add_u32 s77, s77, s79
    s_or_b32 s77, s77, s78
    buffer_store_dwordx4 v[232:235], v241, s[64:67], s77 offen sc1
    s_add_u32 s77, s76, 5
    s_cmp_ge_u32 s77, 320
    s_cselect_b32 s78, 0x40000000, 0
    s_lshl_b32 s77, s77, 10
    s_mul_i32 s79, s4, 327680
    s_add_u32 s77, s77, s79
    s_or_b32 s77, s77, s78
    buffer_store_dwordx4 v[232:235], v241, s[64:67], s77 offen sc1
    s_add_u32 s77, s76, 6
    s_cmp_ge_u32 s77, 320
    s_cselect_b32 s78, 0x40000000, 0
    s_lshl_b32 s77, s77, 10
    s_mul_i32 s79, s4, 327680
    s_add_u32 s77, s77, s79
    s_or_b32 s77, s77, s78
    buffer_store_dwordx4 v[232:235], v241, s[64:67], s77 offen sc1
    s_waitcnt vmcnt(17)
    s_barrier
    s_add_u32 m0, s14, 0
    s_nop 0
    buffer_load_dwordx4 v2, s[44:47], s28 offen offset:0 lds
    buffer_load_dwordx4 v3, s[44:47], s29 offen offset:1024 lds
    buffer_load_dwordx4 v2, s[44:47], s30 offen offset:2048 lds
    s_add_u32 m0, s14, 3072
    s_nop 0
    buffer_load_dwordx4 v3, s[44:47], s31 offen offset:0 lds
    buffer_load_dwordx4 v2, s[44:47], s7 offen offset:1024 lds
    buffer_load_dwordx4 v3, s[44:47], s8 offen offset:2048 lds
    s_add_u32 m0, s15, 24576
    s_nop 0
    buffer_load_dwordx4 v4, s[48:51], s13 offen offset:0 lds
    buffer_load_dwordx4 v5, s[48:51], s13 offen offset:1024 lds
    s_add_u32 m0, s15, 32768
    s_nop 0
    buffer_load_dwordx4 v6, s[52:55], s13 offen offset:0 lds
    buffer_load_dwordx4 v7, s[52:55], s13 offen offset:1024 lds
    v_add_u32 v2, 0x80, v2
    v_add_u32 v3, 0x80, v3
    s_add_u32 s13, s13, 196608
    s_add_u32 s9, s9, 1
    s_cmp_eq_u32 s9, 10
    s_cselect_b32 s96, 1280, 0
    s_cselect_b32 s97, 1966080, 0
    s_sub_u32 s13, s13, s97
    v_subrev_u32 v2, s96, v2
    v_subrev_u32 v3, s96, v3
    v_add_u32 v9, 0, v1
    v_mul_u32_u24 v10, 6554, v9
    v_lshrrev_b32 v10, 16, v10
    v_mul_u32_u24 v11, 10, v10
    v_sub_u32 v11, v9, v11
    v_mul_u32_u24 v10, 1280, v10
    v_lshl_add_u32 v10, v11, 4, v10
    s_add_u32 m0, s82, 0
    s_nop 0
    buffer_load_dwordx4 v10, s[56:59], s80 offen lds
    v_add_u32 v9, 64, v1
    v_mul_u32_u24 v10, 6554, v9
    v_lshrrev_b32 v10, 16, v10
    v_mul_u32_u24 v11, 10, v10
    v_sub_u32 v11, v9, v11
    v_mul_u32_u24 v10, 1280, v10
    v_lshl_add_u32 v10, v11, 4, v10
    s_add_u32 m0, s82, 1024
    s_nop 0
    buffer_load_dwordx4 v10, s[56:59], s80 offen lds
    v_add_u32 v9, 128, v1
    v_mul_u32_u24 v10, 6554, v9
    v_lshrrev_b32 v10, 16, v10
    v_mul_u32_u24 v11, 10, v10
    v_sub_u32 v11, v9, v11
    v_mul_u32_u24 v10, 1280, v10
    v_lshl_add_u32 v10, v11, 4, v10
    s_add_u32 m0, s82, 2048
    s_nop 0
    buffer_load_dwordx4 v10, s[56:59], s80 offen lds
    v_add_u32 v9, 192, v1
    v_mul_u32_u24 v10, 6554, v9
    v_lshrrev_b32 v10, 16, v10
    v_mul_u32_u24 v11, 10, v10
    v_sub_u32 v11, v9, v11
    v_mul_u32_u24 v10, 1280, v10
    v_lshl_add_u32 v10, v11, 4, v10
    s_add_u32 m0, s82, 3072
    s_nop 0
    buffer_load_dwordx4 v10, s[56:59], s80 offen lds
    v_add_u32 v9, 256, v1
    v_mul_u32_u24 v10, 6554, v9
    v_lshrrev_b32 v10, 16, v10
    v_mul_u32_u24 v11, 10, v10
    v_sub_u32 v11, v9, v11
    v_mul_u32_u24 v10, 1280, v10
    v_lshl_add_u32 v10, v11, 4, v10
    s_add_u32 m0, s82, 4096
    s_nop 0
    buffer_load_dwordx4 v10, s[56:59], s80 offen lds
    s_load_dword s92, s[40:41], 0
    s_waitcnt vmcnt(22)
    s_barrier
    s_add_u32 m0, s14, 41088
    s_nop 0
    buffer_load_dwordx4 v2, s[44:47], s28 offen offset:0 lds
    buffer_load_dwordx4 v3, s[44:47], s29 offen offset:1024 lds
    buffer_load_dwordx4 v2, s[44:47], s30 offen offset:2048 lds
    s_add_u32 m0, s14, 44160
    s_nop 0
    buffer_load_dwordx4 v3, s[44:47], s31 offen offset:0 lds
    buffer_load_dwordx4 v2, s[44:47], s7 offen offset:1024 lds
    buffer_load_dwordx4 v3, s[44:47], s8 offen offset:2048 lds
    s_add_u32 m0, s15, 65664
    s_nop 0
    buffer_load_dwordx4 v4, s[48:51], s13 offen offset:0 lds
    buffer_load_dwordx4 v5, s[48:51], s13 offen offset:1024 lds
    s_add_u32 m0, s15, 73856
    s_nop 0
    buffer_load_dwordx4 v6, s[52:55], s13 offen offset:0 lds
    buffer_load_dwordx4 v7, s[52:55], s13 offen offset:1024 lds
    v_add_u32 v2, 0x80, v2
    v_add_u32 v3, 0x80, v3
    s_add_u32 s13, s13, 196608
    s_add_u32 s9, s9, 1
    s_cmp_eq_u32 s9, 10
    s_cselect_b32 s96, 1280, 0
    s_cselect_b32 s97, 1966080, 0
    s_sub_u32 s13, s13, s97
    v_subrev_u32 v2, s96, v2
    v_subrev_u32 v3, s96, v3
    s_waitcnt vmcnt(15)
    s_barrier
    s_waitcnt lgkmcnt(0)
    s_cmp_lg_u32 s92, 0
    s_cbranch_scc1 Ln_ok_8
    s_mov_b32 s94, 200000
    s_mov_b32 s68, s40
    s_mov_b32 s69, s41
    s_mov_b32 s70, 0x100
    s_mov_b32 s71, 0x00020000
    v_mov_b32 v249, 0
Ln_7:
    buffer_load_dword v250, v249, s[68:71], 0 offen sc1
    s_waitcnt vmcnt(0)
    v_readfirstlane_b32 s92, v250
    s_nop 0
    s_cmp_lg_u32 s92, 0
    s_cbranch_scc1 Ln_ok_8
    s_sleep 8
    s_sub_u32 s94, s94, 1
    s_cmp_lg_u32 s94, 0
    s_cbranch_scc1 Ln_7
Ln_ok_8:
    s_nop 1
    v_mov_b32 v250, s92
    v_mov_b32 v9, 160672
    ds_write_b32 v9, v250
    s_add_u32 m0, s14, 82176
    s_nop 0
    buffer_load_dwordx4 v2, s[44:47], s28 offen offset:0 lds
    buffer_load_dwordx4 v3, s[44:47], s29 offen offset:1024 lds
    buffer_load_dwordx4 v2, s[44:47], s30 offen offset:2048 lds
    s_add_u32 m0, s14, 85248
    s_nop 0
    buffer_load_dwordx4 v3, s[44:47], s31 offen offset:0 lds
    buffer_load_dwordx4 v2, s[44:47], s7 offen offset:1024 lds
    buffer_load_dwordx4 v3, s[44:47], s8 offen offset:2048 lds
    s_add_u32 m0, s15, 106752
    s_nop 0
    buffer_load_dwordx4 v4, s[48:51], s13 offen offset:0 lds
    buffer_load_dwordx4 v5, s[48:51], s13 offen offset:1024 lds
    s_add_u32 m0, s15, 114944
    s_nop 0
    buffer_load_dwordx4 v6, s[52:55], s13 offen offset:0 lds
    buffer_load_dwordx4 v7, s[52:55], s13 offen offset:1024 lds
    v_add_u32 v2, 0x80, v2
    v_add_u32 v3, 0x80, v3
    s_add_u32 s13, s13, 196608
    s_add_u32 s9, s9, 1
    s_cmp_eq_u32 s9, 10
    s_cselect_b32 s96, 1280, 0
    s_cselect_b32 s97, 1966080, 0
    s_sub_u32 s13, s13, s97
    v_subrev_u32 v2, s96, v2
    v_subrev_u32 v3, s96, v3
    v_lshrrev_b32 v9, 5, v1
    v_lshlrev_b32 v9, 4, v9
    v_bfe_u32 v10, v1, 2, 3
    v_add_u32 v9, v9, v10
    v_mul_u32_u24 v9, 160, v9
    v_and_b32 v10, 3, v1
    v_lshl_add_u32 v9, v10, 3, v9
    v_add_u32 v9, s82, v9
    s_add_u32 s60, s42, 0x600000
    s_addc_u32 s61, s43, 0
    s_mov_b32 s62, 0x1e0000
    s_mov_b32 s63, 0x00020000
    s_add_u32 s80, s81, 4096
    s_waitcnt vmcnt(20)
    ds_read_b64_tr_b16 v[32:33], v9 offset:0
    ds_read_b64_tr_b16 v[34:35], v9 offset:1280
    ds_read_b64_tr_b16 v[36:37], v9 offset:32
    ds_read_b64_tr_b16 v[38:39], v9 offset:1312
    ds_read_b64_tr_b16 v[40:41], v9 offset:64
    ds_read_b64_tr_b16 v[42:43], v9 offset:1344
    ds_read_b64_tr_b16 v[44:45], v9 offset:96
    ds_read_b64_tr_b16 v[46:47], v9 offset:1376
    ds_read_b64_tr_b16 v[48:49], v9 offset:128
    ds_read_b64_tr_b16 v[50:51], v9 offset:1408
    s_waitcnt lgkmcnt(0)
    buffer_store_dwordx4 v[32:35], v241, s[60:63], s81 offen offset:0 sc1
    buffer_store_dwordx4 v[36:39], v241, s[60:63], s81 offen offset:1024 sc1
    buffer_store_dwordx4 v[40:43], v241, s[60:63], s81 offen offset:2048 sc1
    buffer_store_dwordx4 v[44:47], v241, s[60:63], s81 offen offset:3072 sc1
    buffer_store_dwordx4 v[48:51], v241, s[60:63], s80 offen sc1
    buffer_store_dword v250, v248, s[72:75], s87 offen sc1
    s_waitcnt vmcnt(16)
    s_barrier
    s_add_u32 m0, s14, 0
    s_nop 0
    buffer_load_dwordx4 v2, s[44:47], s28 offen offset:0 lds
    buffer_load_dwordx4 v3, s[44:47], s29 offen offset:1024 lds
    buffer_load_dwordx4 v2, s[44:47], s30 offen offset:2048 lds
    s_add_u32 m0, s14, 3072
    s_nop 0
    buffer_load_dwordx4 v3, s[44:47], s31 offen offset:0 lds
    buffer_load_dwordx4 v2, s[44:47], s7 offen offset:1024 lds
    buffer_load_dwordx4 v3, s[44:47], s8 offen offset:2048 lds
    s_add_u32 m0, s15, 24576
    s_nop 0
    buffer_load_dwordx4 v4, s[48:51], s13 offen offset:0 lds
    buffer_load_dwordx4 v5, s[48:51], s13 offen offset:1024 lds
    s_add_u32 m0, s15, 32768
    s_nop 0
    buffer_load_dwordx4 v6, s[52:55], s13 offen offset:0 lds
    buffer_load_dwordx4 v7, s[52:55], s13 offen offset:1024 lds
    v_add_u32 v2, 0x80, v2
    v_add_u32 v3, 0x80, v3
    s_add_u32 s13, s13, 196608
    s_add_u32 s9, s9, 1
    s_cmp_eq_u32 s9, 10
    s_cselect_b32 s96, 1280, 0
    s_cselect_b32 s97, 1966080, 0
    s_sub_u32 s13, s13, s97
    v_subrev_u32 v2, s96, v2
    v_subrev_u32 v3, s96, v3
    s_waitcnt vmcnt(11)
    buffer_store_dword v250, v248, s[72:75], s89 offen sc1
    s_barrier
    s_add_u32 m0, s14, 41088
    s_nop 0
    buffer_load_dwordx4 v2, s[44:47], s28 offen offset:0 lds
    buffer_load_dwordx4 v3, s[44:47], s29 offen offset:1024 lds
    buffer_load_dwordx4 v2, s[44:47], s30 offen offset:2048 lds
    s_add_u32 m0, s14, 44160
    s_nop 0
    buffer_load_dwordx4 v3, s[44:47], s31 offen offset:0 lds
    buffer_load_dwordx4 v2, s[44:47], s7 offen offset:1024 lds
    buffer_load_dwordx4 v3, s[44:47], s8 offen offset:2048 lds
    s_add_u32 m0, s15, 65664
    s_nop 0
    buffer_load_dwordx4 v4, s[48:51], s13 offen offset:0 lds
    buffer_load_dwordx4 v5, s[48:51], s13 offen offset:1024 lds
    s_add_u32 m0, s15, 73856
    s_nop 0
    buffer_load_dwordx4 v6, s[52:55], s13 offen offset:0 lds
    buffer_load_dwordx4 v7, s[52:55], s13 offen offset:1024 lds
    v_add_u32 v2, 0x80, v2
    v_add_u32 v3, 0x80, v3
    s_add_u32 s13, s13, 196608
    s_add_u32 s9, s9, 1
    s_cmp_eq_u32 s9, 10
    s_cselect_b32 s96, 1280, 0
    s_cselect_b32 s97, 1966080, 0
    s_sub_u32 s13, s13, s97
    v_subrev_u32 v2, s96, v2
    v_subrev_u32 v3, s96, v3
    s_waitcnt vmcnt(11)
    s_barrier
    s_add_u32 m0, s14, 82176
    s_nop 0
    buffer_load_dwordx4 v2, s[44:47], s28 offen offset:0 lds
    buffer_load_dwordx4 v3, s[44:47], s29 offen offset:1024 lds
    buffer_load_dwordx4 v2, s[44:47], s30 offen offset:2048 lds
    s_add_u32 m0, s14, 85248
    s_nop 0
    buffer_load_dwordx4 v3, s[44:47], s31 offen offset:0 lds
    buffer_load_dwordx4 v2, s[44:47], s7 offen offset:1024 lds
    buffer_load_dwordx4 v3, s[44:47], s8 offen offset:2048 lds
    s_add_u32 m0, s15, 106752
    s_nop 0
    buffer_load_dwordx4 v4, s[48:51], s13 offen offset:0 lds
    buffer_load_dwordx4 v5, s[48:51], s13 offen offset:1024 lds
    s_add_u32 m0, s15, 114944
    s_nop 0
    buffer_load_dwordx4 v6, s[52:55], s13 offen offset:0 lds
    buffer_load_dwordx4 v7, s[52:55], s13 offen offset:1024 lds
    v_add_u32 v2, 0x80, v2
    v_add_u32 v3, 0x80, v3
    s_add_u32 s13, s13, 196608
    s_add_u32 s9, s9, 1
    s_cmp_eq_u32 s9, 10
    s_cselect_b32 s96, 1280, 0
    s_cselect_b32 s97, 1966080, 0
    s_sub_u32 s13, s13, s97
    v_subrev_u32 v2, s96, v2
    v_subrev_u32 v3, s96, v3
    s_waitcnt vmcnt(10)
    s_barrier
    s_add_u32 m0, s14, 0
    s_nop 0
    buffer_load_dwordx4 v2, s[44:47], s28 offen offset:0 lds
    buffer_load_dwordx4 v3, s[44:47], s29 offen offset:1024 lds
    buffer_load_dwordx4 v2, s[44:47], s30 offen offset:2048 lds
    s_add_u32 m0, s14, 3072
    s_nop 0
    buffer_load_dwordx4 v3, s[44:47], s31 offen offset:0 lds
    buffer_load_dwordx4 v2, s[44:47], s7 offen offset:1024 lds
    buffer_load_dwordx4 v3, s[44:47], s8 offen offset:2048 lds
    s_add_u32 m0, s15, 24576
    s_nop 0
    buffer_load_dwordx4 v4, s[48:51], s13 offen offset:0 lds
    buffer_load_dwordx4 v5, s[48:51], s13 offen offset:1024 lds
    s_add_u32 m0, s15, 32768
    s_nop 0
    buffer_load_dwordx4 v6, s[52:55], s13 offen offset:0 lds
    buffer_load_dwordx4 v7, s[52:55], s13 offen offset:1024 lds
    v_add_u32 v2, 0x80, v2
    v_add_u32 v3, 0x80, v3
    s_add_u32 s13, s13, 196608
    s_add_u32 s9, s9, 1
    s_cmp_eq_u32 s9, 10
    s_cselect_b32 s96, 1280, 0
    s_cselect_b32 s97, 1966080, 0
    s_sub_u32 s13, s13, s97
    v_subrev_u32 v2, s96, v2
    v_subrev_u32 v3, s96, v3
    s_add_u32 s48, s42, 0x600000
    s_addc_u32 s49, s43, 0
    s_mov_b32 s50, 0x1e0000
    s_mov_b32 s51, 0x00020000
    s_add_u32 s52, s42, 0xce0000
    s_addc_u32 s53, s43, 0
    s_mov_b32 s54, 0x4000
    s_mov_b32 s55, 0x00020000
    s_add_u32 s64, s42, 0xa60000
    s_addc_u32 s65, s43, 0
    s_mov_b32 s66, 0x280000
    s_mov_b32 s67, 0x00020000
    s_waitcnt vmcnt(10)
    s_barrier
    buffer_load_dword v243, v240, s[72:75], s88 offen sc1
    s_mov_b32 s56, s36
    s_mov_b32 s57, s37
    s_mov_b32 s58, 0x500
    s_mov_b32 s59, 0x00020000
    s_sub_u32 s76, s5, 20
    s_lshl_b32 s76, s76, 2
    s_add_u32 s76, s76, s10
    s_cmp_ge_u32 s76, 32
    s_cselect_b32 s86, 0x40000000, 0
    s_and_b32 s77, s4, 1
    s_lshl_b32 s77, s77, 2
    s_lshr_b32 s78, s76, 3
    s_add_u32 s77, s77, s78
    s_and_b32 s76, s76, 7
    s_lshl_b32 s78, s6, 9
    s_lshl_b32 s79, s77, 3
    s_add_u32 s78, s78, s79
    s_add_u32 s78, s78, s76
    s_mul_i32 s78, s78, 1280
    s_or_b32 s78, s78, s86
    v_lshrrev_b32 v9, 5, v1
    v_and_b32 v10, 31, v1
    v_lshlrev_b32 v11, 4, v10
    s_mov_b32 s79, 81920
    v_mul_lo_u32 v12, v9, s79
    v_add_u32 v12, v12, v11
    v_cmp_gt_u32 vcc, 16, v10
    v_mov_b32 v15, 0x80000000
    s_nop 0
    v_cndmask_b32 v13, v15, v12, vcc
    buffer_load_dwordx4 v[104:107], v11, s[56:59], 0 offen offset:0
    buffer_load_dwordx4 v[108:111], v11, s[56:59], 0 offen offset:512
    buffer_load_dwordx4 v[112:115], v11, s[56:59], 0 offen offset:1024
    buffer_load_dwordx4 v[56:59], v12, s[44:47], s78 offen
    buffer_load_dwordx4 v[60:63], v12, s[44:47], s78 offen offset:512
    buffer_load_dwordx4 v[64:67], v13, s[44:47], s78 offen offset:1024
    s_add_u32 s78, s78, 163840
    buffer_load_dwordx4 v[68:71], v12, s[44:47], s78 offen
    buffer_load_dwordx4 v[72:75], v12, s[44:47], s78 offen offset:512
    buffer_load_dwordx4 v[76:79], v13, s[44:47], s78 offen offset:1024
    s_add_u32 s78, s78, 163840
    buffer_load_dwordx4 v[80:83], v12, s[44:47], s78 offen
    buffer_load_dwordx4 v[84:87], v12, s[44:47], s78 offen offset:512
    buffer_load_dwordx4 v[88:91], v13, s[44:47], s78 offen offset:1024
    s_add_u32 s78, s78, 163840
    buffer_load_dwordx4 v[92:95], v12, s[44:47], s78 offen
    buffer_load_dwordx4 v[96:99], v12, s[44:47], s78 offen offset:512
    buffer_load_dwordx4 v[100:103], v13, s[44:47], s78 offen offset:1024
    s_add_u32 s78, s78, 163840
    s_lshl_b32 s78, s6, 3
    s_add_u32 s78, s78, s77
    s_lshl_b32 s78, s78, 3
    s_add_u32 s78, s78, s76
    s_lshl_b32 s80, s78, 6
    s_or_b32 s80, s80, s86
    v_lshlrev_b32 v14, 3, v9
    v_cmp_eq_u32 vcc, 31, v10
    s_nop 1
    v_cndmask_b32 v14, v15, v14, vcc
    s_waitcnt vmcnt(15)
    s_mov_b32 s94, 200000
Lp_9:
    v_cmp_ne_u32 vcc, s92, v243
    s_nop 1
    s_cbranch_vccz Lp_ok_10
    s_sleep 4
    buffer_load_dword v243, v240, s[72:75], s88 offen sc1
    s_waitcnt vmcnt(0)
    s_sub_u32 s94, s94, 1
    s_cmp_lg_u32 s94, 0
    s_cbranch_scc1 Lp_9
Lp_ok_10:
    s_lshl_b32 s96, s10, 2
    s_add_u32 s96, s96, 160688
    v_mov_b32 v236, s96
    v_mov_b32 v237, 1
    ds_write_b32 v236, v237
    s_waitcnt lgkmcnt(0)
    s_barrier
    s_waitcnt vmcnt(9)
    v_mov_b32 v24, 0
    v_dot2_f32_bf16 v24, v56, v104, v24
    v_dot2_f32_bf16 v24, v57, v105, v24
    v_dot2_f32_bf16 v24, v58, v106, v24
    v_dot2_f32_bf16 v24, v59, v107, v24
    v_dot2_f32_bf16 v24, v60, v108, v24
    v_dot2_f32_bf16 v24, v61, v109, v24
    v_dot2_f32_bf16 v24, v62, v110, v24
    v_dot2_f32_bf16 v24, v63, v111, v24
    v_dot2_f32_bf16 v24, v64, v112, v24
    v_dot2_f32_bf16 v24, v65, v113, v24
    v_dot2_f32_bf16 v24, v66, v114, v24
    v_dot2_f32_bf16 v24, v67, v115, v24
    s_waitcnt vmcnt(6)
    v_mov_b32 v25, 0
    v_dot2_f32_bf16 v25, v68, v104, v25
    v_dot2_f32_bf16 v25, v69, v105, v25
    v_dot2_f32_bf16 v25, v70, v106, v25
    v_dot2_f32_bf16 v25, v71, v107, v25
    v_dot2_f32_bf16 v25, v72, v108, v25
    v_dot2_f32_bf16 v25, v73, v109, v25
    v_dot2_f32_bf16 v25, v74, v110, v25
    v_dot2_f32_bf16 v25, v75, v111, v25
    v_dot2_f32_bf16 v25, v76, v112, v25
    v_dot2_f32_bf16 v25, v77, v113, v25
    v_dot2_f32_bf16 v25, v78, v114, v25
    v_dot2_f32_bf16 v25, v79, v115, v25
    s_waitcnt vmcnt(3)
    v_mov_b32 v26, 0
    v_dot2_f32_bf16 v26, v80, v104, v26
    v_dot2_f32_bf16 v26, v81, v105, v26
    v_dot2_f32_bf16 v26, v82, v106, v26
    v_dot2_f32_bf16 v26, v83, v107, v26
    v_dot2_f32_bf16 v26, v84, v108, v26
    v_dot2_f32_bf16 v26, v85, v109, v26
    v_dot2_f32_bf16 v26, v86, v110, v26
    v_dot2_f32_bf16 v26, v87, v111, v26
    v_dot2_f32_bf16 v26, v88, v112, v26
    v_dot2_f32_bf16 v26, v89, v113, v26
    v_dot2_f32_bf16 v26, v90, v114, v26
    v_dot2_f32_bf16 v26, v91, v115, v26
    s_waitcnt vmcnt(0)
    v_mov_b32 v27, 0
    v_dot2_f32_bf16 v27, v92, v104, v27
    v_dot2_f32_bf16 v27, v93, v105, v27
    v_dot2_f32_bf16 v27, v94, v106, v27
    v_dot2_f32_bf16 v27, v95, v107, v27
    v_dot2_f32_bf16 v27, v96, v108, v27
    v_dot2_f32_bf16 v27, v97, v109, v27
    v_dot2_f32_bf16 v27, v98, v110, v27
    v_dot2_f32_bf16 v27, v99, v111, v27
    v_dot2_f32_bf16 v27, v100, v112, v27
    v_dot2_f32_bf16 v27, v101, v113, v27
    v_dot2_f32_bf16 v27, v102, v114, v27
    v_dot2_f32_bf16 v27, v103, v115, v27
    s_nop 2
    v_add_f32_dpp v24, v24, v24 row_shr:1 row_mask:0xf bank_mask:0xf bound_ctrl:0
    v_add_f32_dpp v25, v25, v25 row_shr:1 row_mask:0xf bank_mask:0xf bound_ctrl:0
    v_add_f32_dpp v26, v26, v26 row_shr:1 row_mask:0xf bank_mask:0xf bound_ctrl:0
    v_add_f32_dpp v27, v27, v27 row_shr:1 row_mask:0xf bank_mask:0xf bound_ctrl:0
    v_add_f32_dpp v24, v24, v24 row_shr:2 row_mask:0xf bank_mask:0xf bound_ctrl:0
    v_add_f32_dpp v25, v25, v25 row_shr:2 row_mask:0xf bank_mask:0xf bound_ctrl:0
    v_add_f32_dpp v26, v26, v26 row_shr:2 row_mask:0xf bank_mask:0xf bound_ctrl:0
    v_add_f32_dpp v27, v27, v27 row_shr:2 row_mask:0xf bank_mask:0xf bound_ctrl:0
    v_add_f32_dpp v24, v24, v24 row_shr:4 row_mask:0xf bank_mask:0xf bound_ctrl:0
    v_add_f32_dpp v25, v25, v25 row_shr:4 row_mask:0xf bank_mask:0xf bound_ctrl:0
    v_add_f32_dpp v26, v26, v26 row_shr:4 row_mask:0xf bank_mask:0xf bound_ctrl:0
    v_add_f32_dpp v27, v27, v27 row_shr:4 row_mask:0xf bank_mask:0xf bound_ctrl:0
    v_add_f32_dpp v24, v24, v24 row_shr:8 row_mask:0xf bank_mask:0xf bound_ctrl:0
    v_add_f32_dpp v25, v25, v25 row_shr:8 row_mask:0xf bank_mask:0xf bound_ctrl:0
    v_add_f32_dpp v26, v26, v26 row_shr:8 row_mask:0xf bank_mask:0xf bound_ctrl:0
    v_add_f32_dpp v27, v27, v27 row_shr:8 row_mask:0xf bank_mask:0xf bound_ctrl:0
    v_add_f32_dpp v24, v24, v24 row_bcast:15 row_mask:0xa bank_mask:0xf
    v_add_f32_dpp v25, v25, v25 row_bcast:15 row_mask:0xa bank_mask:0xf
    v_add_f32_dpp v26, v26, v26 row_bcast:15 row_mask:0xa bank_mask:0xf
    v_add_f32_dpp v27, v27, v27 row_bcast:15 row_mask:0xa bank_mask:0xf
    v_cvt_pk_bf16_f32 v24, v24, v24
    v_and_b32 v24, 0xffff0000, v24
    v_mul_f32 v24, 0xbfb8aa3b, v24
    v_exp_f32 v24, v24
    s_nop 0
    v_add_f32 v24, 1.0, v24
    v_rcp_f32 v24, v24
    s_nop 0
    v_cvt_pk_bf16_f32 v24, v24, v24
    v_and_b32 v29, 0xffff0000, v24
    v_mov_b32 v28, v250
    buffer_store_dwordx2 v[28:29], v14, s[52:55], s80 offen offset:0 sc1
    v_cvt_pk_bf16_f32 v25, v25, v25
    v_and_b32 v25, 0xffff0000, v25
    v_mul_f32 v25, 0xbfb8aa3b, v25
    v_exp_f32 v25, v25
    s_nop 0
    v_add_f32 v25, 1.0, v25
    v_rcp_f32 v25, v25
    s_nop 0
    v_cvt_pk_bf16_f32 v25, v25, v25
    v_and_b32 v31, 0xffff0000, v25
    v_mov_b32 v30, v250
    buffer_store_dwordx2 v[30:31], v14, s[52:55], s80 offen offset:16 sc1
    v_cvt_pk_bf16_f32 v26, v26, v26
    v_and_b32 v26, 0xffff0000, v26
    v_mul_f32 v26, 0xbfb8aa3b, v26
    v_exp_f32 v26, v26
    s_nop 0
    v_add_f32 v26, 1.0, v26
    v_rcp_f32 v26, v26
    s_nop 0
    v_cvt_pk_bf16_f32 v26, v26, v26
    v_and_b32 v33, 0xffff0000, v26
    v_mov_b32 v32, v250
    buffer_store_dwordx2 v[32:33], v14, s[52:55], s80 offen offset:32 sc1
    v_cvt_pk_bf16_f32 v27, v27, v27
    v_and_b32 v27, 0xffff0000, v27
    v_mul_f32 v27, 0xbfb8aa3b, v27
    v_exp_f32 v27, v27
    s_nop 0
    v_add_f32 v27, 1.0, v27
    v_rcp_f32 v27, v27
    s_nop 0
    v_cvt_pk_bf16_f32 v27, v27, v27
    v_and_b32 v35, 0xffff0000, v27
    v_mov_b32 v34, v250
    buffer_store_dwordx2 v[34:35], v14, s[52:55], s80 offen offset:48 sc1
    s_lshr_b32 s97, s84, 3
    s_lshl_b32 s97, s97, 9
    s_and_b32 s96, s84, 7
    s_lshl_b32 s96, s96, 3
    s_add_u32 s97, s97, s96
    s_lshl_b32 s96, s10, 1
    s_add_u32 s97, s97, s96
    s_mul_i32 s97, s97, 1280
    s_mul_i32 s96, s85, 160
    s_add_u32 s97, s97, s96
    v_add_u32 v2, 0, v1
    v_mul_u32_u24 v3, 6554, v2
    v_lshrrev_b32 v3, 16, v3
    v_mul_u32_u24 v4, 10, v3
    v_sub_u32 v4, v2, v4
    v_and_b32 v5, 7, v3
    v_lshlrev_b32 v5, 6, v5
    v_lshrrev_b32 v3, 3, v3
    v_add_u32 v3, v3, v5
    v_mul_u32_u24 v3, 1280, v3
    v_lshl_add_u32 v3, v4, 4, v3
    s_add_u32 m0, s83, 0
    s_nop 0
    buffer_load_dwordx4 v3, s[44:47], s97 offen lds
    v_add_u32 v2, 64, v1
    v_mul_u32_u24 v3, 6554, v2
    v_lshrrev_b32 v3, 16, v3
    v_mul_u32_u24 v4, 10, v3
    v_sub_u32 v4, v2, v4
    v_and_b32 v5, 7, v3
    v_lshlrev_b32 v5, 6, v5
    v_lshrrev_b32 v3, 3, v3
    v_add_u32 v3, v3, v5
    v_mul_u32_u24 v3, 1280, v3
    v_lshl_add_u32 v3, v4, 4, v3
    s_add_u32 m0, s83, 1024
    s_nop 0
    buffer_load_dwordx4 v3, s[44:47], s97 offen lds
    v_add_u32 v2, 128, v1
    v_mul_u32_u24 v3, 6554, v2
    v_lshrrev_b32 v3, 16, v3
    v_mul_u32_u24 v4, 10, v3
    v_sub_u32 v4, v2, v4
    v_and_b32 v5, 7, v3
    v_lshlrev_b32 v5, 6, v5
    v_lshrrev_b32 v3, 3, v3
    v_add_u32 v3, v3, v5
    v_mul_u32_u24 v3, 1280, v3
    v_lshl_add_u32 v3, v4, 4, v3
    v_cmp_gt_u32 vcc, 32, v1
    v_mov_b32 v4, 0x80000000
    s_nop 0
    v_cndmask_b32 v3, v4, v3, vcc
    s_add_u32 m0, s83, 2048
    s_nop 0
    buffer_load_dwordx4 v3, s[44:47], s97 offen lds
    s_lshl_b32 s89, s85, 8
    s_add_u32 s89, s89, 17408
    v_min_u32 v247, 47, v1
    v_lshlrev_b32 v247, 2, v247
    buffer_load_dword v239, v247, s[72:75], s89 offen sc1
    s_setprio 0
    s_waitcnt vmcnt(0)
    s_mov_b32 s94, 200000
Lp_11:
    v_cmp_ne_u32 vcc, s92, v239
    s_nop 1
    s_cbranch_vccz Lp_ok_12
    s_sleep 4
    buffer_load_dword v239, v247, s[72:75], s89 offen sc1
    s_waitcnt vmcnt(0)
    s_sub_u32 s94, s94, 1
    s_cmp_lg_u32 s94, 0
    s_cbranch_scc1 Lp_11
Lp_ok_12:
    s_branch Lfetch
LLodd:
    v_lshrrev_b32 v9, 3, v1
    v_and_b32 v10, 7, v1
    v_lshrrev_b32 v11, 1, v9
    v_xor_b32 v10, v10, v11
    v_lshlrev_b32 v10, 4, v10
    s_mov_b32 s12, 81920
    v_mul_lo_u32 v9, v9, s12
    v_add_u32 v2, v9, v10
    v_xor_b32 v10, 64, v10
    v_add_u32 v3, v9, v10
    v_add_u32 v3, 256, v3
    v_add_u32 v4, 512, v2
    v_add_u32 v5, 512, v3
    v_add_u32 v9, 0, v1
    v_mul_u32_u24 v10, 5462, v9
    v_lshrrev_b32 v10, 16, v10
    v_mul_u32_u24 v11, 12, v10
    v_sub_u32 v11, v9, v11
    v_mul_u32_u24 v10, 3072, v10
    v_lshl_add_u32 v10, v11, 4, v10
    v_subrev_u32 v6, 0, v10
    v_add_u32 v9, 64, v1
    v_mul_u32_u24 v10, 5462, v9
    v_lshrrev_b32 v10, 16, v10
    v_mul_u32_u24 v11, 12, v10
    v_sub_u32 v11, v9, v11
    v_mul_u32_u24 v10, 3072, v10
    v_lshl_add_u32 v10, v11, 4, v10
    v_subrev_u32 v7, 1024, v10
    v_add_u32 v9, 128, v1
    v_mul_u32_u24 v10, 5462, v9
    v_lshrrev_b32 v10, 16, v10
    v_mul_u32_u24 v11, 12, v10
    v_sub_u32 v11, v9, v11
    v_mul_u32_u24 v10, 3072, v10
    v_lshl_add_u32 v10, v11, 4, v10
    v_subrev_u32 v8, 2048, v10
    s_mov_b32 s12, 1584
    s_lshl_b32 s13, s10, 2
    s_add_u32 s12, s12, s13
    s_mul_i32 s12, s12, 1280
    s_mul_i32 s13, s10, 49152
    s_mul_i32 s14, s8, 192
    s_add_u32 s13, s13, s14
    s_lshl_b32 s14, s10, 12
    s_mul_i32 s15, s10, 3072
    s_and_b32 s9, s4, 1
    s_mul_i32 s9, s9, 10
    s_mul_i32 s96, s6, 5
    s_add_u32 s9, s9, s96
    s_lshr_b32 s9, s9, 1
    s_cmp_ge_u32 s9, 10
    s_cselect_b32 s96, 10, 0
    s_sub_u32 s9, s9, s96
    s_lshl_b32 s96, s9, 7
    s_add_u32 s12, s12, s96
    s_mul_i32 s96, s9, 196608
    s_add_u32 s13, s13, s96
    s_mov_b32 s46, 0x280000
    s_mov_b32 s47, 0x00020000
    s_mov_b32 s50, 0x1e0000
    s_mov_b32 s51, 0x00020000
    s_mov_b32 s54, 0x1e0000
    s_mov_b32 s55, 0x00020000
    s_waitcnt lgkmcnt(0)
    s_add_u32 m0, s14, 0
    s_nop 0
    buffer_load_dwordx4 v2, s[44:47], s12 offen offset:0 lds
    buffer_load_dwordx4 v3, s[44:47], s12 offen offset:1024 lds
    buffer_load_dwordx4 v4, s[44:47], s12 offen offset:2048 lds
    buffer_load_dwordx4 v5, s[44:47], s12 offen offset:3072 lds
    s_add_u32 m0, s15, 16384
    s_nop 0
    buffer_load_dwordx4 v6, s[48:51], s13 offen offset:0 lds
    buffer_load_dwordx4 v7, s[48:51], s13 offen offset:1024 lds
    buffer_load_dwordx4 v8, s[48:51], s13 offen offset:2048 lds
    s_add_u32 m0, s15, 28704
    s_nop 0
    buffer_load_dwordx4 v6, s[52:55], s13 offen offset:0 lds
    buffer_load_dwordx4 v7, s[52:55], s13 offen offset:1024 lds
    buffer_load_dwordx4 v8, s[52:55], s13 offen offset:2048 lds
    s_add_u32 s12, s12, 128
    s_add_u32 s13, s13, 196608
    s_add_u32 s9, s9, 1
    s_cmp_eq_u32 s9, 10
    s_cselect_b32 s96, 1280, 0
    s_cselect_b32 s97, 1966080, 0
    s_sub_u32 s13, s13, s97
    s_sub_u32 s12, s12, s96
    s_add_u32 s72, s42, 0xce4000
    s_addc_u32 s73, s43, 0
    s_mov_b32 s74, 0x4e00
    s_mov_b32 s75, 0x00020000
    v_cmp_eq_u32 vcc, 0, v1
    v_mov_b32 v248, 0x80000000
    s_nop 0
    v_cndmask_b32 v248, v248, 0, vcc
    s_add_u32 m0, s14, 41088
    s_nop 0
    buffer_load_dwordx4 v2, s[44:47], s12 offen offset:0 lds
    buffer_load_dwordx4 v3, s[44:47], s12 offen offset:1024 lds
    buffer_load_dwordx4 v4, s[44:47], s12 offen offset:2048 lds
    buffer_load_dwordx4 v5, s[44:47], s12 offen offset:3072 lds
    s_add_u32 m0, s15, 57472
    s_nop 0
    buffer_load_dwordx4 v6, s[48:51], s13 offen offset:0 lds
    buffer_load_dwordx4 v7, s[48:51], s13 offen offset:1024 lds
    buffer_load_dwordx4 v8, s[48:51], s13 offen offset:2048 lds
    s_add_u32 m0, s15, 69792
    s_nop 0
    buffer_load_dwordx4 v6, s[52:55], s13 offen offset:0 lds
    buffer_load_dwordx4 v7, s[52:55], s13 offen offset:1024 lds
    buffer_load_dwordx4 v8, s[52:55], s13 offen offset:2048 lds
    s_add_u32 s12, s12, 128
    s_add_u32 s13, s13, 196608
    s_add_u32 s9, s9, 1
    s_cmp_eq_u32 s9, 10
    s_cselect_b32 s96, 1280, 0
    s_cselect_b32 s97, 1966080, 0
    s_sub_u32 s13, s13, s97
    s_sub_u32 s12, s12, s96
    s_lshl_b32 s84, s4, 2
    s_and_b32 s85, s5, 3
    s_add_u32 s84, s84, s85
    s_lshr_b32 s85, s5, 2
    s_mul_i32 s82, s10, 5120
    s_add_u32 s82, s82, 123264
    s_mul_i32 s83, s10, 4224
    s_add_u32 s83, s83, 143744
    s_mul_i32 s88, s85, 48
    s_mul_i32 s96, s10, 12
    s_add_u32 s88, s88, s96
    s_mul_i32 s0, s88, 5120
    s_mov_b32 s95, 0
    s_lshl_b32 s88, s88, 2
    s_add_u32 s88, s88, 14848
    s_mul_i32 s1, s10, 10240
    v_lshlrev_b32 v241, 4, v1
    v_add_u32 v245, 4096, v241
    s_mov_b32 s56, s34
    s_mov_b32 s57, s35
    s_mov_b32 s58, 0x1e0000
    s_mov_b32 s59, 0x00020000
    s_mov_b32 s68, s36
    s_mov_b32 s69, s37
    s_mov_b32 s70, 0x500
    s_mov_b32 s71, 0x00020000
    s_mul_i32 s78, s4, 12
    s_add_u32 s78, s78, s5
    s_sub_u32 s78, s78, 20
    s_lshl_b32 s78, s78, 2
    s_add_u32 s78, s78, s10
    s_lshr_b32 s79, s78, 3
    s_and_b32 s78, s78, 7
    s_mul_i32 s89, s78, 48
    s_add_u32 s89, s89, s79
    s_lshl_b32 s89, s89, 2
    s_add_u32 s89, s89, 14848
    s_mul_i32 s80, s79, 40960
    s_mul_i32 s77, s78, 160
    s_add_u32 s80, s80, s77
    s_mul_i32 s81, s78, 245760
    s_mul_i32 s77, s79, 5120
    s_add_u32 s81, s81, s77
    v_min_u32 v240, 11, v1
    v_lshlrev_b32 v240, 2, v240
    s_waitcnt vmcnt(10)
    s_barrier
    s_add_u32 m0, s14, 82176
    s_nop 0
    buffer_load_dwordx4 v2, s[44:47], s12 offen offset:0 lds
    buffer_load_dwordx4 v3, s[44:47], s12 offen offset:1024 lds
    buffer_load_dwordx4 v4, s[44:47], s12 offen offset:2048 lds
    buffer_load_dwordx4 v5, s[44:47], s12 offen offset:3072 lds
    s_add_u32 m0, s15, 98560
    s_nop 0
    buffer_load_dwordx4 v6, s[48:51], s13 offen offset:0 lds
    buffer_load_dwordx4 v7, s[48:51], s13 offen offset:1024 lds
    buffer_load_dwordx4 v8, s[48:51], s13 offen offset:2048 lds
    s_add_u32 m0, s15, 110880
    s_nop 0
    buffer_load_dwordx4 v6, s[52:55], s13 offen offset:0 lds
    buffer_load_dwordx4 v7, s[52:55], s13 offen offset:1024 lds
    buffer_load_dwordx4 v8, s[52:55], s13 offen offset:2048 lds
    s_add_u32 s12, s12, 128
    s_add_u32 s13, s13, 196608
    s_add_u32 s9, s9, 1
    s_cmp_eq_u32 s9, 10
    s_cselect_b32 s96, 1280, 0
    s_cselect_b32 s97, 1966080, 0
    s_sub_u32 s13, s13, s97
    s_sub_u32 s12, s12, s96
    s_add_u32 s64, s42, 0xa60000
    s_addc_u32 s65, s43, 0
    s_mov_b32 s66, 0x280000
    s_mov_b32 s67, 0x00020000
    s_sub_u32 s76, s5, 20
    s_lshl_b32 s76, s76, 2
    s_add_u32 s76, s76, s10
    s_lshl_b32 s77, s4, 6
    s_add_u32 s87, s76, s77
    s_lshl_b32 s87, s87, 2
    s_add_u32 s87, s87, 17408
    s_mul_i32 s76, s76, 7
    v_mov_b32 v232, -1
    v_mov_b32 v233, -1
    v_mov_b32 v234, -1
    v_mov_b32 v235, -1
    s_add_u32 s77, s76, 0
    s_cmp_ge_u32 s77, 320
    s_cselect_b32 s78, 0x40000000, 0
    s_lshl_b32 s77, s77, 10
    s_mul_i32 s79, s4, 327680
    s_add_u32 s77, s77, s79
    s_or_b32 s77, s77, s78
    buffer_store_dwordx4 v[232:235], v241, s[64:67], s77 offen sc1
    s_add_u32 s77, s76, 1
    s_cmp_ge_u32 s77, 320
    s_cselect_b32 s78, 0x40000000, 0
    s_lshl_b32 s77, s77, 10
    s_mul_i32 s79, s4, 327680
    s_add_u32 s77, s77, s79
    s_or_b32 s77, s77, s78
    buffer_store_dwordx4 v[232:235], v241, s[64:67], s77 offen sc1
    s_add_u32 s77, s76, 2
    s_cmp_ge_u32 s77, 320
    s_cselect_b32 s78, 0x40000000, 0
    s_lshl_b32 s77, s77, 10
    s_mul_i32 s79, s4, 327680
    s_add_u32 s77, s77, s79
    s_or_b32 s77, s77, s78
    buffer_store_dwordx4 v[232:235], v241, s[64:67], s77 offen sc1
    s_add_u32 s77, s76, 3
    s_cmp_ge_u32 s77, 320
    s_cselect_b32 s78, 0x40000000, 0
    s_lshl_b32 s77, s77, 10
    s_mul_i32 s79, s4, 327680
    s_add_u32 s77, s77, s79
    s_or_b32 s77, s77, s78
    buffer_store_dwordx4 v[232:235], v241, s[64:67], s77 offen sc1
    s_add_u32 s77, s76, 4
    s_cmp_ge_u32 s77, 320
    s_cselect_b32 s78, 0x40000000, 0
    s_lshl_b32 s77, s77, 10
    s_mul_i32 s79, s4, 327680
    s_add_u32 s77, s77, s79
    s_or_b32 s77, s77, s78
    buffer_store_dwordx4 v[232:235], v241, s[64:67], s77 offen sc1
    s_add_u32 s77, s76, 5
    s_cmp_ge_u32 s77, 320
    s_cselect_b32 s78, 0x40000000, 0
    s_lshl_b32 s77, s77, 10
    s_mul_i32 s79, s4, 327680
    s_add_u32 s77, s77, s79
    s_or_b32 s77, s77, s78
    buffer_store_dwordx4 v[232:235], v241, s[64:67], s77 offen sc1
    s_add_u32 s77, s76, 6
    s_cmp_ge_u32 s77, 320
    s_cselect_b32 s78, 0x40000000, 0
    s_lshl_b32 s77, s77, 10
    s_mul_i32 s79, s4, 327680
    s_add_u32 s77, s77, s79
    s_or_b32 s77, s77, s78
    buffer_store_dwordx4 v[232:235], v241, s[64:67], s77 offen sc1
    s_waitcnt vmcnt(17)
    s_barrier
    s_add_u32 m0, s14, 0
    s_nop 0
    buffer_load_dwordx4 v2, s[44:47], s12 offen offset:0 lds
    buffer_load_dwordx4 v3, s[44:47], s12 offen offset:1024 lds
    buffer_load_dwordx4 v4, s[44:47], s12 offen offset:2048 lds
    buffer_load_dwordx4 v5, s[44:47], s12 offen offset:3072 lds
    s_add_u32 m0, s15, 16384
    s_nop 0
    buffer_load_dwordx4 v6, s[48:51], s13 offen offset:0 lds
    buffer_load_dwordx4 v7, s[48:51], s13 offen offset:1024 lds
    buffer_load_dwordx4 v8, s[48:51], s13 offen offset:2048 lds
    s_add_u32 m0, s15, 28704
    s_nop 0
    buffer_load_dwordx4 v6, s[52:55], s13 offen offset:0 lds
    buffer_load_dwordx4 v7, s[52:55], s13 offen offset:1024 lds
    buffer_load_dwordx4 v8, s[52:55], s13 offen offset:2048 lds
    s_add_u32 s12, s12, 128
    s_add_u32 s13, s13, 196608
    s_add_u32 s9, s9, 1
    s_cmp_eq_u32 s9, 10
    s_cselect_b32 s96, 1280, 0
    s_cselect_b32 s97, 1966080, 0
    s_sub_u32 s13, s13, s97
    s_sub_u32 s12, s12, s96
    v_add_u32 v9, 0, v1
    v_mul_u32_u24 v10, 6554, v9
    v_lshrrev_b32 v10, 16, v10
    v_mul_u32_u24 v11, 10, v10
    v_sub_u32 v11, v9, v11
    v_mul_u32_u24 v10, 1280, v10
    v_lshl_add_u32 v10, v11, 4, v10
    s_add_u32 m0, s82, 0
    s_nop 0
    buffer_load_dwordx4 v10, s[56:59], s80 offen lds
    v_add_u32 v9, 64, v1
    v_mul_u32_u24 v10, 6554, v9
    v_lshrrev_b32 v10, 16, v10
    v_mul_u32_u24 v11, 10, v10
    v_sub_u32 v11, v9, v11
    v_mul_u32_u24 v10, 1280, v10
    v_lshl_add_u32 v10, v11, 4, v10
    s_add_u32 m0, s82, 1024
    s_nop 0
    buffer_load_dwordx4 v10, s[56:59], s80 offen lds
    v_add_u32 v9, 128, v1
    v_mul_u32_u24 v10, 6554, v9
    v_lshrrev_b32 v10, 16, v10
    v_mul_u32_u24 v11, 10, v10
    v_sub_u32 v11, v9, v11
    v_mul_u32_u24 v10, 1280, v10
    v_lshl_add_u32 v10, v11, 4, v10
    s_add_u32 m0, s82, 2048
    s_nop 0
    buffer_load_dwordx4 v10, s[56:59], s80 offen lds
    v_add_u32 v9, 192, v1
    v_mul_u32_u24 v10, 6554, v9
    v_lshrrev_b32 v10, 16, v10
    v_mul_u32_u24 v11, 10, v10
    v_sub_u32 v11, v9, v11
    v_mul_u32_u24 v10, 1280, v10
    v_lshl_add_u32 v10, v11, 4, v10
    s_add_u32 m0, s82, 3072
    s_nop 0
    buffer_load_dwordx4 v10, s[56:59], s80 offen lds
    v_add_u32 v9, 256, v1
    v_mul_u32_u24 v10, 6554, v9
    v_lshrrev_b32 v10, 16, v10
    v_mul_u32_u24 v11, 10, v10
    v_sub_u32 v11, v9, v11
    v_mul_u32_u24 v10, 1280, v10
    v_lshl_add_u32 v10, v11, 4, v10
    s_add_u32 m0, s82, 4096
    s_nop 0
    buffer_load_dwordx4 v10, s[56:59], s80 offen lds
    s_load_dword s92, s[40:41], 0
    s_waitcnt vmcnt(22)
    s_barrier
    s_add_u32 m0, s14, 41088
    s_nop 0
    buffer_load_dwordx4 v2, s[44:47], s12 offen offset:0 lds
    buffer_load_dwordx4 v3, s[44:47], s12 offen offset:1024 lds
    buffer_load_dwordx4 v4, s[44:47], s12 offen offset:2048 lds
    buffer_load_dwordx4 v5, s[44:47], s12 offen offset:3072 lds
    s_add_u32 m0, s15, 57472
    s_nop 0
    buffer_load_dwordx4 v6, s[48:51], s13 offen offset:0 lds
    buffer_load_dwordx4 v7, s[48:51], s13 offen offset:1024 lds
    buffer_load_dwordx4 v8, s[48:51], s13 offen offset:2048 lds
    s_add_u32 m0, s15, 69792
    s_nop 0
    buffer_load_dwordx4 v6, s[52:55], s13 offen offset:0 lds
    buffer_load_dwordx4 v7, s[52:55], s13 offen offset:1024 lds
    buffer_load_dwordx4 v8, s[52:55], s13 offen offset:2048 lds
    s_add_u32 s12, s12, 128
    s_add_u32 s13, s13, 196608
    s_add_u32 s9, s9, 1
    s_cmp_eq_u32 s9, 10
    s_cselect_b32 s96, 1280, 0
    s_cselect_b32 s97, 1966080, 0
    s_sub_u32 s13, s13, s97
    s_sub_u32 s12, s12, s96
    s_waitcnt vmcnt(15)
    s_barrier
    s_waitcnt lgkmcnt(0)
    s_cmp_lg_u32 s92, 0
    s_cbranch_scc1 Ln_ok_14
    s_mov_b32 s94, 200000
    s_mov_b32 s68, s40
    s_mov_b32 s69, s41
    s_mov_b32 s70, 0x100
    s_mov_b32 s71, 0x00020000
    v_mov_b32 v249, 0
Ln_13:
    buffer_load_dword v250, v249, s[68:71], 0 offen sc1
    s_waitcnt vmcnt(0)
    v_readfirstlane_b32 s92, v250
    s_nop 0
    s_cmp_lg_u32 s92, 0
    s_cbranch_scc1 Ln_ok_14
    s_sleep 8
    s_sub_u32 s94, s94, 1
    s_cmp_lg_u32 s94, 0
    s_cbranch_scc1 Ln_13
Ln_ok_14:
    s_nop 1
    v_mov_b32 v250, s92
    v_mov_b32 v9, 160672
    ds_write_b32 v9, v250
    s_add_u32 m0, s14, 82176
    s_nop 0
    buffer_load_dwordx4 v2, s[44:47], s12 offen offset:0 lds
    buffer_load_dwordx4 v3, s[44:47], s12 offen offset:1024 lds
    buffer_load_dwordx4 v4, s[44:47], s12 offen offset:2048 lds
    buffer_load_dwordx4 v5, s[44:47], s12 offen offset:3072 lds
    s_add_u32 m0, s15, 98560
    s_nop 0
    buffer_load_dwordx4 v6, s[48:51], s13 offen offset:0 lds
    buffer_load_dwordx4 v7, s[48:51], s13 offen offset:1024 lds
    buffer_load_dwordx4 v8, s[48:51], s13 offen offset:2048 lds
    s_add_u32 m0, s15, 110880
    s_nop 0
    buffer_load_dwordx4 v6, s[52:55], s13 offen offset:0 lds
    buffer_load_dwordx4 v7, s[52:55], s13 offen offset:1024 lds
    buffer_load_dwordx4 v8, s[52:55], s13 offen offset:2048 lds
    s_add_u32 s12, s12, 128
    s_add_u32 s13, s13, 196608
    s_add_u32 s9, s9, 1
    s_cmp_eq_u32 s9, 10
    s_cselect_b32 s96, 1280, 0
    s_cselect_b32 s97, 1966080, 0
    s_sub_u32 s13, s13, s97
    s_sub_u32 s12, s12, s96
    v_lshrrev_b32 v9, 5, v1
    v_lshlrev_b32 v9, 4, v9
    v_bfe_u32 v10, v1, 2, 3
    v_add_u32 v9, v9, v10
    v_mul_u32_u24 v9, 160, v9
    v_and_b32 v10, 3, v1
    v_lshl_add_u32 v9, v10, 3, v9
    v_add_u32 v9, s82, v9
    s_add_u32 s60, s42, 0x600000
    s_addc_u32 s61, s43, 0
    s_mov_b32 s62, 0x1e0000
    s_mov_b32 s63, 0x00020000
    s_add_u32 s80, s81, 4096
    s_waitcnt vmcnt(20)
    ds_read_b64_tr_b16 v[32:33], v9 offset:0
    ds_read_b64_tr_b16 v[34:35], v9 offset:1280
    ds_read_b64_tr_b16 v[36:37], v9 offset:32
    ds_read_b64_tr_b16 v[38:39], v9 offset:1312
    ds_read_b64_tr_b16 v[40:41], v9 offset:64
    ds_read_b64_tr_b16 v[42:43], v9 offset:1344
    ds_read_b64_tr_b16 v[44:45], v9 offset:96
    ds_read_b64_tr_b16 v[46:47], v9 offset:1376
    ds_read_b64_tr_b16 v[48:49], v9 offset:128
    ds_read_b64_tr_b16 v[50:51], v9 offset:1408
    s_waitcnt lgkmcnt(0)
    buffer_store_dwordx4 v[32:35], v241, s[60:63], s81 offen offset:0 sc1
    buffer_store_dwordx4 v[36:39], v241, s[60:63], s81 offen offset:1024 sc1
    buffer_store_dwordx4 v[40:43], v241, s[60:63], s81 offen offset:2048 sc1
    buffer_store_dwordx4 v[44:47], v241, s[60:63], s81 offen offset:3072 sc1
    buffer_store_dwordx4 v[48:51], v241, s[60:63], s80 offen sc1
    buffer_store_dword v250, v248, s[72:75], s87 offen sc1
    s_waitcnt vmcnt(16)
    s_barrier
    s_add_u32 m0, s14, 0
    s_nop 0
    buffer_load_dwordx4 v2, s[44:47], s12 offen offset:0 lds
    buffer_load_dwordx4 v3, s[44:47], s12 offen offset:1024 lds
    buffer_load_dwordx4 v4, s[44:47], s12 offen offset:2048 lds
    buffer_load_dwordx4 v5, s[44:47], s12 offen offset:3072 lds
    s_add_u32 m0, s15, 16384
    s_nop 0
    buffer_load_dwordx4 v6, s[48:51], s13 offen offset:0 lds
    buffer_load_dwordx4 v7, s[48:51], s13 offen offset:1024 lds
    buffer_load_dwordx4 v8, s[48:51], s13 offen offset:2048 lds
    s_add_u32 m0, s15, 28704
    s_nop 0
    buffer_load_dwordx4 v6, s[52:55], s13 offen offset:0 lds
    buffer_load_dwordx4 v7, s[52:55], s13 offen offset:1024 lds
    buffer_load_dwordx4 v8, s[52:55], s13 offen offset:2048 lds
    s_add_u32 s12, s12, 128
    s_add_u32 s13, s13, 196608
    s_add_u32 s9, s9, 1
    s_cmp_eq_u32 s9, 10
    s_cselect_b32 s96, 1280, 0
    s_cselect_b32 s97, 1966080, 0
    s_sub_u32 s13, s13, s97
    s_sub_u32 s12, s12, s96
    s_waitcnt vmcnt(11)
    buffer_store_dword v250, v248, s[72:75], s89 offen sc1
    s_barrier
    s_add_u32 m0, s14, 41088
    s_nop 0
    buffer_load_dwordx4 v2, s[44:47], s12 offen offset:0 lds
    buffer_load_dwordx4 v3, s[44:47], s12 offen offset:1024 lds
    buffer_load_dwordx4 v4, s[44:47], s12 offen offset:2048 lds
    buffer_load_dwordx4 v5, s[44:47], s12 offen offset:3072 lds
    s_add_u32 m0, s15, 57472
    s_nop 0
    buffer_load_dwordx4 v6, s[48:51], s13 offen offset:0 lds
    buffer_load_dwordx4 v7, s[48:51], s13 offen offset:1024 lds
    buffer_load_dwordx4 v8, s[48:51], s13 offen offset:2048 lds
    s_add_u32 m0, s15, 69792
    s_nop 0
    buffer_load_dwordx4 v6, s[52:55], s13 offen offset:0 lds
    buffer_load_dwordx4 v7, s[52:55], s13 offen offset:1024 lds
    buffer_load_dwordx4 v8, s[52:55], s13 offen offset:2048 lds
    s_add_u32 s12, s12, 128
    s_add_u32 s13, s13, 196608
    s_add_u32 s9, s9, 1
    s_cmp_eq_u32 s9, 10
    s_cselect_b32 s96, 1280, 0
    s_cselect_b32 s97, 1966080, 0
    s_sub_u32 s13, s13, s97
    s_sub_u32 s12, s12, s96
    s_waitcnt vmcnt(11)
    s_barrier
    s_add_u32 m0, s14, 82176
    s_nop 0
    buffer_load_dwordx4 v2, s[44:47], s12 offen offset:0 lds
    buffer_load_dwordx4 v3, s[44:47], s12 offen offset:1024 lds
    buffer_load_dwordx4 v4, s[44:47], s12 offen offset:2048 lds
    buffer_load_dwordx4 v5, s[44:47], s12 offen offset:3072 lds
    s_add_u32 m0, s15, 98560
    s_nop 0
    buffer_load_dwordx4 v6, s[48:51], s13 offen offset:0 lds
    buffer_load_dwordx4 v7, s[48:51], s13 offen offset:1024 lds
    buffer_load_dwordx4 v8, s[48:51], s13 offen offset:2048 lds
    s_add_u32 m0, s15, 110880
    s_nop 0
    buffer_load_dwordx4 v6, s[52:55], s13 offen offset:0 lds
    buffer_load_dwordx4 v7, s[52:55], s13 offen offset:1024 lds
    buffer_load_dwordx4 v8, s[52:55], s13 offen offset:2048 lds
    s_add_u32 s12, s12, 128
    s_add_u32 s13, s13, 196608
    s_add_u32 s9, s9, 1
    s_cmp_eq_u32 s9, 10
    s_cselect_b32 s96, 1280, 0
    s_cselect_b32 s97, 1966080, 0
    s_sub_u32 s13, s13, s97
    s_sub_u32 s12, s12, s96
    s_waitcnt vmcnt(10)
    s_barrier
    s_add_u32 m0, s14, 0
    s_nop 0
    buffer_load_dwordx4 v2, s[44:47], s12 offen offset:0 lds
    buffer_load_dwordx4 v3, s[44:47], s12 offen offset:1024 lds
    buffer_load_dwordx4 v4, s[44:47], s12 offen offset:2048 lds
    buffer_load_dwordx4 v5, s[44:47], s12 offen offset:3072 lds
    s_add_u32 m0, s15, 16384
    s_nop 0
    buffer_load_dwordx4 v6, s[48:51], s13 offen offset:0 lds
    buffer_load_dwordx4 v7, s[48:51], s13 offen offset:1024 lds
    buffer_load_dwordx4 v8, s[48:51], s13 offen offset:2048 lds
    s_add_u32 m0, s15, 28704
    s_nop 0
    buffer_load_dwordx4 v6, s[52:55], s13 offen offset:0 lds
    buffer_load_dwordx4 v7, s[52:55], s13 offen offset:1024 lds
    buffer_load_dwordx4 v8, s[52:55], s13 offen offset:2048 lds
    s_add_u32 s12, s12, 128
    s_add_u32 s13, s13, 196608
    s_add_u32 s9, s9, 1
    s_cmp_eq_u32 s9, 10
    s_cselect_b32 s96, 1280, 0
    s_cselect_b32 s97, 1966080, 0
    s_sub_u32 s13, s13, s97
    s_sub_u32 s12, s12, s96
    s_add_u32 s48, s42, 0x600000
    s_addc_u32 s49, s43, 0
    s_mov_b32 s50, 0x1e0000
    s_mov_b32 s51, 0x00020000
    s_add_u32 s52, s42, 0xce0000
    s_addc_u32 s53, s43, 0
    s_mov_b32 s54, 0x4000
    s_mov_b32 s55, 0x00020000
    s_add_u32 s64, s42, 0xa60000
    s_addc_u32 s65, s43, 0
    s_mov_b32 s66, 0x280000
    s_mov_b32 s67, 0x00020000
    s_waitcnt vmcnt(10)
    s_barrier
    buffer_load_dword v243, v240, s[72:75], s88 offen sc1
    s_mov_b32 s56, s36
    s_mov_b32 s57, s37
    s_mov_b32 s58, 0x500
    s_mov_b32 s59, 0x00020000
    s_sub_u32 s76, s5, 20
    s_lshl_b32 s76, s76, 2
    s_add_u32 s76, s76, s10
    s_cmp_ge_u32 s76, 32
    s_cselect_b32 s86, 0x40000000, 0
    s_and_b32 s77, s4, 1
    s_lshl_b32 s77, s77, 2
    s_lshr_b32 s78, s76, 3
    s_add_u32 s77, s77, s78
    s_and_b32 s76, s76, 7
    s_lshl_b32 s78, s6, 9
    s_lshl_b32 s79, s77, 3
    s_add_u32 s78, s78, s79
    s_add_u32 s78, s78, s76
    s_mul_i32 s78, s78, 1280
    s_or_b32 s78, s78, s86
    v_lshrrev_b32 v9, 5, v1
    v_and_b32 v10, 31, v1
    v_lshlrev_b32 v11, 4, v10
    s_mov_b32 s79, 81920
    v_mul_lo_u32 v12, v9, s79
    v_add_u32 v12, v12, v11
    v_cmp_gt_u32 vcc, 16, v10
    v_mov_b32 v15, 0x80000000
    s_nop 0
    v_cndmask_b32 v13, v15, v12, vcc
    buffer_load_dwordx4 v[104:107], v11, s[56:59], 0 offen offset:0
    buffer_load_dwordx4 v[108:111], v11, s[56:59], 0 offen offset:512
    buffer_load_dwordx4 v[112:115], v11, s[56:59], 0 offen offset:1024
    buffer_load_dwordx4 v[56:59], v12, s[44:47], s78 offen
    buffer_load_dwordx4 v[60:63], v12, s[44:47], s78 offen offset:512
    buffer_load_dwordx4 v[64:67], v13, s[44:47], s78 offen offset:1024
    s_add_u32 s78, s78, 163840
    buffer_load_dwordx4 v[68:71], v12, s[44:47], s78 offen
    buffer_load_dwordx4 v[72:75], v12, s[44:47], s78 offen offset:512
    buffer_load_dwordx4 v[76:79], v13, s[44:47], s78 offen offset:1024
    s_add_u32 s78, s78, 163840
    buffer_load_dwordx4 v[80:83], v12, s[44:47], s78 offen
    buffer_load_dwordx4 v[84:87], v12, s[44:47], s78 offen offset:512
    buffer_load_dwordx4 v[88:91], v13, s[44:47], s78 offen offset:1024
    s_add_u32 s78, s78, 163840
    buffer_load_dwordx4 v[92:95], v12, s[44:47], s78 offen
    buffer_load_dwordx4 v[96:99], v12, s[44:47], s78 offen offset:512
    buffer_load_dwordx4 v[100:103], v13, s[44:47], s78 offen offset:1024
    s_add_u32 s78, s78, 163840
    s_lshl_b32 s78, s6, 3
    s_add_u32 s78, s78, s77
    s_lshl_b32 s78, s78, 3
    s_add_u32 s78, s78, s76
    s_lshl_b32 s80, s78, 6
    s_or_b32 s80, s80, s86
    v_lshlrev_b32 v14, 3, v9
    v_cmp_eq_u32 vcc, 31, v10
    s_nop 1
    v_cndmask_b32 v14, v15, v14, vcc
    s_waitcnt vmcnt(15)
    s_mov_b32 s94, 200000
Lp_15:
    v_cmp_ne_u32 vcc, s92, v243
    s_nop 1
    s_cbranch_vccz Lp_ok_16
    s_sleep 4
    buffer_load_dword v243, v240, s[72:75], s88 offen sc1
    s_waitcnt vmcnt(0)
    s_sub_u32 s94, s94, 1
    s_cmp_lg_u32 s94, 0
    s_cbranch_scc1 Lp_15
Lp_ok_16:
    s_lshl_b32 s96, s10, 2
    s_add_u32 s96, s96, 160688
    v_mov_b32 v236, s96
    v_mov_b32 v237, 1
    ds_write_b32 v236, v237
    s_waitcnt lgkmcnt(0)
    s_barrier
    s_waitcnt vmcnt(9)
    v_mov_b32 v24, 0
    v_dot2_f32_bf16 v24, v56, v104, v24
    v_dot2_f32_bf16 v24, v57, v105, v24
    v_dot2_f32_bf16 v24, v58, v106, v24
    v_dot2_f32_bf16 v24, v59, v107, v24
    v_dot2_f32_bf16 v24, v60, v108, v24
    v_dot2_f32_bf16 v24, v61, v109, v24
    v_dot2_f32_bf16 v24, v62, v110, v24
    v_dot2_f32_bf16 v24, v63, v111, v24
    v_dot2_f32_bf16 v24, v64, v112, v24
    v_dot2_f32_bf16 v24, v65, v113, v24
    v_dot2_f32_bf16 v24, v66, v114, v24
    v_dot2_f32_bf16 v24, v67, v115, v24
    s_waitcnt vmcnt(6)
    v_mov_b32 v25, 0
    v_dot2_f32_bf16 v25, v68, v104, v25
    v_dot2_f32_bf16 v25, v69, v105, v25
    v_dot2_f32_bf16 v25, v70, v106, v25
    v_dot2_f32_bf16 v25, v71, v107, v25
    v_dot2_f32_bf16 v25, v72, v108, v25
    v_dot2_f32_bf16 v25, v73, v109, v25
    v_dot2_f32_bf16 v25, v74, v110, v25
    v_dot2_f32_bf16 v25, v75, v111, v25
    v_dot2_f32_bf16 v25, v76, v112, v25
    v_dot2_f32_bf16 v25, v77, v113, v25
    v_dot2_f32_bf16 v25, v78, v114, v25
    v_dot2_f32_bf16 v25, v79, v115, v25
    s_waitcnt vmcnt(3)
    v_mov_b32 v26, 0
    v_dot2_f32_bf16 v26, v80, v104, v26
    v_dot2_f32_bf16 v26, v81, v105, v26
    v_dot2_f32_bf16 v26, v82, v106, v26
    v_dot2_f32_bf16 v26, v83, v107, v26
    v_dot2_f32_bf16 v26, v84, v108, v26
    v_dot2_f32_bf16 v26, v85, v109, v26
    v_dot2_f32_bf16 v26, v86, v110, v26
    v_dot2_f32_bf16 v26, v87, v111, v26
    v_dot2_f32_bf16 v26, v88, v112, v26
    v_dot2_f32_bf16 v26, v89, v113, v26
    v_dot2_f32_bf16 v26, v90, v114, v26
    v_dot2_f32_bf16 v26, v91, v115, v26
    s_waitcnt vmcnt(0)
    v_mov_b32 v27, 0
    v_dot2_f32_bf16 v27, v92, v104, v27
    v_dot2_f32_bf16 v27, v93, v105, v27
    v_dot2_f32_bf16 v27, v94, v106, v27
    v_dot2_f32_bf16 v27, v95, v107, v27
    v_dot2_f32_bf16 v27, v96, v108, v27
    v_dot2_f32_bf16 v27, v97, v109, v27
    v_dot2_f32_bf16 v27, v98, v110, v27
    v_dot2_f32_bf16 v27, v99, v111, v27
    v_dot2_f32_bf16 v27, v100, v112, v27
    v_dot2_f32_bf16 v27, v101, v113, v27
    v_dot2_f32_bf16 v27, v102, v114, v27
    v_dot2_f32_bf16 v27, v103, v115, v27
    s_nop 2
    v_add_f32_dpp v24, v24, v24 row_shr:1 row_mask:0xf bank_mask:0xf bound_ctrl:0
    v_add_f32_dpp v25, v25, v25 row_shr:1 row_mask:0xf bank_mask:0xf bound_ctrl:0
    v_add_f32_dpp v26, v26, v26 row_shr:1 row_mask:0xf bank_mask:0xf bound_ctrl:0
    v_add_f32_dpp v27, v27, v27 row_shr:1 row_mask:0xf bank_mask:0xf bound_ctrl:0
    v_add_f32_dpp v24, v24, v24 row_shr:2 row_mask:0xf bank_mask:0xf bound_ctrl:0
    v_add_f32_dpp v25, v25, v25 row_shr:2 row_mask:0xf bank_mask:0xf bound_ctrl:0
    v_add_f32_dpp v26, v26, v26 row_shr:2 row_mask:0xf bank_mask:0xf bound_ctrl:0
    v_add_f32_dpp v27, v27, v27 row_shr:2 row_mask:0xf bank_mask:0xf bound_ctrl:0
    v_add_f32_dpp v24, v24, v24 row_shr:4 row_mask:0xf bank_mask:0xf bound_ctrl:0
    v_add_f32_dpp v25, v25, v25 row_shr:4 row_mask:0xf bank_mask:0xf bound_ctrl:0
    v_add_f32_dpp v26, v26, v26 row_shr:4 row_mask:0xf bank_mask:0xf bound_ctrl:0
    v_add_f32_dpp v27, v27, v27 row_shr:4 row_mask:0xf bank_mask:0xf bound_ctrl:0
    v_add_f32_dpp v24, v24, v24 row_shr:8 row_mask:0xf bank_mask:0xf bound_ctrl:0
    v_add_f32_dpp v25, v25, v25 row_shr:8 row_mask:0xf bank_mask:0xf bound_ctrl:0
    v_add_f32_dpp v26, v26, v26 row_shr:8 row_mask:0xf bank_mask:0xf bound_ctrl:0
    v_add_f32_dpp v27, v27, v27 row_shr:8 row_mask:0xf bank_mask:0xf bound_ctrl:0
    v_add_f32_dpp v24, v24, v24 row_bcast:15 row_mask:0xa bank_mask:0xf
    v_add_f32_dpp v25, v25, v25 row_bcast:15 row_mask:0xa bank_mask:0xf
    v_add_f32_dpp v26, v26, v26 row_bcast:15 row_mask:0xa bank_mask:0xf
    v_add_f32_dpp v27, v27, v27 row_bcast:15 row_mask:0xa bank_mask:0xf
    v_cvt_pk_bf16_f32 v24, v24, v24
    v_and_b32 v24, 0xffff0000, v24
    v_mul_f32 v24, 0xbfb8aa3b, v24
    v_exp_f32 v24, v24
    s_nop 0
    v_add_f32 v24, 1.0, v24
    v_rcp_f32 v24, v24
    s_nop 0
    v_cvt_pk_bf16_f32 v24, v24, v24
    v_and_b32 v29, 0xffff0000, v24
    v_mov_b32 v28, v250
    buffer_store_dwordx2 v[28:29], v14, s[52:55], s80 offen offset:0 sc1
    v_cvt_pk_bf16_f32 v25, v25, v25
    v_and_b32 v25, 0xffff0000, v25
    v_mul_f32 v25, 0xbfb8aa3b, v25
    v_exp_f32 v25, v25
    s_nop 0
    v_add_f32 v25, 1.0, v25
    v_rcp_f32 v25, v25
    s_nop 0
    v_cvt_pk_bf16_f32 v25, v25, v25
    v_and_b32 v31, 0xffff0000, v25
    v_mov_b32 v30, v250
    buffer_store_dwordx2 v[30:31], v14, s[52:55], s80 offen offset:16 sc1
    v_cvt_pk_bf16_f32 v26, v26, v26
    v_and_b32 v26, 0xffff0000, v26
    v_mul_f32 v26, 0xbfb8aa3b, v26
    v_exp_f32 v26, v26
    s_nop 0
    v_add_f32 v26, 1.0, v26
    v_rcp_f32 v26, v26
    s_nop 0
    v_cvt_pk_bf16_f32 v26, v26, v26
    v_and_b32 v33, 0xffff0000, v26
    v_mov_b32 v32, v250
    buffer_store_dwordx2 v[32:33], v14, s[52:55], s80 offen offset:32 sc1
    v_cvt_pk_bf16_f32 v27, v27, v27
    v_and_b32 v27, 0xffff0000, v27
    v_mul_f32 v27, 0xbfb8aa3b, v27
    v_exp_f32 v27, v27
    s_nop 0
    v_add_f32 v27, 1.0, v27
    v_rcp_f32 v27, v27
    s_nop 0
    v_cvt_pk_bf16_f32 v27, v27, v27
    v_and_b32 v35, 0xffff0000, v27
    v_mov_b32 v34, v250
    buffer_store_dwordx2 v[34:35], v14, s[52:55], s80 offen offset:48 sc1
    s_lshr_b32 s97, s84, 3
    s_lshl_b32 s97, s97, 9
    s_and_b32 s96, s84, 7
    s_lshl_b32 s96, s96, 3
    s_add_u32 s97, s97, s96
    s_lshl_b32 s96, s10, 1
    s_add_u32 s97, s97, s96
    s_mul_i32 s97, s97, 1280
    s_mul_i32 s96, s85, 160
    s_add_u32 s97, s97, s96
    v_add_u32 v2, 0, v1
    v_mul_u32_u24 v3, 6554, v2
    v_lshrrev_b32 v3, 16, v3
    v_mul_u32_u24 v4, 10, v3
    v_sub_u32 v4, v2, v4
    v_and_b32 v5, 7, v3
    v_lshlrev_b32 v5, 6, v5
    v_lshrrev_b32 v3, 3, v3
    v_add_u32 v3, v3, v5
    v_mul_u32_u24 v3, 1280, v3
    v_lshl_add_u32 v3, v4, 4, v3
    s_add_u32 m0, s83, 0
    s_nop 0
    buffer_load_dwordx4 v3, s[44:47], s97 offen lds
    v_add_u32 v2, 64, v1
    v_mul_u32_u24 v3, 6554, v2
    v_lshrrev_b32 v3, 16, v3
    v_mul_u32_u24 v4, 10, v3
    v_sub_u32 v4, v2, v4
    v_and_b32 v5, 7, v3
    v_lshlrev_b32 v5, 6, v5
    v_lshrrev_b32 v3, 3, v3
    v_add_u32 v3, v3, v5
    v_mul_u32_u24 v3, 1280, v3
    v_lshl_add_u32 v3, v4, 4, v3
    s_add_u32 m0, s83, 1024
    s_nop 0
    buffer_load_dwordx4 v3, s[44:47], s97 offen lds
    v_add_u32 v2, 128, v1
    v_mul_u32_u24 v3, 6554, v2
    v_lshrrev_b32 v3, 16, v3
    v_mul_u32_u24 v4, 10, v3
    v_sub_u32 v4, v2, v4
    v_and_b32 v5, 7, v3
    v_lshlrev_b32 v5, 6, v5
    v_lshrrev_b32 v3, 3, v3
    v_add_u32 v3, v3, v5
    v_mul_u32_u24 v3, 1280, v3
    v_lshl_add_u32 v3, v4, 4, v3
    v_cmp_gt_u32 vcc, 32, v1
    v_mov_b32 v4, 0x80000000
    s_nop 0
    v_cndmask_b32 v3, v4, v3, vcc
    s_add_u32 m0, s83, 2048
    s_nop 0
    buffer_load_dwordx4 v3, s[44:47], s97 offen lds
    s_lshl_b32 s89, s85, 8
    s_add_u32 s89, s89, 17408
    v_min_u32 v247, 47, v1
    v_lshlrev_b32 v247, 2, v247
    buffer_load_dword v239, v247, s[72:75], s89 offen sc1
    s_setprio 0
    s_waitcnt vmcnt(0)
    s_mov_b32 s94, 200000
Lp_17:
    v_cmp_ne_u32 vcc, s92, v239
    s_nop 1
    s_cbranch_vccz Lp_ok_18
    s_sleep 4
    buffer_load_dword v239, v247, s[72:75], s89 offen sc1
    s_waitcnt vmcnt(0)
    s_sub_u32 s94, s94, 1
    s_cmp_lg_u32 s94, 0
    s_cbranch_scc1 Lp_17
Lp_ok_18:
Lfetch:
    s_mul_i32 s11, s85, 327680
    s_mul_i32 s12, s10, 81920
    s_add_u32 s11, s11, s12
    s_lshr_b32 s12, s84, 3
    s_lshl_b32 s12, s12, 10
    s_add_u32 s11, s11, s12
    s_and_b32 s12, s84, 7
    s_lshl_b32 s12, s12, 7
    s_add_u32 s11, s11, s12
    v_lshrrev_b32 v24, 3, v1
    v_lshlrev_b32 v24, 12, v24
    v_and_b32 v25, 7, v1
    v_lshl_add_u32 v24, v25, 4, v24
    v_add_u32 v25, 0x8000, v24
    v_add_u32 v26, 0x10000, v24
    v_cmp_gt_u32 vcc, 32, v1
    v_mov_b32 v27, 0x80000000
    s_nop 0
    v_cndmask_b32 v26, v27, v26, vcc
    v_lshlrev_b32 v28, 2, v1
    s_add_u32 s12, s83, 3072
    v_add_u32 v28, s12, v28
    v_add_u32 v29, s82, v241
    v_lshlrev_b32 v31, 3, v1
    s_add_u32 s12, s82, 2560
    v_add_u32 v31, s12, v31
    v_and_b32 v30, 15, v1
    v_mul_u32_u24 v30, 160, v30
    v_lshrrev_b32 v32, 4, v1
    v_lshl_add_u32 v30, v32, 3, v30
    v_add_u32 v30, s83, v30
    v_and_b32 v32, 3, v1
    v_lshlrev_b32 v32, 3, v32
    s_lshl_b32 s12, s10, 5
    s_add_u32 s12, s12, 123264
    v_add_u32 v32, s12, v32
    v_lshrrev_b32 v36, 2, v1
    v_add_u32 v36, 0, v36
    v_mul_u32_u24 v37, 3277, v36
    v_lshrrev_b32 v37, 16, v37
    v_mul_u32_u24 v37, 2560, v37
    v_lshl_add_u32 v36, v36, 7, v37
    v_add_u32 v2, v36, v32
    v_lshrrev_b32 v36, 2, v1
    v_add_u32 v36, 16, v36
    v_mul_u32_u24 v37, 3277, v36
    v_lshrrev_b32 v37, 16, v37
    v_mul_u32_u24 v37, 2560, v37
    v_lshl_add_u32 v36, v36, 7, v37
    v_add_u32 v3, v36, v32
    v_lshrrev_b32 v36, 2, v1
    v_add_u32 v36, 32, v36
    v_mul_u32_u24 v37, 3277, v36
    v_lshrrev_b32 v37, 16, v37
    v_mul_u32_u24 v37, 2560, v37
    v_lshl_add_u32 v36, v36, 7, v37
    v_add_u32 v4, v36, v32
    v_lshrrev_b32 v36, 2, v1
    v_add_u32 v36, 48, v36
    v_mul_u32_u24 v37, 3277, v36
    v_lshrrev_b32 v37, 16, v37
    v_mul_u32_u24 v37, 2560, v37
    v_lshl_add_u32 v36, v36, 7, v37
    v_add_u32 v5, v36, v32
    v_lshrrev_b32 v36, 2, v1
    v_add_u32 v36, 64, v36
    v_mul_u32_u24 v37, 3277, v36
    v_lshrrev_b32 v37, 16, v37
    v_mul_u32_u24 v37, 2560, v37
    v_lshl_add_u32 v36, v36, 7, v37
    v_add_u32 v6, v36, v32
    s_lshl_b32 s96, s84, 6
    s_lshl_b32 s97, s10, 4
    s_add_u32 s96, s96, s97
    v_and_b32 v33, 15, v1
    v_add_u32 v33, s96, v33
    v_lshlrev_b32 v33, 3, v33
    s_lshl_b32 s96, s10, 2
    s_add_u32 s96, s96, 160704
    v_mov_b32 v236, s96
    s_mov_b32 s94, 200000
Lgate2:
    ds_read_b32 v237, v236
    s_waitcnt lgkmcnt(0)
    v_readfirstlane_b32 s96, v237
    s_nop 0
    s_cmp_eq_u32 s96, 1
    s_cbranch_scc1 Lgate2_ok
    s_sleep 6
    s_sub_u32 s94, s94, 1
    s_cmp_lg_u32 s94, 0
    s_cbranch_scc1 Lgate2
Lgate2_ok:
    s_mov_b32 s94, 200000
Ly_19:
    buffer_load_dwordx4 v[40:43], v24, s[64:67], s11 offen sc1
    buffer_load_dwordx4 v[44:47], v25, s[64:67], s11 offen sc1
    buffer_load_dwordx4 v[48:51], v26, s[64:67], s11 offen sc1
    buffer_load_dwordx2 v[34:35], v33, s[52:55], 0 offen sc1
    s_waitcnt vmcnt(0)
    v_max3_u32 v27, v40, v41, v42
    v_max3_u32 v27, v27, v43, v44
    v_max3_u32 v27, v27, v45, v46
    v_max3_u32 v27, v27, v47, v48
    v_max3_u32 v27, v27, v49, v50
    v_max_u32 v27, v27, v51
    v_cmp_eq_u32 vcc, -1, v27
    v_cmp_ne_u32 s[96:97], s92, v34
    s_nop 0
    s_or_b64 vcc, vcc, s[96:97]
    s_cbranch_scc0 Ly_ok_20
    s_sleep 8
    s_sub_u32 s94, s94, 1
    s_cmp_lg_u32 s94, 0
    s_cbranch_scc1 Ly_19
Ly_ok_20:
    ds_write_b128 v29, v[40:43]
    ds_write_b128 v29, v[44:47] offset:1024
    v_cmp_gt_u32 vcc, 32, v1
    s_nop 0
    s_and_saveexec_b64 s[96:97], vcc
    ds_write_b128 v29, v[48:51] offset:2048
    s_mov_b64 exec, s[96:97]
    ds_read_b64 v[56:57], v30 offset:0
    ds_read_b64 v[58:59], v30 offset:32
    ds_read_b64 v[60:61], v30 offset:64
    ds_read_b64 v[62:63], v30 offset:96
    ds_read_b64 v[64:65], v30 offset:128
    v_sub_f32 v36, 1.0, v35
    v_cvt_pk_bf16_f32 v36, v36, v36
    v_and_b32 v36, 0xffff0000, v36
    ds_write_b32 v28, v36
    v_mov_b32 v37, 160644
    v_mov_b32 v38, 1
    s_waitcnt lgkmcnt(0)
    v_cmp_eq_u32 vcc, 0, v1
    s_nop 0
    s_and_saveexec_b64 s[96:97], vcc
    ds_add_u32 v37, v38
    s_mov_b64 exec, s[96:97]
    v_lshlrev_b32 v72, 16, v56
    v_and_b32 v73, 0xffff0000, v56
    v_lshlrev_b32 v74, 16, v57
    v_and_b32 v75, 0xffff0000, v57
    v_mul_f32 v72, v35, v72
    v_mul_f32 v73, v35, v73
    v_mul_f32 v74, v35, v74
    v_mul_f32 v75, v35, v75
    v_lshlrev_b32 v76, 16, v58
    v_and_b32 v77, 0xffff0000, v58
    v_lshlrev_b32 v78, 16, v59
    v_and_b32 v79, 0xffff0000, v59
    v_mul_f32 v76, v35, v76
    v_mul_f32 v77, v35, v77
    v_mul_f32 v78, v35, v78
    v_mul_f32 v79, v35, v79
    v_lshlrev_b32 v80, 16, v60
    v_and_b32 v81, 0xffff0000, v60
    v_lshlrev_b32 v82, 16, v61
    v_and_b32 v83, 0xffff0000, v61
    v_mul_f32 v80, v35, v80
    v_mul_f32 v81, v35, v81
    v_mul_f32 v82, v35, v82
    v_mul_f32 v83, v35, v83
    v_lshlrev_b32 v84, 16, v62
    v_and_b32 v85, 0xffff0000, v62
    v_lshlrev_b32 v86, 16, v63
    v_and_b32 v87, 0xffff0000, v63
    v_mul_f32 v84, v35, v84
    v_mul_f32 v85, v35, v85
    v_mul_f32 v86, v35, v86
    v_mul_f32 v87, v35, v87
    v_lshlrev_b32 v88, 16, v64
    v_and_b32 v89, 0xffff0000, v64
    v_lshlrev_b32 v90, 16, v65
    v_and_b32 v91, 0xffff0000, v65
    v_mul_f32 v88, v35, v88
    v_mul_f32 v89, v35, v89
    v_mul_f32 v90, v35, v90
    v_mul_f32 v91, v35, v91
    s_mov_b32 s94, 200000
Llsync:
    ds_read_b32 v38, v37
    s_waitcnt lgkmcnt(0)
    v_readfirstlane_b32 s12, v38
    s_nop 0
    s_cmp_ge_u32 s12, 4
    s_cbranch_scc1 Llsync_ok
    s_sleep 1
    s_sub_u32 s94, s94, 1
    s_cmp_lg_u32 s94, 0
    s_cbranch_scc1 Llsync
Llsync_ok:
    ds_read_b64_tr_b16 v[56:57], v2
    ds_read_b64_tr_b16 v[58:59], v3
    ds_read_b64_tr_b16 v[60:61], v4
    ds_read_b64_tr_b16 v[62:63], v5
    ds_read_b64_tr_b16 v[64:65], v6
    s_waitcnt lgkmcnt(4)
    v_lshlrev_b32 v96, 16, v56
    v_and_b32 v97, 0xffff0000, v56
    v_lshlrev_b32 v98, 16, v57
    v_and_b32 v99, 0xffff0000, v57
    v_mul_f32 v72, v72, v96
    v_mul_f32 v73, v73, v97
    v_mul_f32 v74, v74, v98
    v_mul_f32 v75, v75, v99
    v_cvt_pk_bf16_f32 v72, v72, v73
    v_cvt_pk_bf16_f32 v73, v74, v75
    ds_write_b64 v31, v[72:73] offset:0
    s_waitcnt lgkmcnt(4)
    v_lshlrev_b32 v96, 16, v58
    v_and_b32 v97, 0xffff0000, v58
    v_lshlrev_b32 v98, 16, v59
    v_and_b32 v99, 0xffff0000, v59
    v_mul_f32 v76, v76, v96
    v_mul_f32 v77, v77, v97
    v_mul_f32 v78, v78, v98
    v_mul_f32 v79, v79, v99
    v_cvt_pk_bf16_f32 v76, v76, v77
    v_cvt_pk_bf16_f32 v77, v78, v79
    ds_write_b64 v31, v[76:77] offset:512
    s_waitcnt lgkmcnt(4)
    v_lshlrev_b32 v96, 16, v60
    v_and_b32 v97, 0xffff0000, v60
    v_lshlrev_b32 v98, 16, v61
    v_and_b32 v99, 0xffff0000, v61
    v_mul_f32 v80, v80, v96
    v_mul_f32 v81, v81, v97
    v_mul_f32 v82, v82, v98
    v_mul_f32 v83, v83, v99
    v_cvt_pk_bf16_f32 v80, v80, v81
    v_cvt_pk_bf16_f32 v81, v82, v83
    ds_write_b64 v31, v[80:81] offset:1024
    s_waitcnt lgkmcnt(4)
    v_lshlrev_b32 v96, 16, v62
    v_and_b32 v97, 0xffff0000, v62
    v_lshlrev_b32 v98, 16, v63
    v_and_b32 v99, 0xffff0000, v63
    v_mul_f32 v84, v84, v96
    v_mul_f32 v85, v85, v97
    v_mul_f32 v86, v86, v98
    v_mul_f32 v87, v87, v99
    v_cvt_pk_bf16_f32 v84, v84, v85
    v_cvt_pk_bf16_f32 v85, v86, v87
    ds_write_b64 v31, v[84:85] offset:1536
    s_waitcnt lgkmcnt(4)
    v_lshlrev_b32 v96, 16, v64
    v_and_b32 v97, 0xffff0000, v64
    v_lshlrev_b32 v98, 16, v65
    v_and_b32 v99, 0xffff0000, v65
    v_mul_f32 v88, v88, v96
    v_mul_f32 v89, v89, v97
    v_mul_f32 v90, v90, v98
    v_mul_f32 v91, v91, v99
    v_cvt_pk_bf16_f32 v88, v88, v89
    v_cvt_pk_bf16_f32 v89, v90, v91
    ds_write_b64 v31, v[88:89] offset:2048
    s_waitcnt lgkmcnt(0)
    s_barrier
Ldone:
    s_endpgm
Lcwave:
    s_getpc_b64 s[60:61]
Lpc:
    s_sub_u32 s60, s60, (Lpc - gated_mix__ssm_conv_h3__glu_gated_bilinear__prompt_kernel)
    s_subb_u32 s61, s61, 0
    s_mov_b32 s62, CODE_END - gated_mix__ssm_conv_h3__glu_gated_bilinear__prompt_kernel
    s_mov_b32 s63, 0x00020000
    v_lshrrev_b32 v253, 6, v0
    s_lshr_b32 s59, s2, 3
    s_mul_i32 s59, s59, 4
    v_add_u32 v253, s59, v253
    v_mul_u32_u24 v253, 3, v253
    v_and_b32 v254, 63, v0
    v_add_u32 v253, v253, v254
    v_lshlrev_b32 v253, 7, v253
    v_cmp_gt_u32 vcc, 3, v254
    v_mov_b32 v254, 0x80000000
    s_nop 0
    v_cndmask_b32 v253, v254, v253, vcc
    buffer_load_dword v254, v253, s[60:63], 0 offen
    s_cmp_ge_u32 s5, 30
    s_cbranch_scc1 LCodd
    s_and_b32 s10, s3, 1
    s_lshr_b32 s11, s3, 1
    v_and_b32 v2, 31, v1
    v_lshrrev_b32 v3, 5, v1
    v_lshrrev_b32 v9, 1, v2
    v_and_b32 v9, 7, v9
    v_xor_b32 v9, v9, v3
    v_lshlrev_b32 v9, 4, v9
    v_lshl_add_u32 v9, v2, 7, v9
    s_mul_i32 s12, s11, 12288
    v_add_u32 v4, s12, v9
    v_xor_b32 v5, 32, v4
    v_xor_b32 v6, 64, v4
    v_xor_b32 v7, 96, v4
    v_bfe_u32 v9, v1, 4, 1
    v_bfe_u32 v11, v1, 2, 2
    v_lshl_add_u32 v8, v3, 3, v11
    v_lshlrev_b32 v8, 7, v8
    v_lshl_add_u32 v8, v9, 13, v8
    v_xor_b32 v9, s10, v9
    v_lshl_add_u32 v8, v9, 6, v8
    v_lshrrev_b32 v11, 1, v11
    v_lshl_add_u32 v8, v11, 5, v8
    v_and_b32 v9, 3, v1
    v_lshl_add_u32 v8, v9, 3, v8
    v_add_u32 v8, 24576, v8
    v_xor_b32 v11, 32, v8
    v_lshrrev_b32 v9, 4, v2
    v_lshlrev_b32 v10, 10, v9
    v_lshl_add_u32 v10, v3, 8, v10
    v_and_b32 v9, 15, v2
    v_lshl_add_u32 v10, v9, 4, v10
    s_lshl_b32 s13, s8, 1
    s_add_u32 s13, s13, s10
    v_mov_b32 v249, 0x80000000
    s_mul_i32 s12, s11, 3
    s_add_u32 s12, s12, 0
    s_and_b32 s14, s12, 1
    s_lshr_b32 s12, s12, 1
    s_mul_i32 s15, s7, 3
    s_add_u32 s12, s12, s15
    s_mul_i32 s15, s12, 96
    s_add_u32 s15, s15, s14
    s_lshl_b32 s79, s13, 1
    s_add_u32 s15, s15, s79
    s_lshl_b32 s15, s15, 2
    s_add_u32 s15, s15, 2560
    v_writelane_b32 v249, s15, 0
    s_mul_i32 s12, s12, 196608
    s_lshl_b32 s14, s14, 11
    s_add_u32 s12, s12, s14
    s_lshl_b32 s14, s13, 12
    s_add_u32 s76, s12, s14
    s_mul_i32 s12, s11, 3
    s_add_u32 s12, s12, 1
    s_and_b32 s14, s12, 1
    s_lshr_b32 s12, s12, 1
    s_mul_i32 s15, s7, 3
    s_add_u32 s12, s12, s15
    s_mul_i32 s15, s12, 96
    s_add_u32 s15, s15, s14
    s_lshl_b32 s79, s13, 1
    s_add_u32 s15, s15, s79
    s_lshl_b32 s15, s15, 2
    s_add_u32 s15, s15, 2560
    v_writelane_b32 v249, s15, 1
    s_mul_i32 s12, s12, 196608
    s_lshl_b32 s14, s14, 11
    s_add_u32 s12, s12, s14
    s_lshl_b32 s14, s13, 12
    s_add_u32 s77, s12, s14
    s_mul_i32 s12, s11, 3
    s_add_u32 s12, s12, 2
    s_and_b32 s14, s12, 1
    s_lshr_b32 s12, s12, 1
    s_mul_i32 s15, s7, 3
    s_add_u32 s12, s12, s15
    s_mul_i32 s15, s12, 96
    s_add_u32 s15, s15, s14
    s_lshl_b32 s79, s13, 1
    s_add_u32 s15, s15, s79
    s_lshl_b32 s15, s15, 2
    s_add_u32 s15, s15, 2560
    v_writelane_b32 v249, s15, 2
    s_mul_i32 s12, s12, 196608
    s_lshl_b32 s14, s14, 11
    s_add_u32 s12, s12, s14
    s_lshl_b32 s14, s13, 12
    s_add_u32 s78, s12, s14
    s_lshl_b32 s84, s4, 2
    s_and_b32 s85, s5, 3
    s_add_u32 s84, s84, s85
    s_lshr_b32 s85, s5, 2
    s_mul_i32 s86, s85, 245760
    s_mul_i32 s96, s3, 61440
    s_add_u32 s86, s86, s96
    s_mul_i32 s87, s84, 196608
    s_mul_i32 s96, s3, 49152
    s_add_u32 s87, s87, s96
    s_mul_i32 s88, s3, 10240
    s_mul_i32 s83, s84, 384
    s_mul_i32 s96, s3, 96
    s_add_u32 s83, s83, s96
    s_add_u32 s83, s83, 2560
    s_lshr_b32 s97, s84, 3
    s_lshl_b32 s97, s97, 9
    s_and_b32 s96, s84, 7
    s_lshl_b32 s96, s96, 3
    s_add_u32 s97, s97, s96
    s_lshl_b32 s96, s3, 1
    s_add_u32 s97, s97, s96
    s_mul_i32 s89, s97, 1280
    s_mul_i32 s96, s85, 160
    s_add_u32 s89, s89, s96
    v_add_u32 v12, 0, v1
    v_mul_u32_u24 v13, 6554, v12
    v_lshrrev_b32 v13, 16, v13
    v_mul_u32_u24 v14, 10, v13
    v_sub_u32 v14, v12, v14
    v_and_b32 v15, 7, v13
    v_lshlrev_b32 v15, 6, v15
    v_lshrrev_b32 v13, 3, v13
    v_add_u32 v13, v13, v15
    v_mul_u32_u24 v13, 1280, v13
    v_lshl_add_u32 v242, v14, 4, v13
    v_add_u32 v12, 64, v1
    v_mul_u32_u24 v13, 6554, v12
    v_lshrrev_b32 v13, 16, v13
    v_mul_u32_u24 v14, 10, v13
    v_sub_u32 v14, v12, v14
    v_and_b32 v15, 7, v13
    v_lshlrev_b32 v15, 6, v15
    v_lshrrev_b32 v13, 3, v13
    v_add_u32 v13, v13, v15
    v_mul_u32_u24 v13, 1280, v13
    v_lshl_add_u32 v244, v14, 4, v13
    v_add_u32 v12, 128, v1
    v_mul_u32_u24 v13, 6554, v12
    v_lshrrev_b32 v13, 16, v13
    v_mul_u32_u24 v14, 10, v13
    v_sub_u32 v14, v12, v14
    v_and_b32 v15, 7, v13
    v_lshlrev_b32 v15, 6, v15
    v_lshrrev_b32 v13, 3, v13
    v_add_u32 v13, v13, v15
    v_mul_u32_u24 v13, 1280, v13
    v_lshl_add_u32 v245, v14, 4, v13
    v_cmp_gt_u32 vcc, 32, v1
    v_mov_b32 v14, 0x80000000
    s_nop 0
    v_cndmask_b32 v245, v14, v245, vcc
    v_lshlrev_b32 v240, 4, v1
    v_add_u32 v241, 4096, v240
    v_min_u32 v246, 23, v1
    v_lshlrev_b32 v246, 2, v246
    v_and_b32 v9, 31, v1
    v_lshlrev_b32 v9, 2, v9
    v_add_u32 v9, 160640, v9
    v_mov_b32 v12, 0
    ds_write_b32 v9, v12
    s_waitcnt lgkmcnt(0)
    s_mov_b32 s44, s42
    s_mov_b32 s45, s43
    s_mov_b32 s46, 0x600000
    s_mov_b32 s47, 0x00020000
    s_add_u32 s48, s42, 0x600000
    s_addc_u32 s49, s43, 0
    s_mov_b32 s50, 0x1e0000
    s_mov_b32 s51, 0x00020000
    s_mov_b32 s56, s38
    s_mov_b32 s57, s39
    s_mov_b32 s58, 0x280000
    s_mov_b32 s59, 0x00020000
    s_add_u32 s72, s42, 0xce4000
    s_addc_u32 s73, s43, 0
    s_mov_b32 s74, 0x4e00
    s_mov_b32 s75, 0x00020000
    v_cmp_eq_u32 vcc, 0, v1
    v_mov_b32 v248, 0x80000000
    s_nop 0
    v_cndmask_b32 v248, v248, 0, vcc
    s_setprio 0
    s_barrier
    ds_read_b64_tr_b16 v[16:17], v8 offset:0
    ds_read_b64_tr_b16 v[18:19], v8 offset:512
    ds_read_b128 v[24:27], v4 offset:0
    ds_read_b128 v[28:31], v4 offset:4096
    ds_read_b128 v[32:35], v4 offset:8192
    ds_read_b64_tr_b16 v[20:21], v11 offset:0
    ds_read_b64_tr_b16 v[22:23], v11 offset:512
    s_waitcnt lgkmcnt(4)
    v_mfma_f32_32x32x16_bf16 v[64:79], v[16:19], v[24:27], 0
    ds_read_b64_tr_b16 v[40:41], v8 offset:2048
    ds_read_b64_tr_b16 v[42:43], v8 offset:2560
    s_waitcnt lgkmcnt(5)
    v_mfma_f32_32x32x16_bf16 v[80:95], v[16:19], v[28:31], 0
    ds_read_b128 v[48:51], v5 offset:0
    ds_read_b128 v[52:55], v5 offset:4096
    s_waitcnt lgkmcnt(6)
    v_mfma_f32_32x32x16_bf16 v[96:111], v[16:19], v[32:35], 0
    ds_read_b128 v[56:59], v5 offset:8192
    ds_read_b64_tr_b16 v[44:45], v11 offset:2048
    s_waitcnt lgkmcnt(6)
    v_mfma_f32_32x32x16_bf16 v[112:127], v[20:23], v[24:27], 0
    ds_read_b64_tr_b16 v[46:47], v11 offset:2560
    v_mfma_f32_32x32x16_bf16 v[128:143], v[20:23], v[28:31], 0
    v_mfma_f32_32x32x16_bf16 v[144:159], v[20:23], v[32:35], 0
    s_waitcnt lgkmcnt(4)
    v_mfma_f32_32x32x16_bf16 v[64:79], v[40:43], v[48:51], v[64:79]
    ds_read_b64_tr_b16 v[16:17], v8 offset:4096
    ds_read_b64_tr_b16 v[18:19], v8 offset:4608
    s_waitcnt lgkmcnt(5)
    v_mfma_f32_32x32x16_bf16 v[80:95], v[40:43], v[52:55], v[80:95]
    ds_read_b128 v[24:27], v6 offset:0
    ds_read_b128 v[28:31], v6 offset:4096
    s_waitcnt lgkmcnt(6)
    v_mfma_f32_32x32x16_bf16 v[96:111], v[40:43], v[56:59], v[96:111]
    ds_read_b128 v[32:35], v6 offset:8192
    ds_read_b64_tr_b16 v[20:21], v11 offset:4096
    s_waitcnt lgkmcnt(6)
    v_mfma_f32_32x32x16_bf16 v[112:127], v[44:47], v[48:51], v[112:127]
    ds_read_b64_tr_b16 v[22:23], v11 offset:4608
    v_mfma_f32_32x32x16_bf16 v[128:143], v[44:47], v[52:55], v[128:143]
    v_mfma_f32_32x32x16_bf16 v[144:159], v[44:47], v[56:59], v[144:159]
    s_waitcnt lgkmcnt(4)
    v_mfma_f32_32x32x16_bf16 v[64:79], v[16:19], v[24:27], v[64:79]
    ds_read_b64_tr_b16 v[40:41], v8 offset:6144
    ds_read_b64_tr_b16 v[42:43], v8 offset:6656
    s_waitcnt lgkmcnt(5)
    v_mfma_f32_32x32x16_bf16 v[80:95], v[16:19], v[28:31], v[80:95]
    ds_read_b128 v[48:51], v7 offset:0
    ds_read_b128 v[52:55], v7 offset:4096
    s_waitcnt lgkmcnt(6)
    v_mfma_f32_32x32x16_bf16 v[96:111], v[16:19], v[32:35], v[96:111]
    ds_read_b128 v[56:59], v7 offset:8192
    ds_read_b64_tr_b16 v[44:45], v11 offset:6144
    s_waitcnt lgkmcnt(6)
    v_mfma_f32_32x32x16_bf16 v[112:127], v[20:23], v[24:27], v[112:127]
    ds_read_b64_tr_b16 v[46:47], v11 offset:6656
    v_mfma_f32_32x32x16_bf16 v[128:143], v[20:23], v[28:31], v[128:143]
    v_mfma_f32_32x32x16_bf16 v[144:159], v[20:23], v[32:35], v[144:159]
    s_waitcnt lgkmcnt(4)
    v_mfma_f32_32x32x16_bf16 v[64:79], v[40:43], v[48:51], v[64:79]
    s_waitcnt lgkmcnt(0)
    v_add_u32 v4, 0xa080, v4
    v_add_u32 v5, 0xa080, v5
    v_add_u32 v6, 0xa080, v6
    v_add_u32 v7, 0xa080, v7
    v_add_u32 v8, 0xa080, v8
    v_add_u32 v11, 0xa080, v11
    s_barrier
    v_mfma_f32_32x32x16_bf16 v[80:95], v[40:43], v[52:55], v[80:95]
    ds_read_b64_tr_b16 v[16:17], v8 offset:0
    ds_read_b64_tr_b16 v[18:19], v8 offset:512
    ds_read_b128 v[24:27], v4 offset:0
    v_mfma_f32_32x32x16_bf16 v[96:111], v[40:43], v[56:59], v[96:111]
    ds_read_b128 v[28:31], v4 offset:4096
    ds_read_b128 v[32:35], v4 offset:8192
    v_mfma_f32_32x32x16_bf16 v[112:127], v[44:47], v[48:51], v[112:127]
    ds_read_b64_tr_b16 v[20:21], v11 offset:0
    ds_read_b64_tr_b16 v[22:23], v11 offset:512
    v_mfma_f32_32x32x16_bf16 v[128:143], v[44:47], v[52:55], v[128:143]
    v_mfma_f32_32x32x16_bf16 v[144:159], v[44:47], v[56:59], v[144:159]
    s_waitcnt lgkmcnt(4)
    v_mfma_f32_32x32x16_bf16 v[64:79], v[16:19], v[24:27], v[64:79]
    ds_read_b64_tr_b16 v[40:41], v8 offset:2048
    ds_read_b64_tr_b16 v[42:43], v8 offset:2560
    s_waitcnt lgkmcnt(5)
    v_mfma_f32_32x32x16_bf16 v[80:95], v[16:19], v[28:31], v[80:95]
    ds_read_b128 v[48:51], v5 offset:0
    ds_read_b128 v[52:55], v5 offset:4096
    s_waitcnt lgkmcnt(6)
    v_mfma_f32_32x32x16_bf16 v[96:111], v[16:19], v[32:35], v[96:111]
    ds_read_b128 v[56:59], v5 offset:8192
    ds_read_b64_tr_b16 v[44:45], v11 offset:2048
    s_waitcnt lgkmcnt(6)
    v_mfma_f32_32x32x16_bf16 v[112:127], v[20:23], v[24:27], v[112:127]
    ds_read_b64_tr_b16 v[46:47], v11 offset:2560
    v_mfma_f32_32x32x16_bf16 v[128:143], v[20:23], v[28:31], v[128:143]
    v_mfma_f32_32x32x16_bf16 v[144:159], v[20:23], v[32:35], v[144:159]
    s_waitcnt lgkmcnt(4)
    v_mfma_f32_32x32x16_bf16 v[64:79], v[40:43], v[48:51], v[64:79]
    ds_read_b64_tr_b16 v[16:17], v8 offset:4096
    ds_read_b64_tr_b16 v[18:19], v8 offset:4608
    s_waitcnt lgkmcnt(5)
    v_mfma_f32_32x32x16_bf16 v[80:95], v[40:43], v[52:55], v[80:95]
    ds_read_b128 v[24:27], v6 offset:0
    ds_read_b128 v[28:31], v6 offset:4096
    s_waitcnt lgkmcnt(6)
    v_mfma_f32_32x32x16_bf16 v[96:111], v[40:43], v[56:59], v[96:111]
    ds_read_b128 v[32:35], v6 offset:8192
    ds_read_b64_tr_b16 v[20:21], v11 offset:4096
    s_waitcnt lgkmcnt(6)
    v_mfma_f32_32x32x16_bf16 v[112:127], v[44:47], v[48:51], v[112:127]
    ds_read_b64_tr_b16 v[22:23], v11 offset:4608
    v_mfma_f32_32x32x16_bf16 v[128:143], v[44:47], v[52:55], v[128:143]
    v_mfma_f32_32x32x16_bf16 v[144:159], v[44:47], v[56:59], v[144:159]
    s_waitcnt lgkmcnt(4)
    v_mfma_f32_32x32x16_bf16 v[64:79], v[16:19], v[24:27], v[64:79]
    ds_read_b64_tr_b16 v[40:41], v8 offset:6144
    ds_read_b64_tr_b16 v[42:43], v8 offset:6656
    s_waitcnt lgkmcnt(5)
    v_mfma_f32_32x32x16_bf16 v[80:95], v[16:19], v[28:31], v[80:95]
    ds_read_b128 v[48:51], v7 offset:0
    ds_read_b128 v[52:55], v7 offset:4096
    s_waitcnt lgkmcnt(6)
    v_mfma_f32_32x32x16_bf16 v[96:111], v[16:19], v[32:35], v[96:111]
    ds_read_b128 v[56:59], v7 offset:8192
    ds_read_b64_tr_b16 v[44:45], v11 offset:6144
    s_waitcnt lgkmcnt(6)
    v_mfma_f32_32x32x16_bf16 v[112:127], v[20:23], v[24:27], v[112:127]
    ds_read_b64_tr_b16 v[46:47], v11 offset:6656
    v_mfma_f32_32x32x16_bf16 v[128:143], v[20:23], v[28:31], v[128:143]
    v_mfma_f32_32x32x16_bf16 v[144:159], v[20:23], v[32:35], v[144:159]
    s_waitcnt lgkmcnt(4)
    v_mfma_f32_32x32x16_bf16 v[64:79], v[40:43], v[48:51], v[64:79]
    s_waitcnt lgkmcnt(0)
    v_add_u32 v4, 0xa080, v4
    v_add_u32 v5, 0xa080, v5
    v_add_u32 v6, 0xa080, v6
    v_add_u32 v7, 0xa080, v7
    v_add_u32 v8, 0xa080, v8
    v_add_u32 v11, 0xa080, v11
    s_barrier
    v_mfma_f32_32x32x16_bf16 v[80:95], v[40:43], v[52:55], v[80:95]
    ds_read_b64_tr_b16 v[16:17], v8 offset:0
    ds_read_b64_tr_b16 v[18:19], v8 offset:512
    ds_read_b128 v[24:27], v4 offset:0
    v_mfma_f32_32x32x16_bf16 v[96:111], v[40:43], v[56:59], v[96:111]
    ds_read_b128 v[28:31], v4 offset:4096
    ds_read_b128 v[32:35], v4 offset:8192
    v_mfma_f32_32x32x16_bf16 v[112:127], v[44:47], v[48:51], v[112:127]
    ds_read_b64_tr_b16 v[20:21], v11 offset:0
    ds_read_b64_tr_b16 v[22:23], v11 offset:512
    v_mfma_f32_32x32x16_bf16 v[128:143], v[44:47], v[52:55], v[128:143]
    v_mfma_f32_32x32x16_bf16 v[144:159], v[44:47], v[56:59], v[144:159]
    s_waitcnt lgkmcnt(4)
    v_mfma_f32_32x32x16_bf16 v[64:79], v[16:19], v[24:27], v[64:79]
    ds_read_b64_tr_b16 v[40:41], v8 offset:2048
    ds_read_b64_tr_b16 v[42:43], v8 offset:2560
    s_waitcnt lgkmcnt(5)
    v_mfma_f32_32x32x16_bf16 v[80:95], v[16:19], v[28:31], v[80:95]
    ds_read_b128 v[48:51], v5 offset:0
    ds_read_b128 v[52:55], v5 offset:4096
    s_waitcnt lgkmcnt(6)
    v_mfma_f32_32x32x16_bf16 v[96:111], v[16:19], v[32:35], v[96:111]
    ds_read_b128 v[56:59], v5 offset:8192
    ds_read_b64_tr_b16 v[44:45], v11 offset:2048
    s_waitcnt lgkmcnt(6)
    v_mfma_f32_32x32x16_bf16 v[112:127], v[20:23], v[24:27], v[112:127]
    ds_read_b64_tr_b16 v[46:47], v11 offset:2560
    v_mfma_f32_32x32x16_bf16 v[128:143], v[20:23], v[28:31], v[128:143]
    v_mfma_f32_32x32x16_bf16 v[144:159], v[20:23], v[32:35], v[144:159]
    s_waitcnt lgkmcnt(4)
    v_mfma_f32_32x32x16_bf16 v[64:79], v[40:43], v[48:51], v[64:79]
    ds_read_b64_tr_b16 v[16:17], v8 offset:4096
    ds_read_b64_tr_b16 v[18:19], v8 offset:4608
    s_waitcnt lgkmcnt(5)
    v_mfma_f32_32x32x16_bf16 v[80:95], v[40:43], v[52:55], v[80:95]
    ds_read_b128 v[24:27], v6 offset:0
    ds_read_b128 v[28:31], v6 offset:4096
    s_waitcnt lgkmcnt(6)
    v_mfma_f32_32x32x16_bf16 v[96:111], v[40:43], v[56:59], v[96:111]
    ds_read_b128 v[32:35], v6 offset:8192
    ds_read_b64_tr_b16 v[20:21], v11 offset:4096
    s_waitcnt lgkmcnt(6)
    v_mfma_f32_32x32x16_bf16 v[112:127], v[44:47], v[48:51], v[112:127]
    ds_read_b64_tr_b16 v[22:23], v11 offset:4608
    v_mfma_f32_32x32x16_bf16 v[128:143], v[44:47], v[52:55], v[128:143]
    v_mfma_f32_32x32x16_bf16 v[144:159], v[44:47], v[56:59], v[144:159]
    s_waitcnt lgkmcnt(4)
    v_mfma_f32_32x32x16_bf16 v[64:79], v[16:19], v[24:27], v[64:79]
    ds_read_b64_tr_b16 v[40:41], v8 offset:6144
    ds_read_b64_tr_b16 v[42:43], v8 offset:6656
    s_waitcnt lgkmcnt(5)
    v_mfma_f32_32x32x16_bf16 v[80:95], v[16:19], v[28:31], v[80:95]
    ds_read_b128 v[48:51], v7 offset:0
    ds_read_b128 v[52:55], v7 offset:4096
    s_waitcnt lgkmcnt(6)
    v_mfma_f32_32x32x16_bf16 v[96:111], v[16:19], v[32:35], v[96:111]
    ds_read_b128 v[56:59], v7 offset:8192
    ds_read_b64_tr_b16 v[44:45], v11 offset:6144
    s_waitcnt lgkmcnt(6)
    v_mfma_f32_32x32x16_bf16 v[112:127], v[20:23], v[24:27], v[112:127]
    ds_read_b64_tr_b16 v[46:47], v11 offset:6656
    v_mfma_f32_32x32x16_bf16 v[128:143], v[20:23], v[28:31], v[128:143]
    v_mfma_f32_32x32x16_bf16 v[144:159], v[20:23], v[32:35], v[144:159]
    s_waitcnt lgkmcnt(4)
    v_mfma_f32_32x32x16_bf16 v[64:79], v[40:43], v[48:51], v[64:79]
    s_waitcnt lgkmcnt(0)
    v_add_u32 v4, 0xfffebf00, v4
    v_add_u32 v5, 0xfffebf00, v5
    v_add_u32 v6, 0xfffebf00, v6
    v_add_u32 v7, 0xfffebf00, v7
    v_add_u32 v8, 0xfffebf00, v8
    v_add_u32 v11, 0xfffebf00, v11
    s_barrier
    v_mfma_f32_32x32x16_bf16 v[80:95], v[40:43], v[52:55], v[80:95]
    ds_read_b64_tr_b16 v[16:17], v8 offset:0
    ds_read_b64_tr_b16 v[18:19], v8 offset:512
    ds_read_b128 v[24:27], v4 offset:0
    v_mfma_f32_32x32x16_bf16 v[96:111], v[40:43], v[56:59], v[96:111]
    ds_read_b128 v[28:31], v4 offset:4096
    ds_read_b128 v[32:35], v4 offset:8192
    v_mfma_f32_32x32x16_bf16 v[112:127], v[44:47], v[48:51], v[112:127]
    ds_read_b64_tr_b16 v[20:21], v11 offset:0
    ds_read_b64_tr_b16 v[22:23], v11 offset:512
    v_mfma_f32_32x32x16_bf16 v[128:143], v[44:47], v[52:55], v[128:143]
    v_mfma_f32_32x32x16_bf16 v[144:159], v[44:47], v[56:59], v[144:159]
    s_waitcnt lgkmcnt(4)
    v_mfma_f32_32x32x16_bf16 v[64:79], v[16:19], v[24:27], v[64:79]
    ds_read_b64_tr_b16 v[40:41], v8 offset:2048
    ds_read_b64_tr_b16 v[42:43], v8 offset:2560
    s_waitcnt lgkmcnt(5)
    v_mfma_f32_32x32x16_bf16 v[80:95], v[16:19], v[28:31], v[80:95]
    ds_read_b128 v[48:51], v5 offset:0
    ds_read_b128 v[52:55], v5 offset:4096
    s_waitcnt lgkmcnt(6)
    v_mfma_f32_32x32x16_bf16 v[96:111], v[16:19], v[32:35], v[96:111]
    ds_read_b128 v[56:59], v5 offset:8192
    ds_read_b64_tr_b16 v[44:45], v11 offset:2048
    s_waitcnt lgkmcnt(6)
    v_mfma_f32_32x32x16_bf16 v[112:127], v[20:23], v[24:27], v[112:127]
    ds_read_b64_tr_b16 v[46:47], v11 offset:2560
    v_mfma_f32_32x32x16_bf16 v[128:143], v[20:23], v[28:31], v[128:143]
    v_mfma_f32_32x32x16_bf16 v[144:159], v[20:23], v[32:35], v[144:159]
    s_waitcnt lgkmcnt(4)
    v_mfma_f32_32x32x16_bf16 v[64:79], v[40:43], v[48:51], v[64:79]
    ds_read_b64_tr_b16 v[16:17], v8 offset:4096
    ds_read_b64_tr_b16 v[18:19], v8 offset:4608
    s_waitcnt lgkmcnt(5)
    v_mfma_f32_32x32x16_bf16 v[80:95], v[40:43], v[52:55], v[80:95]
    ds_read_b128 v[24:27], v6 offset:0
    ds_read_b128 v[28:31], v6 offset:4096
    s_waitcnt lgkmcnt(6)
    v_mfma_f32_32x32x16_bf16 v[96:111], v[40:43], v[56:59], v[96:111]
    ds_read_b128 v[32:35], v6 offset:8192
    ds_read_b64_tr_b16 v[20:21], v11 offset:4096
    s_waitcnt lgkmcnt(6)
    v_mfma_f32_32x32x16_bf16 v[112:127], v[44:47], v[48:51], v[112:127]
    ds_read_b64_tr_b16 v[22:23], v11 offset:4608
    v_mfma_f32_32x32x16_bf16 v[128:143], v[44:47], v[52:55], v[128:143]
    v_mfma_f32_32x32x16_bf16 v[144:159], v[44:47], v[56:59], v[144:159]
    s_waitcnt lgkmcnt(4)
    v_mfma_f32_32x32x16_bf16 v[64:79], v[16:19], v[24:27], v[64:79]
    ds_read_b64_tr_b16 v[40:41], v8 offset:6144
    ds_read_b64_tr_b16 v[42:43], v8 offset:6656
    s_waitcnt lgkmcnt(5)
    v_mfma_f32_32x32x16_bf16 v[80:95], v[16:19], v[28:31], v[80:95]
    ds_read_b128 v[48:51], v7 offset:0
    ds_read_b128 v[52:55], v7 offset:4096
    s_waitcnt lgkmcnt(6)
    v_mfma_f32_32x32x16_bf16 v[96:111], v[16:19], v[32:35], v[96:111]
    ds_read_b128 v[56:59], v7 offset:8192
    ds_read_b64_tr_b16 v[44:45], v11 offset:6144
    s_waitcnt lgkmcnt(6)
    v_mfma_f32_32x32x16_bf16 v[112:127], v[20:23], v[24:27], v[112:127]
    ds_read_b64_tr_b16 v[46:47], v11 offset:6656
    v_mfma_f32_32x32x16_bf16 v[128:143], v[20:23], v[28:31], v[128:143]
    v_mfma_f32_32x32x16_bf16 v[144:159], v[20:23], v[32:35], v[144:159]
    s_waitcnt lgkmcnt(4)
    v_mfma_f32_32x32x16_bf16 v[64:79], v[40:43], v[48:51], v[64:79]
    s_waitcnt lgkmcnt(0)
    v_add_u32 v4, 0xa080, v4
    v_add_u32 v5, 0xa080, v5
    v_add_u32 v6, 0xa080, v6
    v_add_u32 v7, 0xa080, v7
    v_add_u32 v8, 0xa080, v8
    v_add_u32 v11, 0xa080, v11
    s_barrier
    v_mfma_f32_32x32x16_bf16 v[80:95], v[40:43], v[52:55], v[80:95]
    ds_read_b64_tr_b16 v[16:17], v8 offset:0
    ds_read_b64_tr_b16 v[18:19], v8 offset:512
    ds_read_b128 v[24:27], v4 offset:0
    v_mfma_f32_32x32x16_bf16 v[96:111], v[40:43], v[56:59], v[96:111]
    ds_read_b128 v[28:31], v4 offset:4096
    ds_read_b128 v[32:35], v4 offset:8192
    v_mfma_f32_32x32x16_bf16 v[112:127], v[44:47], v[48:51], v[112:127]
    ds_read_b64_tr_b16 v[20:21], v11 offset:0
    ds_read_b64_tr_b16 v[22:23], v11 offset:512
    v_mfma_f32_32x32x16_bf16 v[128:143], v[44:47], v[52:55], v[128:143]
    v_mfma_f32_32x32x16_bf16 v[144:159], v[44:47], v[56:59], v[144:159]
    s_waitcnt lgkmcnt(4)
    v_mfma_f32_32x32x16_bf16 v[64:79], v[16:19], v[24:27], v[64:79]
    ds_read_b64_tr_b16 v[40:41], v8 offset:2048
    ds_read_b64_tr_b16 v[42:43], v8 offset:2560
    s_waitcnt lgkmcnt(5)
    v_mfma_f32_32x32x16_bf16 v[80:95], v[16:19], v[28:31], v[80:95]
    ds_read_b128 v[48:51], v5 offset:0
    ds_read_b128 v[52:55], v5 offset:4096
    s_waitcnt lgkmcnt(6)
    v_mfma_f32_32x32x16_bf16 v[96:111], v[16:19], v[32:35], v[96:111]
    ds_read_b128 v[56:59], v5 offset:8192
    ds_read_b64_tr_b16 v[44:45], v11 offset:2048
    s_waitcnt lgkmcnt(6)
    v_mfma_f32_32x32x16_bf16 v[112:127], v[20:23], v[24:27], v[112:127]
    ds_read_b64_tr_b16 v[46:47], v11 offset:2560
    v_mfma_f32_32x32x16_bf16 v[128:143], v[20:23], v[28:31], v[128:143]
    v_mfma_f32_32x32x16_bf16 v[144:159], v[20:23], v[32:35], v[144:159]
    s_waitcnt lgkmcnt(4)
    v_mfma_f32_32x32x16_bf16 v[64:79], v[40:43], v[48:51], v[64:79]
    ds_read_b64_tr_b16 v[16:17], v8 offset:4096
    ds_read_b64_tr_b16 v[18:19], v8 offset:4608
    s_waitcnt lgkmcnt(5)
    v_mfma_f32_32x32x16_bf16 v[80:95], v[40:43], v[52:55], v[80:95]
    ds_read_b128 v[24:27], v6 offset:0
    ds_read_b128 v[28:31], v6 offset:4096
    s_waitcnt lgkmcnt(6)
    v_mfma_f32_32x32x16_bf16 v[96:111], v[40:43], v[56:59], v[96:111]
    ds_read_b128 v[32:35], v6 offset:8192
    ds_read_b64_tr_b16 v[20:21], v11 offset:4096
    s_waitcnt lgkmcnt(6)
    v_mfma_f32_32x32x16_bf16 v[112:127], v[44:47], v[48:51], v[112:127]
    ds_read_b64_tr_b16 v[22:23], v11 offset:4608
    v_mfma_f32_32x32x16_bf16 v[128:143], v[44:47], v[52:55], v[128:143]
    v_mfma_f32_32x32x16_bf16 v[144:159], v[44:47], v[56:59], v[144:159]
    s_waitcnt lgkmcnt(4)
    v_mfma_f32_32x32x16_bf16 v[64:79], v[16:19], v[24:27], v[64:79]
    ds_read_b64_tr_b16 v[40:41], v8 offset:6144
    ds_read_b64_tr_b16 v[42:43], v8 offset:6656
    s_waitcnt lgkmcnt(5)
    v_mfma_f32_32x32x16_bf16 v[80:95], v[16:19], v[28:31], v[80:95]
    ds_read_b128 v[48:51], v7 offset:0
    ds_read_b128 v[52:55], v7 offset:4096
    s_waitcnt lgkmcnt(6)
    v_mfma_f32_32x32x16_bf16 v[96:111], v[16:19], v[32:35], v[96:111]
    ds_read_b128 v[56:59], v7 offset:8192
    ds_read_b64_tr_b16 v[44:45], v11 offset:6144
    s_waitcnt lgkmcnt(6)
    v_mfma_f32_32x32x16_bf16 v[112:127], v[20:23], v[24:27], v[112:127]
    ds_read_b64_tr_b16 v[46:47], v11 offset:6656
    v_mfma_f32_32x32x16_bf16 v[128:143], v[20:23], v[28:31], v[128:143]
    v_mfma_f32_32x32x16_bf16 v[144:159], v[20:23], v[32:35], v[144:159]
    s_waitcnt lgkmcnt(4)
    v_mfma_f32_32x32x16_bf16 v[64:79], v[40:43], v[48:51], v[64:79]
    s_waitcnt lgkmcnt(0)
    v_add_u32 v4, 0xa080, v4
    v_add_u32 v5, 0xa080, v5
    v_add_u32 v6, 0xa080, v6
    v_add_u32 v7, 0xa080, v7
    v_add_u32 v8, 0xa080, v8
    v_add_u32 v11, 0xa080, v11
    s_barrier
    v_mfma_f32_32x32x16_bf16 v[80:95], v[40:43], v[52:55], v[80:95]
    ds_read_b64_tr_b16 v[16:17], v8 offset:0
    ds_read_b64_tr_b16 v[18:19], v8 offset:512
    ds_read_b128 v[24:27], v4 offset:0
    v_mfma_f32_32x32x16_bf16 v[96:111], v[40:43], v[56:59], v[96:111]
    ds_read_b128 v[28:31], v4 offset:4096
    ds_read_b128 v[32:35], v4 offset:8192
    v_mfma_f32_32x32x16_bf16 v[112:127], v[44:47], v[48:51], v[112:127]
    ds_read_b64_tr_b16 v[20:21], v11 offset:0
    ds_read_b64_tr_b16 v[22:23], v11 offset:512
    v_mfma_f32_32x32x16_bf16 v[128:143], v[44:47], v[52:55], v[128:143]
    v_mfma_f32_32x32x16_bf16 v[144:159], v[44:47], v[56:59], v[144:159]
    s_waitcnt lgkmcnt(4)
    v_mfma_f32_32x32x16_bf16 v[64:79], v[16:19], v[24:27], v[64:79]
    ds_read_b64_tr_b16 v[40:41], v8 offset:2048
    ds_read_b64_tr_b16 v[42:43], v8 offset:2560
    s_waitcnt lgkmcnt(5)
    v_mfma_f32_32x32x16_bf16 v[80:95], v[16:19], v[28:31], v[80:95]
    ds_read_b128 v[48:51], v5 offset:0
    ds_read_b128 v[52:55], v5 offset:4096
    s_waitcnt lgkmcnt(6)
    v_mfma_f32_32x32x16_bf16 v[96:111], v[16:19], v[32:35], v[96:111]
    ds_read_b128 v[56:59], v5 offset:8192
    ds_read_b64_tr_b16 v[44:45], v11 offset:2048
    s_waitcnt lgkmcnt(6)
    v_mfma_f32_32x32x16_bf16 v[112:127], v[20:23], v[24:27], v[112:127]
    ds_read_b64_tr_b16 v[46:47], v11 offset:2560
    v_mfma_f32_32x32x16_bf16 v[128:143], v[20:23], v[28:31], v[128:143]
    v_mfma_f32_32x32x16_bf16 v[144:159], v[20:23], v[32:35], v[144:159]
    s_waitcnt lgkmcnt(4)
    v_mfma_f32_32x32x16_bf16 v[64:79], v[40:43], v[48:51], v[64:79]
    ds_read_b64_tr_b16 v[16:17], v8 offset:4096
    ds_read_b64_tr_b16 v[18:19], v8 offset:4608
    s_waitcnt lgkmcnt(5)
    v_mfma_f32_32x32x16_bf16 v[80:95], v[40:43], v[52:55], v[80:95]
    ds_read_b128 v[24:27], v6 offset:0
    ds_read_b128 v[28:31], v6 offset:4096
    s_waitcnt lgkmcnt(6)
    v_mfma_f32_32x32x16_bf16 v[96:111], v[40:43], v[56:59], v[96:111]
    ds_read_b128 v[32:35], v6 offset:8192
    ds_read_b64_tr_b16 v[20:21], v11 offset:4096
    s_waitcnt lgkmcnt(6)
    v_mfma_f32_32x32x16_bf16 v[112:127], v[44:47], v[48:51], v[112:127]
    ds_read_b64_tr_b16 v[22:23], v11 offset:4608
    v_mfma_f32_32x32x16_bf16 v[128:143], v[44:47], v[52:55], v[128:143]
    v_mfma_f32_32x32x16_bf16 v[144:159], v[44:47], v[56:59], v[144:159]
    s_waitcnt lgkmcnt(4)
    v_mfma_f32_32x32x16_bf16 v[64:79], v[16:19], v[24:27], v[64:79]
    ds_read_b64_tr_b16 v[40:41], v8 offset:6144
    ds_read_b64_tr_b16 v[42:43], v8 offset:6656
    s_waitcnt lgkmcnt(5)
    v_mfma_f32_32x32x16_bf16 v[80:95], v[16:19], v[28:31], v[80:95]
    ds_read_b128 v[48:51], v7 offset:0
    ds_read_b128 v[52:55], v7 offset:4096
    s_waitcnt lgkmcnt(6)
    v_mfma_f32_32x32x16_bf16 v[96:111], v[16:19], v[32:35], v[96:111]
    ds_read_b128 v[56:59], v7 offset:8192
    ds_read_b64_tr_b16 v[44:45], v11 offset:6144
    s_waitcnt lgkmcnt(6)
    v_mfma_f32_32x32x16_bf16 v[112:127], v[20:23], v[24:27], v[112:127]
    ds_read_b64_tr_b16 v[46:47], v11 offset:6656
    v_mfma_f32_32x32x16_bf16 v[128:143], v[20:23], v[28:31], v[128:143]
    v_mfma_f32_32x32x16_bf16 v[144:159], v[20:23], v[32:35], v[144:159]
    s_waitcnt lgkmcnt(4)
    v_mfma_f32_32x32x16_bf16 v[64:79], v[40:43], v[48:51], v[64:79]
    s_waitcnt lgkmcnt(0)
    v_add_u32 v4, 0xfffebf00, v4
    v_add_u32 v5, 0xfffebf00, v5
    v_add_u32 v6, 0xfffebf00, v6
    v_add_u32 v7, 0xfffebf00, v7
    v_add_u32 v8, 0xfffebf00, v8
    v_add_u32 v11, 0xfffebf00, v11
    s_barrier
    v_mfma_f32_32x32x16_bf16 v[80:95], v[40:43], v[52:55], v[80:95]
    ds_read_b64_tr_b16 v[16:17], v8 offset:0
    ds_read_b64_tr_b16 v[18:19], v8 offset:512
    ds_read_b128 v[24:27], v4 offset:0
    v_mfma_f32_32x32x16_bf16 v[96:111], v[40:43], v[56:59], v[96:111]
    ds_read_b128 v[28:31], v4 offset:4096
    ds_read_b128 v[32:35], v4 offset:8192
    v_mfma_f32_32x32x16_bf16 v[112:127], v[44:47], v[48:51], v[112:127]
    ds_read_b64_tr_b16 v[20:21], v11 offset:0
    ds_read_b64_tr_b16 v[22:23], v11 offset:512
    v_mfma_f32_32x32x16_bf16 v[128:143], v[44:47], v[52:55], v[128:143]
    v_mfma_f32_32x32x16_bf16 v[144:159], v[44:47], v[56:59], v[144:159]
    s_waitcnt lgkmcnt(4)
    v_mfma_f32_32x32x16_bf16 v[64:79], v[16:19], v[24:27], v[64:79]
    ds_read_b64_tr_b16 v[40:41], v8 offset:2048
    ds_read_b64_tr_b16 v[42:43], v8 offset:2560
    s_waitcnt lgkmcnt(5)
    v_mfma_f32_32x32x16_bf16 v[80:95], v[16:19], v[28:31], v[80:95]
    ds_read_b128 v[48:51], v5 offset:0
    ds_read_b128 v[52:55], v5 offset:4096
    s_waitcnt lgkmcnt(6)
    v_mfma_f32_32x32x16_bf16 v[96:111], v[16:19], v[32:35], v[96:111]
    ds_read_b128 v[56:59], v5 offset:8192
    ds_read_b64_tr_b16 v[44:45], v11 offset:2048
    s_waitcnt lgkmcnt(6)
    v_mfma_f32_32x32x16_bf16 v[112:127], v[20:23], v[24:27], v[112:127]
    ds_read_b64_tr_b16 v[46:47], v11 offset:2560
    v_mfma_f32_32x32x16_bf16 v[128:143], v[20:23], v[28:31], v[128:143]
    v_mfma_f32_32x32x16_bf16 v[144:159], v[20:23], v[32:35], v[144:159]
    s_waitcnt lgkmcnt(4)
    v_mfma_f32_32x32x16_bf16 v[64:79], v[40:43], v[48:51], v[64:79]
    ds_read_b64_tr_b16 v[16:17], v8 offset:4096
    ds_read_b64_tr_b16 v[18:19], v8 offset:4608
    s_waitcnt lgkmcnt(5)
    v_mfma_f32_32x32x16_bf16 v[80:95], v[40:43], v[52:55], v[80:95]
    ds_read_b128 v[24:27], v6 offset:0
    ds_read_b128 v[28:31], v6 offset:4096
    s_waitcnt lgkmcnt(6)
    v_mfma_f32_32x32x16_bf16 v[96:111], v[40:43], v[56:59], v[96:111]
    ds_read_b128 v[32:35], v6 offset:8192
    ds_read_b64_tr_b16 v[20:21], v11 offset:4096
    s_waitcnt lgkmcnt(6)
    v_mfma_f32_32x32x16_bf16 v[112:127], v[44:47], v[48:51], v[112:127]
    ds_read_b64_tr_b16 v[22:23], v11 offset:4608
    v_mfma_f32_32x32x16_bf16 v[128:143], v[44:47], v[52:55], v[128:143]
    v_mfma_f32_32x32x16_bf16 v[144:159], v[44:47], v[56:59], v[144:159]
    v_mov_b32 v9, 160672
    ds_read_b32 v250, v9
    s_waitcnt lgkmcnt(5)
    v_mfma_f32_32x32x16_bf16 v[64:79], v[16:19], v[24:27], v[64:79]
    ds_read_b64_tr_b16 v[40:41], v8 offset:6144
    ds_read_b64_tr_b16 v[42:43], v8 offset:6656
    s_waitcnt lgkmcnt(6)
    v_mfma_f32_32x32x16_bf16 v[80:95], v[16:19], v[28:31], v[80:95]
    ds_read_b128 v[48:51], v7 offset:0
    ds_read_b128 v[52:55], v7 offset:4096
    s_waitcnt lgkmcnt(7)
    v_mfma_f32_32x32x16_bf16 v[96:111], v[16:19], v[32:35], v[96:111]
    ds_read_b128 v[56:59], v7 offset:8192
    ds_read_b64_tr_b16 v[44:45], v11 offset:6144
    s_waitcnt lgkmcnt(7)
    v_mfma_f32_32x32x16_bf16 v[112:127], v[20:23], v[24:27], v[112:127]
    ds_read_b64_tr_b16 v[46:47], v11 offset:6656
    v_mfma_f32_32x32x16_bf16 v[128:143], v[20:23], v[28:31], v[128:143]
    v_mfma_f32_32x32x16_bf16 v[144:159], v[20:23], v[32:35], v[144:159]
    s_waitcnt lgkmcnt(4)
    v_mfma_f32_32x32x16_bf16 v[64:79], v[40:43], v[48:51], v[64:79]
    s_waitcnt lgkmcnt(0)
    v_add_u32 v4, 0xa080, v4
    v_add_u32 v5, 0xa080, v5
    v_add_u32 v6, 0xa080, v6
    v_add_u32 v7, 0xa080, v7
    v_add_u32 v8, 0xa080, v8
    v_add_u32 v11, 0xa080, v11
    s_barrier
    v_mfma_f32_32x32x16_bf16 v[80:95], v[40:43], v[52:55], v[80:95]
    ds_read_b64_tr_b16 v[16:17], v8 offset:0
    ds_read_b64_tr_b16 v[18:19], v8 offset:512
    ds_read_b128 v[24:27], v4 offset:0
    v_mfma_f32_32x32x16_bf16 v[96:111], v[40:43], v[56:59], v[96:111]
    ds_read_b128 v[28:31], v4 offset:4096
    ds_read_b128 v[32:35], v4 offset:8192
    v_mfma_f32_32x32x16_bf16 v[112:127], v[44:47], v[48:51], v[112:127]
    ds_read_b64_tr_b16 v[20:21], v11 offset:0
    ds_read_b64_tr_b16 v[22:23], v11 offset:512
    v_mfma_f32_32x32x16_bf16 v[128:143], v[44:47], v[52:55], v[128:143]
    v_mfma_f32_32x32x16_bf16 v[144:159], v[44:47], v[56:59], v[144:159]
    s_waitcnt lgkmcnt(4)
    v_mfma_f32_32x32x16_bf16 v[64:79], v[16:19], v[24:27], v[64:79]
    ds_read_b64_tr_b16 v[40:41], v8 offset:2048
    ds_read_b64_tr_b16 v[42:43], v8 offset:2560
    s_waitcnt lgkmcnt(5)
    v_mfma_f32_32x32x16_bf16 v[80:95], v[16:19], v[28:31], v[80:95]
    ds_read_b128 v[48:51], v5 offset:0
    ds_read_b128 v[52:55], v5 offset:4096
    s_waitcnt lgkmcnt(6)
    v_mfma_f32_32x32x16_bf16 v[96:111], v[16:19], v[32:35], v[96:111]
    ds_read_b128 v[56:59], v5 offset:8192
    ds_read_b64_tr_b16 v[44:45], v11 offset:2048
    s_waitcnt lgkmcnt(6)
    v_mfma_f32_32x32x16_bf16 v[112:127], v[20:23], v[24:27], v[112:127]
    ds_read_b64_tr_b16 v[46:47], v11 offset:2560
    v_mfma_f32_32x32x16_bf16 v[128:143], v[20:23], v[28:31], v[128:143]
    v_mfma_f32_32x32x16_bf16 v[144:159], v[20:23], v[32:35], v[144:159]
    s_waitcnt lgkmcnt(4)
    v_mfma_f32_32x32x16_bf16 v[64:79], v[40:43], v[48:51], v[64:79]
    ds_read_b64_tr_b16 v[16:17], v8 offset:4096
    ds_read_b64_tr_b16 v[18:19], v8 offset:4608
    s_waitcnt lgkmcnt(5)
    v_mfma_f32_32x32x16_bf16 v[80:95], v[40:43], v[52:55], v[80:95]
    ds_read_b128 v[24:27], v6 offset:0
    ds_read_b128 v[28:31], v6 offset:4096
    s_waitcnt lgkmcnt(6)
    v_mfma_f32_32x32x16_bf16 v[96:111], v[40:43], v[56:59], v[96:111]
    ds_read_b128 v[32:35], v6 offset:8192
    ds_read_b64_tr_b16 v[20:21], v11 offset:4096
    s_waitcnt lgkmcnt(6)
    v_mfma_f32_32x32x16_bf16 v[112:127], v[44:47], v[48:51], v[112:127]
    ds_read_b64_tr_b16 v[22:23], v11 offset:4608
    v_mfma_f32_32x32x16_bf16 v[128:143], v[44:47], v[52:55], v[128:143]
    v_mfma_f32_32x32x16_bf16 v[144:159], v[44:47], v[56:59], v[144:159]
    s_waitcnt lgkmcnt(4)
    v_mfma_f32_32x32x16_bf16 v[64:79], v[16:19], v[24:27], v[64:79]
    ds_read_b64_tr_b16 v[40:41], v8 offset:6144
    ds_read_b64_tr_b16 v[42:43], v8 offset:6656
    s_waitcnt lgkmcnt(5)
    v_mfma_f32_32x32x16_bf16 v[80:95], v[16:19], v[28:31], v[80:95]
    ds_read_b128 v[48:51], v7 offset:0
    ds_read_b128 v[52:55], v7 offset:4096
    s_waitcnt lgkmcnt(6)
    v_mfma_f32_32x32x16_bf16 v[96:111], v[16:19], v[32:35], v[96:111]
    ds_read_b128 v[56:59], v7 offset:8192
    ds_read_b64_tr_b16 v[44:45], v11 offset:6144
    s_waitcnt lgkmcnt(6)
    v_mfma_f32_32x32x16_bf16 v[112:127], v[20:23], v[24:27], v[112:127]
    ds_read_b64_tr_b16 v[46:47], v11 offset:6656
    v_mfma_f32_32x32x16_bf16 v[128:143], v[20:23], v[28:31], v[128:143]
    v_mfma_f32_32x32x16_bf16 v[144:159], v[20:23], v[32:35], v[144:159]
    s_waitcnt lgkmcnt(4)
    v_mfma_f32_32x32x16_bf16 v[64:79], v[40:43], v[48:51], v[64:79]
    s_waitcnt lgkmcnt(0)
    v_add_u32 v4, 0xa080, v4
    v_add_u32 v5, 0xa080, v5
    v_add_u32 v6, 0xa080, v6
    v_add_u32 v7, 0xa080, v7
    v_add_u32 v8, 0xa080, v8
    v_add_u32 v11, 0xa080, v11
    s_barrier
    v_mfma_f32_32x32x16_bf16 v[80:95], v[40:43], v[52:55], v[80:95]
    ds_read_b64_tr_b16 v[16:17], v8 offset:0
    ds_read_b64_tr_b16 v[18:19], v8 offset:512
    ds_read_b128 v[24:27], v4 offset:0
    v_mfma_f32_32x32x16_bf16 v[96:111], v[40:43], v[56:59], v[96:111]
    ds_read_b128 v[28:31], v4 offset:4096
    ds_read_b128 v[32:35], v4 offset:8192
    v_mfma_f32_32x32x16_bf16 v[112:127], v[44:47], v[48:51], v[112:127]
    ds_read_b64_tr_b16 v[20:21], v11 offset:0
    ds_read_b64_tr_b16 v[22:23], v11 offset:512
    v_mfma_f32_32x32x16_bf16 v[128:143], v[44:47], v[52:55], v[128:143]
    v_mfma_f32_32x32x16_bf16 v[144:159], v[44:47], v[56:59], v[144:159]
    s_waitcnt lgkmcnt(4)
    v_mfma_f32_32x32x16_bf16 v[64:79], v[16:19], v[24:27], v[64:79]
    ds_read_b64_tr_b16 v[40:41], v8 offset:2048
    ds_read_b64_tr_b16 v[42:43], v8 offset:2560
    s_waitcnt lgkmcnt(5)
    v_mfma_f32_32x32x16_bf16 v[80:95], v[16:19], v[28:31], v[80:95]
    ds_read_b128 v[48:51], v5 offset:0
    ds_read_b128 v[52:55], v5 offset:4096
    s_waitcnt lgkmcnt(6)
    v_mfma_f32_32x32x16_bf16 v[96:111], v[16:19], v[32:35], v[96:111]
    ds_read_b128 v[56:59], v5 offset:8192
    ds_read_b64_tr_b16 v[44:45], v11 offset:2048
    s_waitcnt lgkmcnt(6)
    v_mfma_f32_32x32x16_bf16 v[112:127], v[20:23], v[24:27], v[112:127]
    ds_read_b64_tr_b16 v[46:47], v11 offset:2560
    v_mfma_f32_32x32x16_bf16 v[128:143], v[20:23], v[28:31], v[128:143]
    v_mfma_f32_32x32x16_bf16 v[144:159], v[20:23], v[32:35], v[144:159]
    s_waitcnt lgkmcnt(4)
    v_mfma_f32_32x32x16_bf16 v[64:79], v[40:43], v[48:51], v[64:79]
    ds_read_b64_tr_b16 v[16:17], v8 offset:4096
    ds_read_b64_tr_b16 v[18:19], v8 offset:4608
    s_waitcnt lgkmcnt(5)
    v_mfma_f32_32x32x16_bf16 v[80:95], v[40:43], v[52:55], v[80:95]
    ds_read_b128 v[24:27], v6 offset:0
    ds_read_b128 v[28:31], v6 offset:4096
    s_waitcnt lgkmcnt(6)
    v_mfma_f32_32x32x16_bf16 v[96:111], v[40:43], v[56:59], v[96:111]
    ds_read_b128 v[32:35], v6 offset:8192
    ds_read_b64_tr_b16 v[20:21], v11 offset:4096
    s_waitcnt lgkmcnt(6)
    v_mfma_f32_32x32x16_bf16 v[112:127], v[44:47], v[48:51], v[112:127]
    ds_read_b64_tr_b16 v[22:23], v11 offset:4608
    v_mfma_f32_32x32x16_bf16 v[128:143], v[44:47], v[52:55], v[128:143]
    v_mfma_f32_32x32x16_bf16 v[144:159], v[44:47], v[56:59], v[144:159]
    s_waitcnt lgkmcnt(4)
    v_mfma_f32_32x32x16_bf16 v[64:79], v[16:19], v[24:27], v[64:79]
    ds_read_b64_tr_b16 v[40:41], v8 offset:6144
    ds_read_b64_tr_b16 v[42:43], v8 offset:6656
    s_waitcnt lgkmcnt(5)
    v_mfma_f32_32x32x16_bf16 v[80:95], v[16:19], v[28:31], v[80:95]
    ds_read_b128 v[48:51], v7 offset:0
    ds_read_b128 v[52:55], v7 offset:4096
    s_waitcnt lgkmcnt(6)
    v_mfma_f32_32x32x16_bf16 v[96:111], v[16:19], v[32:35], v[96:111]
    ds_read_b128 v[56:59], v7 offset:8192
    ds_read_b64_tr_b16 v[44:45], v11 offset:6144
    s_waitcnt lgkmcnt(6)
    v_mfma_f32_32x32x16_bf16 v[112:127], v[20:23], v[24:27], v[112:127]
    ds_read_b64_tr_b16 v[46:47], v11 offset:6656
    v_mfma_f32_32x32x16_bf16 v[128:143], v[20:23], v[28:31], v[128:143]
    v_mfma_f32_32x32x16_bf16 v[144:159], v[20:23], v[32:35], v[144:159]
    s_waitcnt lgkmcnt(4)
    v_mfma_f32_32x32x16_bf16 v[64:79], v[40:43], v[48:51], v[64:79]
    s_waitcnt lgkmcnt(0)
    v_add_u32 v4, 0xfffebf00, v4
    v_add_u32 v5, 0xfffebf00, v5
    v_add_u32 v6, 0xfffebf00, v6
    v_add_u32 v7, 0xfffebf00, v7
    v_add_u32 v8, 0xfffebf00, v8
    v_add_u32 v11, 0xfffebf00, v11
    s_barrier
    s_setprio 2
    v_mfma_f32_32x32x16_bf16 v[80:95], v[40:43], v[52:55], v[80:95]
    ds_read_b64_tr_b16 v[16:17], v8 offset:0
    ds_read_b64_tr_b16 v[18:19], v8 offset:512
    ds_read_b128 v[24:27], v4 offset:0
    v_mfma_f32_32x32x16_bf16 v[96:111], v[40:43], v[56:59], v[96:111]
    ds_read_b128 v[28:31], v4 offset:4096
    ds_read_b128 v[32:35], v4 offset:8192
    v_mfma_f32_32x32x16_bf16 v[112:127], v[44:47], v[48:51], v[112:127]
    ds_read_b64_tr_b16 v[20:21], v11 offset:0
    ds_read_b64_tr_b16 v[22:23], v11 offset:512
    v_mfma_f32_32x32x16_bf16 v[128:143], v[44:47], v[52:55], v[128:143]
    v_mfma_f32_32x32x16_bf16 v[144:159], v[44:47], v[56:59], v[144:159]
    s_waitcnt lgkmcnt(4)
    v_mfma_f32_32x32x16_bf16 v[64:79], v[16:19], v[24:27], v[64:79]
    ds_read_b64_tr_b16 v[40:41], v8 offset:2048
    ds_read_b64_tr_b16 v[42:43], v8 offset:2560
    s_waitcnt lgkmcnt(5)
    v_mfma_f32_32x32x16_bf16 v[80:95], v[16:19], v[28:31], v[80:95]
    ds_read_b128 v[48:51], v5 offset:0
    ds_read_b128 v[52:55], v5 offset:4096
    s_add_u32 s14, s86, 0
    buffer_load_dwordx4 v[160:163], v240, s[48:51], s14 offen offset:0 sc1
    s_waitcnt lgkmcnt(6)
    v_mfma_f32_32x32x16_bf16 v[96:111], v[16:19], v[32:35], v[96:111]
    ds_read_b128 v[56:59], v5 offset:8192
    ds_read_b64_tr_b16 v[44:45], v11 offset:2048
    buffer_load_dwordx4 v[164:167], v240, s[48:51], s14 offen offset:1024 sc1
    s_waitcnt lgkmcnt(6)
    v_mfma_f32_32x32x16_bf16 v[112:127], v[20:23], v[24:27], v[112:127]
    ds_read_b64_tr_b16 v[46:47], v11 offset:2560
    buffer_load_dwordx4 v[168:171], v240, s[48:51], s14 offen offset:2048 sc1
    v_mfma_f32_32x32x16_bf16 v[128:143], v[20:23], v[28:31], v[128:143]
    buffer_load_dwordx4 v[172:175], v240, s[48:51], s14 offen offset:3072 sc1
    v_mfma_f32_32x32x16_bf16 v[144:159], v[20:23], v[32:35], v[144:159]
    buffer_load_dwordx4 v[176:179], v241, s[48:51], s14 offen sc1
    s_waitcnt lgkmcnt(4)
    v_mfma_f32_32x32x16_bf16 v[64:79], v[40:43], v[48:51], v[64:79]
    ds_read_b64_tr_b16 v[16:17], v8 offset:4096
    ds_read_b64_tr_b16 v[18:19], v8 offset:4608
    s_add_u32 s14, s86, 5120
    buffer_load_dwordx4 v[180:183], v240, s[48:51], s14 offen offset:0 sc1
    s_waitcnt lgkmcnt(5)
    v_mfma_f32_32x32x16_bf16 v[80:95], v[40:43], v[52:55], v[80:95]
    ds_read_b128 v[24:27], v6 offset:0
    ds_read_b128 v[28:31], v6 offset:4096
    buffer_load_dwordx4 v[184:187], v240, s[48:51], s14 offen offset:1024 sc1
    s_waitcnt lgkmcnt(6)
    v_mfma_f32_32x32x16_bf16 v[96:111], v[40:43], v[56:59], v[96:111]
    ds_read_b128 v[32:35], v6 offset:8192
    ds_read_b64_tr_b16 v[20:21], v11 offset:4096
    buffer_load_dwordx4 v[188:191], v240, s[48:51], s14 offen offset:2048 sc1
    s_waitcnt lgkmcnt(6)
    v_mfma_f32_32x32x16_bf16 v[112:127], v[44:47], v[48:51], v[112:127]
    ds_read_b64_tr_b16 v[22:23], v11 offset:4608
    buffer_load_dwordx4 v[192:195], v240, s[48:51], s14 offen offset:3072 sc1
    v_mfma_f32_32x32x16_bf16 v[128:143], v[44:47], v[52:55], v[128:143]
    buffer_load_dwordx4 v[196:199], v241, s[48:51], s14 offen sc1
    v_mfma_f32_32x32x16_bf16 v[144:159], v[44:47], v[56:59], v[144:159]
    s_add_u32 s14, s86, 10240
    buffer_load_dwordx4 v[200:203], v240, s[48:51], s14 offen offset:0 sc1
    s_waitcnt lgkmcnt(4)
    v_mfma_f32_32x32x16_bf16 v[64:79], v[16:19], v[24:27], v[64:79]
    ds_read_b64_tr_b16 v[40:41], v8 offset:6144
    ds_read_b64_tr_b16 v[42:43], v8 offset:6656
    buffer_load_dwordx4 v[204:207], v240, s[48:51], s14 offen offset:1024 sc1
    s_waitcnt lgkmcnt(5)
    v_mfma_f32_32x32x16_bf16 v[80:95], v[16:19], v[28:31], v[80:95]
    ds_read_b128 v[48:51], v7 offset:0
    ds_read_b128 v[52:55], v7 offset:4096
    buffer_load_dwordx4 v[208:211], v240, s[48:51], s14 offen offset:2048 sc1
    s_waitcnt lgkmcnt(6)
    v_mfma_f32_32x32x16_bf16 v[96:111], v[16:19], v[32:35], v[96:111]
    ds_read_b128 v[56:59], v7 offset:8192
    ds_read_b64_tr_b16 v[44:45], v11 offset:6144
    buffer_load_dwordx4 v[212:215], v240, s[48:51], s14 offen offset:3072 sc1
    s_waitcnt lgkmcnt(6)
    v_mfma_f32_32x32x16_bf16 v[112:127], v[20:23], v[24:27], v[112:127]
    ds_read_b64_tr_b16 v[46:47], v11 offset:6656
    buffer_load_dwordx4 v[216:219], v241, s[48:51], s14 offen sc1
    v_mfma_f32_32x32x16_bf16 v[128:143], v[20:23], v[28:31], v[128:143]
    s_add_u32 s14, s86, 15360
    buffer_load_dwordx4 v[220:223], v240, s[48:51], s14 offen offset:0 sc1
    v_mfma_f32_32x32x16_bf16 v[144:159], v[20:23], v[32:35], v[144:159]
    buffer_load_dwordx4 v[224:227], v240, s[48:51], s14 offen offset:1024 sc1
    s_waitcnt lgkmcnt(4)
    v_mfma_f32_32x32x16_bf16 v[64:79], v[40:43], v[48:51], v[64:79]
    buffer_load_dwordx4 v[228:231], v240, s[48:51], s14 offen offset:2048 sc1
    s_waitcnt lgkmcnt(3)
    v_mfma_f32_32x32x16_bf16 v[80:95], v[40:43], v[52:55], v[80:95]
    buffer_load_dwordx4 v[232:235], v240, s[48:51], s14 offen offset:3072 sc1
    s_waitcnt lgkmcnt(2)
    v_mfma_f32_32x32x16_bf16 v[96:111], v[40:43], v[56:59], v[96:111]
    buffer_load_dwordx4 v[236:239], v241, s[48:51], s14 offen sc1
    s_waitcnt lgkmcnt(0)
    v_mfma_f32_32x32x16_bf16 v[112:127], v[44:47], v[48:51], v[112:127]
    v_mfma_f32_32x32x16_bf16 v[128:143], v[44:47], v[52:55], v[128:143]
    v_mfma_f32_32x32x16_bf16 v[144:159], v[44:47], v[56:59], v[144:159]
    s_nop 0
    v_mul_f32 v64, v64, v72
    v_mul_f32 v65, v65, v73
    v_mul_f32 v66, v66, v74
    v_mul_f32 v67, v67, v75
    v_mul_f32 v68, v68, v76
    v_mul_f32 v69, v69, v77
    v_mul_f32 v70, v70, v78
    v_mul_f32 v71, v71, v79
    v_cvt_pk_bf16_f32 v16, v64, v65
    v_cvt_pk_bf16_f32 v17, v66, v67
    v_cvt_pk_bf16_f32 v18, v68, v69
    v_cvt_pk_bf16_f32 v19, v70, v71
    buffer_store_dwordx4 v[16:19], v10, s[44:47], s76 offen offset:0 sc1
    v_mul_f32 v80, v80, v88
    v_mul_f32 v81, v81, v89
    v_mul_f32 v82, v82, v90
    v_mul_f32 v83, v83, v91
    v_mul_f32 v84, v84, v92
    v_mul_f32 v85, v85, v93
    v_mul_f32 v86, v86, v94
    v_mul_f32 v87, v87, v95
    v_cvt_pk_bf16_f32 v20, v80, v81
    v_cvt_pk_bf16_f32 v21, v82, v83
    v_cvt_pk_bf16_f32 v22, v84, v85
    v_cvt_pk_bf16_f32 v23, v86, v87
    buffer_store_dwordx4 v[20:23], v10, s[44:47], s77 offen offset:0 sc1
    v_mul_f32 v96, v96, v104
    v_mul_f32 v97, v97, v105
    v_mul_f32 v98, v98, v106
    v_mul_f32 v99, v99, v107
    v_mul_f32 v100, v100, v108
    v_mul_f32 v101, v101, v109
    v_mul_f32 v102, v102, v110
    v_mul_f32 v103, v103, v111
    v_cvt_pk_bf16_f32 v24, v96, v97
    v_cvt_pk_bf16_f32 v25, v98, v99
    v_cvt_pk_bf16_f32 v26, v100, v101
    v_cvt_pk_bf16_f32 v27, v102, v103
    buffer_store_dwordx4 v[24:27], v10, s[44:47], s78 offen offset:0 sc1
    v_mul_f32 v112, v112, v120
    v_mul_f32 v113, v113, v121
    v_mul_f32 v114, v114, v122
    v_mul_f32 v115, v115, v123
    v_mul_f32 v116, v116, v124
    v_mul_f32 v117, v117, v125
    v_mul_f32 v118, v118, v126
    v_mul_f32 v119, v119, v127
    v_cvt_pk_bf16_f32 v28, v112, v113
    v_cvt_pk_bf16_f32 v29, v114, v115
    v_cvt_pk_bf16_f32 v30, v116, v117
    v_cvt_pk_bf16_f32 v31, v118, v119
    buffer_store_dwordx4 v[28:31], v10, s[44:47], s76 offen offset:512 sc1
    v_mul_f32 v128, v128, v136
    v_mul_f32 v129, v129, v137
    v_mul_f32 v130, v130, v138
    v_mul_f32 v131, v131, v139
    v_mul_f32 v132, v132, v140
    v_mul_f32 v133, v133, v141
    v_mul_f32 v134, v134, v142
    v_mul_f32 v135, v135, v143
    v_cvt_pk_bf16_f32 v32, v128, v129
    v_cvt_pk_bf16_f32 v33, v130, v131
    v_cvt_pk_bf16_f32 v34, v132, v133
    v_cvt_pk_bf16_f32 v35, v134, v135
    buffer_store_dwordx4 v[32:35], v10, s[44:47], s77 offen offset:512 sc1
    v_mul_f32 v144, v144, v152
    v_mul_f32 v145, v145, v153
    v_mul_f32 v146, v146, v154
    v_mul_f32 v147, v147, v155
    v_mul_f32 v148, v148, v156
    v_mul_f32 v149, v149, v157
    v_mul_f32 v150, v150, v158
    v_mul_f32 v151, v151, v159
    v_cvt_pk_bf16_f32 v36, v144, v145
    v_cvt_pk_bf16_f32 v37, v146, v147
    v_cvt_pk_bf16_f32 v38, v148, v149
    v_cvt_pk_bf16_f32 v39, v150, v151
    buffer_store_dwordx4 v[36:39], v10, s[44:47], s78 offen offset:512 sc1
    s_branch LCjoin
LCodd:
    s_and_b32 s10, s3, 1
    s_lshr_b32 s11, s3, 1
    v_and_b32 v2, 31, v1
    v_lshrrev_b32 v3, 5, v1
    v_lshrrev_b32 v9, 1, v2
    v_and_b32 v9, 7, v9
    v_xor_b32 v9, v9, v3
    v_lshlrev_b32 v9, 4, v9
    v_lshl_add_u32 v9, v2, 7, v9
    s_lshl_b32 s12, s11, 13
    v_add_u32 v4, s12, v9
    v_xor_b32 v5, 32, v4
    v_xor_b32 v6, 64, v4
    v_xor_b32 v7, 96, v4
    v_bfe_u32 v9, v1, 4, 1
    v_mul_u32_u24 v8, 12320, v9
    v_bfe_u32 v9, v1, 2, 2
    v_lshl_add_u32 v9, v3, 3, v9
    v_mul_u32_u24 v9, 192, v9
    v_add_u32 v8, v8, v9
    v_and_b32 v9, 3, v1
    v_lshl_add_u32 v8, v9, 3, v8
    s_mul_i32 s12, s10, 96
    s_add_u32 s12, s12, 16384
    v_add_u32 v8, s12, v8
    v_lshrrev_b32 v9, 4, v2
    v_lshlrev_b32 v10, 10, v9
    v_lshl_add_u32 v10, v3, 8, v10
    v_and_b32 v9, 15, v2
    v_lshl_add_u32 v10, v9, 4, v10
    s_lshl_b32 s12, s7, 1
    s_add_u32 s12, s12, s11
    s_mul_i32 s13, s8, 6
    s_mul_i32 s14, s10, 3
    s_add_u32 s13, s13, s14
    s_mul_i32 s79, s12, 96
    s_add_u32 s79, s79, s13
    s_lshl_b32 s79, s79, 2
    s_add_u32 s79, s79, 2560
    s_mul_i32 s12, s12, 196608
    s_add_u32 s14, s13, 0
    s_lshr_b32 s15, s14, 1
    s_lshl_b32 s15, s15, 12
    s_and_b32 s14, s14, 1
    s_lshl_b32 s14, s14, 9
    s_add_u32 s14, s14, s15
    s_add_u32 s76, s14, s12
    s_add_u32 s14, s13, 1
    s_lshr_b32 s15, s14, 1
    s_lshl_b32 s15, s15, 12
    s_and_b32 s14, s14, 1
    s_lshl_b32 s14, s14, 9
    s_add_u32 s14, s14, s15
    s_add_u32 s77, s14, s12
    s_add_u32 s14, s13, 2
    s_lshr_b32 s15, s14, 1
    s_lshl_b32 s15, s15, 12
    s_and_b32 s14, s14, 1
    s_lshl_b32 s14, s14, 9
    s_add_u32 s14, s14, s15
    s_add_u32 s78, s14, s12
    v_lshlrev_b32 v249, 2, v1
    v_add_u32 v249, s79, v249
    v_cmp_gt_u32 vcc, 3, v1
    v_mov_b32 v9, 0x80000000
    s_nop 0
    v_cndmask_b32 v249, v9, v249, vcc
    s_lshl_b32 s84, s4, 2
    s_and_b32 s85, s5, 3
    s_add_u32 s84, s84, s85
    s_lshr_b32 s85, s5, 2
    s_mul_i32 s86, s85, 245760
    s_mul_i32 s96, s3, 61440
    s_add_u32 s86, s86, s96
    s_mul_i32 s87, s84, 196608
    s_mul_i32 s96, s3, 49152
    s_add_u32 s87, s87, s96
    s_mul_i32 s88, s3, 10240
    s_mul_i32 s83, s84, 384
    s_mul_i32 s96, s3, 96
    s_add_u32 s83, s83, s96
    s_add_u32 s83, s83, 2560
    s_lshr_b32 s97, s84, 3
    s_lshl_b32 s97, s97, 9
    s_and_b32 s96, s84, 7
    s_lshl_b32 s96, s96, 3
    s_add_u32 s97, s97, s96
    s_lshl_b32 s96, s3, 1
    s_add_u32 s97, s97, s96
    s_mul_i32 s89, s97, 1280
    s_mul_i32 s96, s85, 160
    s_add_u32 s89, s89, s96
    v_add_u32 v12, 0, v1
    v_mul_u32_u24 v13, 6554, v12
    v_lshrrev_b32 v13, 16, v13
    v_mul_u32_u24 v14, 10, v13
    v_sub_u32 v14, v12, v14
    v_and_b32 v15, 7, v13
    v_lshlrev_b32 v15, 6, v15
    v_lshrrev_b32 v13, 3, v13
    v_add_u32 v13, v13, v15
    v_mul_u32_u24 v13, 1280, v13
    v_lshl_add_u32 v242, v14, 4, v13
    v_add_u32 v12, 64, v1
    v_mul_u32_u24 v13, 6554, v12
    v_lshrrev_b32 v13, 16, v13
    v_mul_u32_u24 v14, 10, v13
    v_sub_u32 v14, v12, v14
    v_and_b32 v15, 7, v13
    v_lshlrev_b32 v15, 6, v15
    v_lshrrev_b32 v13, 3, v13
    v_add_u32 v13, v13, v15
    v_mul_u32_u24 v13, 1280, v13
    v_lshl_add_u32 v244, v14, 4, v13
    v_add_u32 v12, 128, v1
    v_mul_u32_u24 v13, 6554, v12
    v_lshrrev_b32 v13, 16, v13
    v_mul_u32_u24 v14, 10, v13
    v_sub_u32 v14, v12, v14
    v_and_b32 v15, 7, v13
    v_lshlrev_b32 v15, 6, v15
    v_lshrrev_b32 v13, 3, v13
    v_add_u32 v13, v13, v15
    v_mul_u32_u24 v13, 1280, v13
    v_lshl_add_u32 v245, v14, 4, v13
    v_cmp_gt_u32 vcc, 32, v1
    v_mov_b32 v14, 0x80000000
    s_nop 0
    v_cndmask_b32 v245, v14, v245, vcc
    v_lshlrev_b32 v240, 4, v1
    v_add_u32 v241, 4096, v240
    v_min_u32 v246, 23, v1
    v_lshlrev_b32 v246, 2, v246
    v_and_b32 v9, 31, v1
    v_lshlrev_b32 v9, 2, v9
    v_add_u32 v9, 160640, v9
    v_mov_b32 v12, 0
    ds_write_b32 v9, v12
    s_waitcnt lgkmcnt(0)
    s_mov_b32 s44, s42
    s_mov_b32 s45, s43
    s_mov_b32 s46, 0x600000
    s_mov_b32 s47, 0x00020000
    s_add_u32 s48, s42, 0x600000
    s_addc_u32 s49, s43, 0
    s_mov_b32 s50, 0x1e0000
    s_mov_b32 s51, 0x00020000
    s_mov_b32 s56, s38
    s_mov_b32 s57, s39
    s_mov_b32 s58, 0x280000
    s_mov_b32 s59, 0x00020000
    s_add_u32 s72, s42, 0xce4000
    s_addc_u32 s73, s43, 0
    s_mov_b32 s74, 0x4e00
    s_mov_b32 s75, 0x00020000
    v_cmp_eq_u32 vcc, 0, v1
    v_mov_b32 v248, 0x80000000
    s_nop 0
    v_cndmask_b32 v248, v248, 0, vcc
    s_setprio 0
    s_barrier
    ds_read_b64_tr_b16 v[16:17], v8 offset:0
    ds_read_b64_tr_b16 v[18:19], v8 offset:768
    ds_read_b128 v[28:31], v4 offset:0
    ds_read_b128 v[32:35], v4 offset:4096
    ds_read_b64_tr_b16 v[20:21], v8 offset:32
    ds_read_b64_tr_b16 v[22:23], v8 offset:800
    ds_read_b64_tr_b16 v[24:25], v8 offset:64
    ds_read_b64_tr_b16 v[26:27], v8 offset:832
    s_waitcnt lgkmcnt(5)
    v_mfma_f32_32x32x16_bf16 v[64:79], v[16:19], v[28:31], 0
    ds_read_b64_tr_b16 v[40:41], v8 offset:3072
    ds_read_b64_tr_b16 v[42:43], v8 offset:3840
    s_waitcnt lgkmcnt(6)
    v_mfma_f32_32x32x16_bf16 v[80:95], v[16:19], v[32:35], 0
    ds_read_b128 v[52:55], v5 offset:0
    ds_read_b128 v[56:59], v5 offset:4096
    s_waitcnt lgkmcnt(6)
    v_mfma_f32_32x32x16_bf16 v[96:111], v[20:23], v[28:31], 0
    ds_read_b64_tr_b16 v[44:45], v8 offset:3104
    ds_read_b64_tr_b16 v[46:47], v8 offset:3872
    v_mfma_f32_32x32x16_bf16 v[112:127], v[20:23], v[32:35], 0
    ds_read_b64_tr_b16 v[48:49], v8 offset:3136
    ds_read_b64_tr_b16 v[50:51], v8 offset:3904
    s_waitcnt lgkmcnt(8)
    v_mfma_f32_32x32x16_bf16 v[128:143], v[24:27], v[28:31], 0
    v_mfma_f32_32x32x16_bf16 v[144:159], v[24:27], v[32:35], 0
    s_waitcnt lgkmcnt(5)
    v_mfma_f32_32x32x16_bf16 v[64:79], v[40:43], v[52:55], v[64:79]
    ds_read_b64_tr_b16 v[16:17], v8 offset:6144
    ds_read_b64_tr_b16 v[18:19], v8 offset:6912
    s_waitcnt lgkmcnt(6)
    v_mfma_f32_32x32x16_bf16 v[80:95], v[40:43], v[56:59], v[80:95]
    ds_read_b128 v[28:31], v6 offset:0
    ds_read_b128 v[32:35], v6 offset:4096
    s_waitcnt lgkmcnt(6)
    v_mfma_f32_32x32x16_bf16 v[96:111], v[44:47], v[52:55], v[96:111]
    ds_read_b64_tr_b16 v[20:21], v8 offset:6176
    ds_read_b64_tr_b16 v[22:23], v8 offset:6944
    v_mfma_f32_32x32x16_bf16 v[112:127], v[44:47], v[56:59], v[112:127]
    ds_read_b64_tr_b16 v[24:25], v8 offset:6208
    ds_read_b64_tr_b16 v[26:27], v8 offset:6976
    s_waitcnt lgkmcnt(8)
    v_mfma_f32_32x32x16_bf16 v[128:143], v[48:51], v[52:55], v[128:143]
    v_mfma_f32_32x32x16_bf16 v[144:159], v[48:51], v[56:59], v[144:159]
    s_waitcnt lgkmcnt(5)
    v_mfma_f32_32x32x16_bf16 v[64:79], v[16:19], v[28:31], v[64:79]
    ds_read_b64_tr_b16 v[40:41], v8 offset:9216
    ds_read_b64_tr_b16 v[42:43], v8 offset:9984
    s_waitcnt lgkmcnt(6)
    v_mfma_f32_32x32x16_bf16 v[80:95], v[16:19], v[32:35], v[80:95]
    ds_read_b128 v[52:55], v7 offset:0
    ds_read_b128 v[56:59], v7 offset:4096
    s_waitcnt lgkmcnt(6)
    v_mfma_f32_32x32x16_bf16 v[96:111], v[20:23], v[28:31], v[96:111]
    ds_read_b64_tr_b16 v[44:45], v8 offset:9248
    ds_read_b64_tr_b16 v[46:47], v8 offset:10016
    v_mfma_f32_32x32x16_bf16 v[112:127], v[20:23], v[32:35], v[112:127]
    ds_read_b64_tr_b16 v[48:49], v8 offset:9280
    ds_read_b64_tr_b16 v[50:51], v8 offset:10048
    s_waitcnt lgkmcnt(8)
    v_mfma_f32_32x32x16_bf16 v[128:143], v[24:27], v[28:31], v[128:143]
    v_mfma_f32_32x32x16_bf16 v[144:159], v[24:27], v[32:35], v[144:159]
    s_waitcnt lgkmcnt(5)
    v_mfma_f32_32x32x16_bf16 v[64:79], v[40:43], v[52:55], v[64:79]
    s_waitcnt lgkmcnt(0)
    v_add_u32 v4, 0xa080, v4
    v_add_u32 v5, 0xa080, v5
    v_add_u32 v6, 0xa080, v6
    v_add_u32 v7, 0xa080, v7
    v_add_u32 v8, 0xa080, v8
    s_barrier
    v_mfma_f32_32x32x16_bf16 v[80:95], v[40:43], v[56:59], v[80:95]
    ds_read_b64_tr_b16 v[16:17], v8 offset:0
    ds_read_b64_tr_b16 v[18:19], v8 offset:768
    ds_read_b128 v[28:31], v4 offset:0
    v_mfma_f32_32x32x16_bf16 v[96:111], v[44:47], v[52:55], v[96:111]
    ds_read_b128 v[32:35], v4 offset:4096
    ds_read_b64_tr_b16 v[20:21], v8 offset:32
    v_mfma_f32_32x32x16_bf16 v[112:127], v[44:47], v[56:59], v[112:127]
    ds_read_b64_tr_b16 v[22:23], v8 offset:800
    ds_read_b64_tr_b16 v[24:25], v8 offset:64
    v_mfma_f32_32x32x16_bf16 v[128:143], v[48:51], v[52:55], v[128:143]
    ds_read_b64_tr_b16 v[26:27], v8 offset:832
    v_mfma_f32_32x32x16_bf16 v[144:159], v[48:51], v[56:59], v[144:159]
    s_waitcnt lgkmcnt(5)
    v_mfma_f32_32x32x16_bf16 v[64:79], v[16:19], v[28:31], v[64:79]
    ds_read_b64_tr_b16 v[40:41], v8 offset:3072
    ds_read_b64_tr_b16 v[42:43], v8 offset:3840
    s_waitcnt lgkmcnt(6)
    v_mfma_f32_32x32x16_bf16 v[80:95], v[16:19], v[32:35], v[80:95]
    ds_read_b128 v[52:55], v5 offset:0
    ds_read_b128 v[56:59], v5 offset:4096
    s_waitcnt lgkmcnt(6)
    v_mfma_f32_32x32x16_bf16 v[96:111], v[20:23], v[28:31], v[96:111]
    ds_read_b64_tr_b16 v[44:45], v8 offset:3104
    ds_read_b64_tr_b16 v[46:47], v8 offset:3872
    v_mfma_f32_32x32x16_bf16 v[112:127], v[20:23], v[32:35], v[112:127]
    ds_read_b64_tr_b16 v[48:49], v8 offset:3136
    ds_read_b64_tr_b16 v[50:51], v8 offset:3904
    s_waitcnt lgkmcnt(8)
    v_mfma_f32_32x32x16_bf16 v[128:143], v[24:27], v[28:31], v[128:143]
    v_mfma_f32_32x32x16_bf16 v[144:159], v[24:27], v[32:35], v[144:159]
    s_waitcnt lgkmcnt(5)
    v_mfma_f32_32x32x16_bf16 v[64:79], v[40:43], v[52:55], v[64:79]
    ds_read_b64_tr_b16 v[16:17], v8 offset:6144
    ds_read_b64_tr_b16 v[18:19], v8 offset:6912
    s_waitcnt lgkmcnt(6)
    v_mfma_f32_32x32x16_bf16 v[80:95], v[40:43], v[56:59], v[80:95]
    ds_read_b128 v[28:31], v6 offset:0
    ds_read_b128 v[32:35], v6 offset:4096
    s_waitcnt lgkmcnt(6)
    v_mfma_f32_32x32x16_bf16 v[96:111], v[44:47], v[52:55], v[96:111]
    ds_read_b64_tr_b16 v[20:21], v8 offset:6176
    ds_read_b64_tr_b16 v[22:23], v8 offset:6944
    v_mfma_f32_32x32x16_bf16 v[112:127], v[44:47], v[56:59], v[112:127]
    ds_read_b64_tr_b16 v[24:25], v8 offset:6208
    ds_read_b64_tr_b16 v[26:27], v8 offset:6976
    s_waitcnt lgkmcnt(8)
    v_mfma_f32_32x32x16_bf16 v[128:143], v[48:51], v[52:55], v[128:143]
    v_mfma_f32_32x32x16_bf16 v[144:159], v[48:51], v[56:59], v[144:159]
    s_waitcnt lgkmcnt(5)
    v_mfma_f32_32x32x16_bf16 v[64:79], v[16:19], v[28:31], v[64:79]
    ds_read_b64_tr_b16 v[40:41], v8 offset:9216
    ds_read_b64_tr_b16 v[42:43], v8 offset:9984
    s_waitcnt lgkmcnt(6)
    v_mfma_f32_32x32x16_bf16 v[80:95], v[16:19], v[32:35], v[80:95]
    ds_read_b128 v[52:55], v7 offset:0
    ds_read_b128 v[56:59], v7 offset:4096
    s_waitcnt lgkmcnt(6)
    v_mfma_f32_32x32x16_bf16 v[96:111], v[20:23], v[28:31], v[96:111]
    ds_read_b64_tr_b16 v[44:45], v8 offset:9248
    ds_read_b64_tr_b16 v[46:47], v8 offset:10016
    v_mfma_f32_32x32x16_bf16 v[112:127], v[20:23], v[32:35], v[112:127]
    ds_read_b64_tr_b16 v[48:49], v8 offset:9280
    ds_read_b64_tr_b16 v[50:51], v8 offset:10048
    s_waitcnt lgkmcnt(8)
    v_mfma_f32_32x32x16_bf16 v[128:143], v[24:27], v[28:31], v[128:143]
    v_mfma_f32_32x32x16_bf16 v[144:159], v[24:27], v[32:35], v[144:159]
    s_waitcnt lgkmcnt(5)
    v_mfma_f32_32x32x16_bf16 v[64:79], v[40:43], v[52:55], v[64:79]
    s_waitcnt lgkmcnt(0)
    v_add_u32 v4, 0xa080, v4
    v_add_u32 v5, 0xa080, v5
    v_add_u32 v6, 0xa080, v6
    v_add_u32 v7, 0xa080, v7
    v_add_u32 v8, 0xa080, v8
    s_barrier
    v_mfma_f32_32x32x16_bf16 v[80:95], v[40:43], v[56:59], v[80:95]
    ds_read_b64_tr_b16 v[16:17], v8 offset:0
    ds_read_b64_tr_b16 v[18:19], v8 offset:768
    ds_read_b128 v[28:31], v4 offset:0
    v_mfma_f32_32x32x16_bf16 v[96:111], v[44:47], v[52:55], v[96:111]
    ds_read_b128 v[32:35], v4 offset:4096
    ds_read_b64_tr_b16 v[20:21], v8 offset:32
    v_mfma_f32_32x32x16_bf16 v[112:127], v[44:47], v[56:59], v[112:127]
    ds_read_b64_tr_b16 v[22:23], v8 offset:800
    ds_read_b64_tr_b16 v[24:25], v8 offset:64
    v_mfma_f32_32x32x16_bf16 v[128:143], v[48:51], v[52:55], v[128:143]
    ds_read_b64_tr_b16 v[26:27], v8 offset:832
    v_mfma_f32_32x32x16_bf16 v[144:159], v[48:51], v[56:59], v[144:159]
    s_waitcnt lgkmcnt(5)
    v_mfma_f32_32x32x16_bf16 v[64:79], v[16:19], v[28:31], v[64:79]
    ds_read_b64_tr_b16 v[40:41], v8 offset:3072
    ds_read_b64_tr_b16 v[42:43], v8 offset:3840
    s_waitcnt lgkmcnt(6)
    v_mfma_f32_32x32x16_bf16 v[80:95], v[16:19], v[32:35], v[80:95]
    ds_read_b128 v[52:55], v5 offset:0
    ds_read_b128 v[56:59], v5 offset:4096
    s_waitcnt lgkmcnt(6)
    v_mfma_f32_32x32x16_bf16 v[96:111], v[20:23], v[28:31], v[96:111]
    ds_read_b64_tr_b16 v[44:45], v8 offset:3104
    ds_read_b64_tr_b16 v[46:47], v8 offset:3872
    v_mfma_f32_32x32x16_bf16 v[112:127], v[20:23], v[32:35], v[112:127]
    ds_read_b64_tr_b16 v[48:49], v8 offset:3136
    ds_read_b64_tr_b16 v[50:51], v8 offset:3904
    s_waitcnt lgkmcnt(8)
    v_mfma_f32_32x32x16_bf16 v[128:143], v[24:27], v[28:31], v[128:143]
    v_mfma_f32_32x32x16_bf16 v[144:159], v[24:27], v[32:35], v[144:159]
    s_waitcnt lgkmcnt(5)
    v_mfma_f32_32x32x16_bf16 v[64:79], v[40:43], v[52:55], v[64:79]
    ds_read_b64_tr_b16 v[16:17], v8 offset:6144
    ds_read_b64_tr_b16 v[18:19], v8 offset:6912
    s_waitcnt lgkmcnt(6)
    v_mfma_f32_32x32x16_bf16 v[80:95], v[40:43], v[56:59], v[80:95]
    ds_read_b128 v[28:31], v6 offset:0
    ds_read_b128 v[32:35], v6 offset:4096
    s_waitcnt lgkmcnt(6)
    v_mfma_f32_32x32x16_bf16 v[96:111], v[44:47], v[52:55], v[96:111]
    ds_read_b64_tr_b16 v[20:21], v8 offset:6176
    ds_read_b64_tr_b16 v[22:23], v8 offset:6944
    v_mfma_f32_32x32x16_bf16 v[112:127], v[44:47], v[56:59], v[112:127]
    ds_read_b64_tr_b16 v[24:25], v8 offset:6208
    ds_read_b64_tr_b16 v[26:27], v8 offset:6976
    s_waitcnt lgkmcnt(8)
    v_mfma_f32_32x32x16_bf16 v[128:143], v[48:51], v[52:55], v[128:143]
    v_mfma_f32_32x32x16_bf16 v[144:159], v[48:51], v[56:59], v[144:159]
    s_waitcnt lgkmcnt(5)
    v_mfma_f32_32x32x16_bf16 v[64:79], v[16:19], v[28:31], v[64:79]
    ds_read_b64_tr_b16 v[40:41], v8 offset:9216
    ds_read_b64_tr_b16 v[42:43], v8 offset:9984
    s_waitcnt lgkmcnt(6)
    v_mfma_f32_32x32x16_bf16 v[80:95], v[16:19], v[32:35], v[80:95]
    ds_read_b128 v[52:55], v7 offset:0
    ds_read_b128 v[56:59], v7 offset:4096
    s_waitcnt lgkmcnt(6)
    v_mfma_f32_32x32x16_bf16 v[96:111], v[20:23], v[28:31], v[96:111]
    ds_read_b64_tr_b16 v[44:45], v8 offset:9248
    ds_read_b64_tr_b16 v[46:47], v8 offset:10016
    v_mfma_f32_32x32x16_bf16 v[112:127], v[20:23], v[32:35], v[112:127]
    ds_read_b64_tr_b16 v[48:49], v8 offset:9280
    ds_read_b64_tr_b16 v[50:51], v8 offset:10048
    s_waitcnt lgkmcnt(8)
    v_mfma_f32_32x32x16_bf16 v[128:143], v[24:27], v[28:31], v[128:143]
    v_mfma_f32_32x32x16_bf16 v[144:159], v[24:27], v[32:35], v[144:159]
    s_waitcnt lgkmcnt(5)
    v_mfma_f32_32x32x16_bf16 v[64:79], v[40:43], v[52:55], v[64:79]
    s_waitcnt lgkmcnt(0)
    v_add_u32 v4, 0xfffebf00, v4
    v_add_u32 v5, 0xfffebf00, v5
    v_add_u32 v6, 0xfffebf00, v6
    v_add_u32 v7, 0xfffebf00, v7
    v_add_u32 v8, 0xfffebf00, v8
    s_barrier
    v_mfma_f32_32x32x16_bf16 v[80:95], v[40:43], v[56:59], v[80:95]
    ds_read_b64_tr_b16 v[16:17], v8 offset:0
    ds_read_b64_tr_b16 v[18:19], v8 offset:768
    ds_read_b128 v[28:31], v4 offset:0
    v_mfma_f32_32x32x16_bf16 v[96:111], v[44:47], v[52:55], v[96:111]
    ds_read_b128 v[32:35], v4 offset:4096
    ds_read_b64_tr_b16 v[20:21], v8 offset:32
    v_mfma_f32_32x32x16_bf16 v[112:127], v[44:47], v[56:59], v[112:127]
    ds_read_b64_tr_b16 v[22:23], v8 offset:800
    ds_read_b64_tr_b16 v[24:25], v8 offset:64
    v_mfma_f32_32x32x16_bf16 v[128:143], v[48:51], v[52:55], v[128:143]
    ds_read_b64_tr_b16 v[26:27], v8 offset:832
    v_mfma_f32_32x32x16_bf16 v[144:159], v[48:51], v[56:59], v[144:159]
    s_waitcnt lgkmcnt(5)
    v_mfma_f32_32x32x16_bf16 v[64:79], v[16:19], v[28:31], v[64:79]
    ds_read_b64_tr_b16 v[40:41], v8 offset:3072
    ds_read_b64_tr_b16 v[42:43], v8 offset:3840
    s_waitcnt lgkmcnt(6)
    v_mfma_f32_32x32x16_bf16 v[80:95], v[16:19], v[32:35], v[80:95]
    ds_read_b128 v[52:55], v5 offset:0
    ds_read_b128 v[56:59], v5 offset:4096
    s_waitcnt lgkmcnt(6)
    v_mfma_f32_32x32x16_bf16 v[96:111], v[20:23], v[28:31], v[96:111]
    ds_read_b64_tr_b16 v[44:45], v8 offset:3104
    ds_read_b64_tr_b16 v[46:47], v8 offset:3872
    v_mfma_f32_32x32x16_bf16 v[112:127], v[20:23], v[32:35], v[112:127]
    ds_read_b64_tr_b16 v[48:49], v8 offset:3136
    ds_read_b64_tr_b16 v[50:51], v8 offset:3904
    s_waitcnt lgkmcnt(8)
    v_mfma_f32_32x32x16_bf16 v[128:143], v[24:27], v[28:31], v[128:143]
    v_mfma_f32_32x32x16_bf16 v[144:159], v[24:27], v[32:35], v[144:159]
    s_waitcnt lgkmcnt(5)
    v_mfma_f32_32x32x16_bf16 v[64:79], v[40:43], v[52:55], v[64:79]
    ds_read_b64_tr_b16 v[16:17], v8 offset:6144
    ds_read_b64_tr_b16 v[18:19], v8 offset:6912
    s_waitcnt lgkmcnt(6)
    v_mfma_f32_32x32x16_bf16 v[80:95], v[40:43], v[56:59], v[80:95]
    ds_read_b128 v[28:31], v6 offset:0
    ds_read_b128 v[32:35], v6 offset:4096
    s_waitcnt lgkmcnt(6)
    v_mfma_f32_32x32x16_bf16 v[96:111], v[44:47], v[52:55], v[96:111]
    ds_read_b64_tr_b16 v[20:21], v8 offset:6176
    ds_read_b64_tr_b16 v[22:23], v8 offset:6944
    v_mfma_f32_32x32x16_bf16 v[112:127], v[44:47], v[56:59], v[112:127]
    ds_read_b64_tr_b16 v[24:25], v8 offset:6208
    ds_read_b64_tr_b16 v[26:27], v8 offset:6976
    s_waitcnt lgkmcnt(8)
    v_mfma_f32_32x32x16_bf16 v[128:143], v[48:51], v[52:55], v[128:143]
    v_mfma_f32_32x32x16_bf16 v[144:159], v[48:51], v[56:59], v[144:159]
    s_waitcnt lgkmcnt(5)
    v_mfma_f32_32x32x16_bf16 v[64:79], v[16:19], v[28:31], v[64:79]
    ds_read_b64_tr_b16 v[40:41], v8 offset:9216
    ds_read_b64_tr_b16 v[42:43], v8 offset:9984
    s_waitcnt lgkmcnt(6)
    v_mfma_f32_32x32x16_bf16 v[80:95], v[16:19], v[32:35], v[80:95]
    ds_read_b128 v[52:55], v7 offset:0
    ds_read_b128 v[56:59], v7 offset:4096
    s_waitcnt lgkmcnt(6)
    v_mfma_f32_32x32x16_bf16 v[96:111], v[20:23], v[28:31], v[96:111]
    ds_read_b64_tr_b16 v[44:45], v8 offset:9248
    ds_read_b64_tr_b16 v[46:47], v8 offset:10016
    v_mfma_f32_32x32x16_bf16 v[112:127], v[20:23], v[32:35], v[112:127]
    ds_read_b64_tr_b16 v[48:49], v8 offset:9280
    ds_read_b64_tr_b16 v[50:51], v8 offset:10048
    s_waitcnt lgkmcnt(8)
    v_mfma_f32_32x32x16_bf16 v[128:143], v[24:27], v[28:31], v[128:143]
    v_mfma_f32_32x32x16_bf16 v[144:159], v[24:27], v[32:35], v[144:159]
    s_waitcnt lgkmcnt(5)
    v_mfma_f32_32x32x16_bf16 v[64:79], v[40:43], v[52:55], v[64:79]
    s_waitcnt lgkmcnt(0)
    v_add_u32 v4, 0xa080, v4
    v_add_u32 v5, 0xa080, v5
    v_add_u32 v6, 0xa080, v6
    v_add_u32 v7, 0xa080, v7
    v_add_u32 v8, 0xa080, v8
    s_barrier
    v_mfma_f32_32x32x16_bf16 v[80:95], v[40:43], v[56:59], v[80:95]
    ds_read_b64_tr_b16 v[16:17], v8 offset:0
    ds_read_b64_tr_b16 v[18:19], v8 offset:768
    ds_read_b128 v[28:31], v4 offset:0
    v_mfma_f32_32x32x16_bf16 v[96:111], v[44:47], v[52:55], v[96:111]
    ds_read_b128 v[32:35], v4 offset:4096
    ds_read_b64_tr_b16 v[20:21], v8 offset:32
    v_mfma_f32_32x32x16_bf16 v[112:127], v[44:47], v[56:59], v[112:127]
    ds_read_b64_tr_b16 v[22:23], v8 offset:800
    ds_read_b64_tr_b16 v[24:25], v8 offset:64
    v_mfma_f32_32x32x16_bf16 v[128:143], v[48:51], v[52:55], v[128:143]
    ds_read_b64_tr_b16 v[26:27], v8 offset:832
    v_mfma_f32_32x32x16_bf16 v[144:159], v[48:51], v[56:59], v[144:159]
    s_waitcnt lgkmcnt(5)
    v_mfma_f32_32x32x16_bf16 v[64:79], v[16:19], v[28:31], v[64:79]
    ds_read_b64_tr_b16 v[40:41], v8 offset:3072
    ds_read_b64_tr_b16 v[42:43], v8 offset:3840
    s_waitcnt lgkmcnt(6)
    v_mfma_f32_32x32x16_bf16 v[80:95], v[16:19], v[32:35], v[80:95]
    ds_read_b128 v[52:55], v5 offset:0
    ds_read_b128 v[56:59], v5 offset:4096
    s_waitcnt lgkmcnt(6)
    v_mfma_f32_32x32x16_bf16 v[96:111], v[20:23], v[28:31], v[96:111]
    ds_read_b64_tr_b16 v[44:45], v8 offset:3104
    ds_read_b64_tr_b16 v[46:47], v8 offset:3872
    v_mfma_f32_32x32x16_bf16 v[112:127], v[20:23], v[32:35], v[112:127]
    ds_read_b64_tr_b16 v[48:49], v8 offset:3136
    ds_read_b64_tr_b16 v[50:51], v8 offset:3904
    s_waitcnt lgkmcnt(8)
    v_mfma_f32_32x32x16_bf16 v[128:143], v[24:27], v[28:31], v[128:143]
    v_mfma_f32_32x32x16_bf16 v[144:159], v[24:27], v[32:35], v[144:159]
    s_waitcnt lgkmcnt(5)
    v_mfma_f32_32x32x16_bf16 v[64:79], v[40:43], v[52:55], v[64:79]
    ds_read_b64_tr_b16 v[16:17], v8 offset:6144
    ds_read_b64_tr_b16 v[18:19], v8 offset:6912
    s_waitcnt lgkmcnt(6)
    v_mfma_f32_32x32x16_bf16 v[80:95], v[40:43], v[56:59], v[80:95]
    ds_read_b128 v[28:31], v6 offset:0
    ds_read_b128 v[32:35], v6 offset:4096
    s_waitcnt lgkmcnt(6)
    v_mfma_f32_32x32x16_bf16 v[96:111], v[44:47], v[52:55], v[96:111]
    ds_read_b64_tr_b16 v[20:21], v8 offset:6176
    ds_read_b64_tr_b16 v[22:23], v8 offset:6944
    v_mfma_f32_32x32x16_bf16 v[112:127], v[44:47], v[56:59], v[112:127]
    ds_read_b64_tr_b16 v[24:25], v8 offset:6208
    ds_read_b64_tr_b16 v[26:27], v8 offset:6976
    s_waitcnt lgkmcnt(8)
    v_mfma_f32_32x32x16_bf16 v[128:143], v[48:51], v[52:55], v[128:143]
    v_mfma_f32_32x32x16_bf16 v[144:159], v[48:51], v[56:59], v[144:159]
    s_waitcnt lgkmcnt(5)
    v_mfma_f32_32x32x16_bf16 v[64:79], v[16:19], v[28:31], v[64:79]
    ds_read_b64_tr_b16 v[40:41], v8 offset:9216
    ds_read_b64_tr_b16 v[42:43], v8 offset:9984
    s_waitcnt lgkmcnt(6)
    v_mfma_f32_32x32x16_bf16 v[80:95], v[16:19], v[32:35], v[80:95]
    ds_read_b128 v[52:55], v7 offset:0
    ds_read_b128 v[56:59], v7 offset:4096
    s_waitcnt lgkmcnt(6)
    v_mfma_f32_32x32x16_bf16 v[96:111], v[20:23], v[28:31], v[96:111]
    ds_read_b64_tr_b16 v[44:45], v8 offset:9248
    ds_read_b64_tr_b16 v[46:47], v8 offset:10016
    v_mfma_f32_32x32x16_bf16 v[112:127], v[20:23], v[32:35], v[112:127]
    ds_read_b64_tr_b16 v[48:49], v8 offset:9280
    ds_read_b64_tr_b16 v[50:51], v8 offset:10048
    s_waitcnt lgkmcnt(8)
    v_mfma_f32_32x32x16_bf16 v[128:143], v[24:27], v[28:31], v[128:143]
    v_mfma_f32_32x32x16_bf16 v[144:159], v[24:27], v[32:35], v[144:159]
    s_waitcnt lgkmcnt(5)
    v_mfma_f32_32x32x16_bf16 v[64:79], v[40:43], v[52:55], v[64:79]
    s_waitcnt lgkmcnt(0)
    v_add_u32 v4, 0xa080, v4
    v_add_u32 v5, 0xa080, v5
    v_add_u32 v6, 0xa080, v6
    v_add_u32 v7, 0xa080, v7
    v_add_u32 v8, 0xa080, v8
    s_barrier
    v_mfma_f32_32x32x16_bf16 v[80:95], v[40:43], v[56:59], v[80:95]
    ds_read_b64_tr_b16 v[16:17], v8 offset:0
    ds_read_b64_tr_b16 v[18:19], v8 offset:768
    ds_read_b128 v[28:31], v4 offset:0
    v_mfma_f32_32x32x16_bf16 v[96:111], v[44:47], v[52:55], v[96:111]
    ds_read_b128 v[32:35], v4 offset:4096
    ds_read_b64_tr_b16 v[20:21], v8 offset:32
    v_mfma_f32_32x32x16_bf16 v[112:127], v[44:47], v[56:59], v[112:127]
    ds_read_b64_tr_b16 v[22:23], v8 offset:800
    ds_read_b64_tr_b16 v[24:25], v8 offset:64
    v_mfma_f32_32x32x16_bf16 v[128:143], v[48:51], v[52:55], v[128:143]
    ds_read_b64_tr_b16 v[26:27], v8 offset:832
    v_mfma_f32_32x32x16_bf16 v[144:159], v[48:51], v[56:59], v[144:159]
    s_waitcnt lgkmcnt(5)
    v_mfma_f32_32x32x16_bf16 v[64:79], v[16:19], v[28:31], v[64:79]
    ds_read_b64_tr_b16 v[40:41], v8 offset:3072
    ds_read_b64_tr_b16 v[42:43], v8 offset:3840
    s_waitcnt lgkmcnt(6)
    v_mfma_f32_32x32x16_bf16 v[80:95], v[16:19], v[32:35], v[80:95]
    ds_read_b128 v[52:55], v5 offset:0
    ds_read_b128 v[56:59], v5 offset:4096
    s_waitcnt lgkmcnt(6)
    v_mfma_f32_32x32x16_bf16 v[96:111], v[20:23], v[28:31], v[96:111]
    ds_read_b64_tr_b16 v[44:45], v8 offset:3104
    ds_read_b64_tr_b16 v[46:47], v8 offset:3872
    v_mfma_f32_32x32x16_bf16 v[112:127], v[20:23], v[32:35], v[112:127]
    ds_read_b64_tr_b16 v[48:49], v8 offset:3136
    ds_read_b64_tr_b16 v[50:51], v8 offset:3904
    s_waitcnt lgkmcnt(8)
    v_mfma_f32_32x32x16_bf16 v[128:143], v[24:27], v[28:31], v[128:143]
    v_mfma_f32_32x32x16_bf16 v[144:159], v[24:27], v[32:35], v[144:159]
    s_waitcnt lgkmcnt(5)
    v_mfma_f32_32x32x16_bf16 v[64:79], v[40:43], v[52:55], v[64:79]
    ds_read_b64_tr_b16 v[16:17], v8 offset:6144
    ds_read_b64_tr_b16 v[18:19], v8 offset:6912
    s_waitcnt lgkmcnt(6)
    v_mfma_f32_32x32x16_bf16 v[80:95], v[40:43], v[56:59], v[80:95]
    ds_read_b128 v[28:31], v6 offset:0
    ds_read_b128 v[32:35], v6 offset:4096
    s_waitcnt lgkmcnt(6)
    v_mfma_f32_32x32x16_bf16 v[96:111], v[44:47], v[52:55], v[96:111]
    ds_read_b64_tr_b16 v[20:21], v8 offset:6176
    ds_read_b64_tr_b16 v[22:23], v8 offset:6944
    v_mfma_f32_32x32x16_bf16 v[112:127], v[44:47], v[56:59], v[112:127]
    ds_read_b64_tr_b16 v[24:25], v8 offset:6208
    ds_read_b64_tr_b16 v[26:27], v8 offset:6976
    s_waitcnt lgkmcnt(8)
    v_mfma_f32_32x32x16_bf16 v[128:143], v[48:51], v[52:55], v[128:143]
    v_mfma_f32_32x32x16_bf16 v[144:159], v[48:51], v[56:59], v[144:159]
    s_waitcnt lgkmcnt(5)
    v_mfma_f32_32x32x16_bf16 v[64:79], v[16:19], v[28:31], v[64:79]
    ds_read_b64_tr_b16 v[40:41], v8 offset:9216
    ds_read_b64_tr_b16 v[42:43], v8 offset:9984
    s_waitcnt lgkmcnt(6)
    v_mfma_f32_32x32x16_bf16 v[80:95], v[16:19], v[32:35], v[80:95]
    ds_read_b128 v[52:55], v7 offset:0
    ds_read_b128 v[56:59], v7 offset:4096
    s_waitcnt lgkmcnt(6)
    v_mfma_f32_32x32x16_bf16 v[96:111], v[20:23], v[28:31], v[96:111]
    ds_read_b64_tr_b16 v[44:45], v8 offset:9248
    ds_read_b64_tr_b16 v[46:47], v8 offset:10016
    v_mfma_f32_32x32x16_bf16 v[112:127], v[20:23], v[32:35], v[112:127]
    ds_read_b64_tr_b16 v[48:49], v8 offset:9280
    ds_read_b64_tr_b16 v[50:51], v8 offset:10048
    s_waitcnt lgkmcnt(8)
    v_mfma_f32_32x32x16_bf16 v[128:143], v[24:27], v[28:31], v[128:143]
    v_mfma_f32_32x32x16_bf16 v[144:159], v[24:27], v[32:35], v[144:159]
    s_waitcnt lgkmcnt(5)
    v_mfma_f32_32x32x16_bf16 v[64:79], v[40:43], v[52:55], v[64:79]
    s_waitcnt lgkmcnt(0)
    v_add_u32 v4, 0xfffebf00, v4
    v_add_u32 v5, 0xfffebf00, v5
    v_add_u32 v6, 0xfffebf00, v6
    v_add_u32 v7, 0xfffebf00, v7
    v_add_u32 v8, 0xfffebf00, v8
    s_barrier
    v_mfma_f32_32x32x16_bf16 v[80:95], v[40:43], v[56:59], v[80:95]
    ds_read_b64_tr_b16 v[16:17], v8 offset:0
    ds_read_b64_tr_b16 v[18:19], v8 offset:768
    ds_read_b128 v[28:31], v4 offset:0
    v_mfma_f32_32x32x16_bf16 v[96:111], v[44:47], v[52:55], v[96:111]
    ds_read_b128 v[32:35], v4 offset:4096
    ds_read_b64_tr_b16 v[20:21], v8 offset:32
    v_mfma_f32_32x32x16_bf16 v[112:127], v[44:47], v[56:59], v[112:127]
    ds_read_b64_tr_b16 v[22:23], v8 offset:800
    ds_read_b64_tr_b16 v[24:25], v8 offset:64
    v_mfma_f32_32x32x16_bf16 v[128:143], v[48:51], v[52:55], v[128:143]
    ds_read_b64_tr_b16 v[26:27], v8 offset:832
    v_mfma_f32_32x32x16_bf16 v[144:159], v[48:51], v[56:59], v[144:159]
    s_waitcnt lgkmcnt(5)
    v_mfma_f32_32x32x16_bf16 v[64:79], v[16:19], v[28:31], v[64:79]
    ds_read_b64_tr_b16 v[40:41], v8 offset:3072
    ds_read_b64_tr_b16 v[42:43], v8 offset:3840
    s_waitcnt lgkmcnt(6)
    v_mfma_f32_32x32x16_bf16 v[80:95], v[16:19], v[32:35], v[80:95]
    ds_read_b128 v[52:55], v5 offset:0
    ds_read_b128 v[56:59], v5 offset:4096
    s_waitcnt lgkmcnt(6)
    v_mfma_f32_32x32x16_bf16 v[96:111], v[20:23], v[28:31], v[96:111]
    ds_read_b64_tr_b16 v[44:45], v8 offset:3104
    ds_read_b64_tr_b16 v[46:47], v8 offset:3872
    v_mfma_f32_32x32x16_bf16 v[112:127], v[20:23], v[32:35], v[112:127]
    ds_read_b64_tr_b16 v[48:49], v8 offset:3136
    ds_read_b64_tr_b16 v[50:51], v8 offset:3904
    s_waitcnt lgkmcnt(8)
    v_mfma_f32_32x32x16_bf16 v[128:143], v[24:27], v[28:31], v[128:143]
    v_mfma_f32_32x32x16_bf16 v[144:159], v[24:27], v[32:35], v[144:159]
    s_waitcnt lgkmcnt(5)
    v_mfma_f32_32x32x16_bf16 v[64:79], v[40:43], v[52:55], v[64:79]
    ds_read_b64_tr_b16 v[16:17], v8 offset:6144
    ds_read_b64_tr_b16 v[18:19], v8 offset:6912
    s_waitcnt lgkmcnt(6)
    v_mfma_f32_32x32x16_bf16 v[80:95], v[40:43], v[56:59], v[80:95]
    ds_read_b128 v[28:31], v6 offset:0
    ds_read_b128 v[32:35], v6 offset:4096
    s_waitcnt lgkmcnt(6)
    v_mfma_f32_32x32x16_bf16 v[96:111], v[44:47], v[52:55], v[96:111]
    ds_read_b64_tr_b16 v[20:21], v8 offset:6176
    ds_read_b64_tr_b16 v[22:23], v8 offset:6944
    v_mfma_f32_32x32x16_bf16 v[112:127], v[44:47], v[56:59], v[112:127]
    ds_read_b64_tr_b16 v[24:25], v8 offset:6208
    ds_read_b64_tr_b16 v[26:27], v8 offset:6976
    s_waitcnt lgkmcnt(8)
    v_mfma_f32_32x32x16_bf16 v[128:143], v[48:51], v[52:55], v[128:143]
    v_mfma_f32_32x32x16_bf16 v[144:159], v[48:51], v[56:59], v[144:159]
    v_mov_b32 v9, 160672
    ds_read_b32 v250, v9
    s_waitcnt lgkmcnt(6)
    v_mfma_f32_32x32x16_bf16 v[64:79], v[16:19], v[28:31], v[64:79]
    ds_read_b64_tr_b16 v[40:41], v8 offset:9216
    ds_read_b64_tr_b16 v[42:43], v8 offset:9984
    s_waitcnt lgkmcnt(7)
    v_mfma_f32_32x32x16_bf16 v[80:95], v[16:19], v[32:35], v[80:95]
    ds_read_b128 v[52:55], v7 offset:0
    ds_read_b128 v[56:59], v7 offset:4096
    s_waitcnt lgkmcnt(7)
    v_mfma_f32_32x32x16_bf16 v[96:111], v[20:23], v[28:31], v[96:111]
    ds_read_b64_tr_b16 v[44:45], v8 offset:9248
    ds_read_b64_tr_b16 v[46:47], v8 offset:10016
    v_mfma_f32_32x32x16_bf16 v[112:127], v[20:23], v[32:35], v[112:127]
    ds_read_b64_tr_b16 v[48:49], v8 offset:9280
    ds_read_b64_tr_b16 v[50:51], v8 offset:10048
    s_waitcnt lgkmcnt(9)
    v_mfma_f32_32x32x16_bf16 v[128:143], v[24:27], v[28:31], v[128:143]
    v_mfma_f32_32x32x16_bf16 v[144:159], v[24:27], v[32:35], v[144:159]
    s_waitcnt lgkmcnt(5)
    v_mfma_f32_32x32x16_bf16 v[64:79], v[40:43], v[52:55], v[64:79]
    s_waitcnt lgkmcnt(0)
    v_add_u32 v4, 0xa080, v4
    v_add_u32 v5, 0xa080, v5
    v_add_u32 v6, 0xa080, v6
    v_add_u32 v7, 0xa080, v7
    v_add_u32 v8, 0xa080, v8
    s_barrier
    v_mfma_f32_32x32x16_bf16 v[80:95], v[40:43], v[56:59], v[80:95]
    ds_read_b64_tr_b16 v[16:17], v8 offset:0
    ds_read_b64_tr_b16 v[18:19], v8 offset:768
    ds_read_b128 v[28:31], v4 offset:0
    v_mfma_f32_32x32x16_bf16 v[96:111], v[44:47], v[52:55], v[96:111]
    ds_read_b128 v[32:35], v4 offset:4096
    ds_read_b64_tr_b16 v[20:21], v8 offset:32
    v_mfma_f32_32x32x16_bf16 v[112:127], v[44:47], v[56:59], v[112:127]
    ds_read_b64_tr_b16 v[22:23], v8 offset:800
    ds_read_b64_tr_b16 v[24:25], v8 offset:64
    v_mfma_f32_32x32x16_bf16 v[128:143], v[48:51], v[52:55], v[128:143]
    ds_read_b64_tr_b16 v[26:27], v8 offset:832
    v_mfma_f32_32x32x16_bf16 v[144:159], v[48:51], v[56:59], v[144:159]
    s_waitcnt lgkmcnt(5)
    v_mfma_f32_32x32x16_bf16 v[64:79], v[16:19], v[28:31], v[64:79]
    ds_read_b64_tr_b16 v[40:41], v8 offset:3072
    ds_read_b64_tr_b16 v[42:43], v8 offset:3840
    s_waitcnt lgkmcnt(6)
    v_mfma_f32_32x32x16_bf16 v[80:95], v[16:19], v[32:35], v[80:95]
    ds_read_b128 v[52:55], v5 offset:0
    ds_read_b128 v[56:59], v5 offset:4096
    s_waitcnt lgkmcnt(6)
    v_mfma_f32_32x32x16_bf16 v[96:111], v[20:23], v[28:31], v[96:111]
    ds_read_b64_tr_b16 v[44:45], v8 offset:3104
    ds_read_b64_tr_b16 v[46:47], v8 offset:3872
    v_mfma_f32_32x32x16_bf16 v[112:127], v[20:23], v[32:35], v[112:127]
    ds_read_b64_tr_b16 v[48:49], v8 offset:3136
    ds_read_b64_tr_b16 v[50:51], v8 offset:3904
    s_waitcnt lgkmcnt(8)
    v_mfma_f32_32x32x16_bf16 v[128:143], v[24:27], v[28:31], v[128:143]
    v_mfma_f32_32x32x16_bf16 v[144:159], v[24:27], v[32:35], v[144:159]
    s_waitcnt lgkmcnt(5)
    v_mfma_f32_32x32x16_bf16 v[64:79], v[40:43], v[52:55], v[64:79]
    ds_read_b64_tr_b16 v[16:17], v8 offset:6144
    ds_read_b64_tr_b16 v[18:19], v8 offset:6912
    s_waitcnt lgkmcnt(6)
    v_mfma_f32_32x32x16_bf16 v[80:95], v[40:43], v[56:59], v[80:95]
    ds_read_b128 v[28:31], v6 offset:0
    ds_read_b128 v[32:35], v6 offset:4096
    s_waitcnt lgkmcnt(6)
    v_mfma_f32_32x32x16_bf16 v[96:111], v[44:47], v[52:55], v[96:111]
    ds_read_b64_tr_b16 v[20:21], v8 offset:6176
    ds_read_b64_tr_b16 v[22:23], v8 offset:6944
    v_mfma_f32_32x32x16_bf16 v[112:127], v[44:47], v[56:59], v[112:127]
    ds_read_b64_tr_b16 v[24:25], v8 offset:6208
    ds_read_b64_tr_b16 v[26:27], v8 offset:6976
    s_waitcnt lgkmcnt(8)
    v_mfma_f32_32x32x16_bf16 v[128:143], v[48:51], v[52:55], v[128:143]
    v_mfma_f32_32x32x16_bf16 v[144:159], v[48:51], v[56:59], v[144:159]
    s_waitcnt lgkmcnt(5)
    v_mfma_f32_32x32x16_bf16 v[64:79], v[16:19], v[28:31], v[64:79]
    ds_read_b64_tr_b16 v[40:41], v8 offset:9216
    ds_read_b64_tr_b16 v[42:43], v8 offset:9984
    s_waitcnt lgkmcnt(6)
    v_mfma_f32_32x32x16_bf16 v[80:95], v[16:19], v[32:35], v[80:95]
    ds_read_b128 v[52:55], v7 offset:0
    ds_read_b128 v[56:59], v7 offset:4096
    s_waitcnt lgkmcnt(6)
    v_mfma_f32_32x32x16_bf16 v[96:111], v[20:23], v[28:31], v[96:111]
    ds_read_b64_tr_b16 v[44:45], v8 offset:9248
    ds_read_b64_tr_b16 v[46:47], v8 offset:10016
    v_mfma_f32_32x32x16_bf16 v[112:127], v[20:23], v[32:35], v[112:127]
    ds_read_b64_tr_b16 v[48:49], v8 offset:9280
    ds_read_b64_tr_b16 v[50:51], v8 offset:10048
    s_waitcnt lgkmcnt(8)
    v_mfma_f32_32x32x16_bf16 v[128:143], v[24:27], v[28:31], v[128:143]
    v_mfma_f32_32x32x16_bf16 v[144:159], v[24:27], v[32:35], v[144:159]
    s_waitcnt lgkmcnt(5)
    v_mfma_f32_32x32x16_bf16 v[64:79], v[40:43], v[52:55], v[64:79]
    s_waitcnt lgkmcnt(0)
    v_add_u32 v4, 0xa080, v4
    v_add_u32 v5, 0xa080, v5
    v_add_u32 v6, 0xa080, v6
    v_add_u32 v7, 0xa080, v7
    v_add_u32 v8, 0xa080, v8
    s_barrier
    v_mfma_f32_32x32x16_bf16 v[80:95], v[40:43], v[56:59], v[80:95]
    ds_read_b64_tr_b16 v[16:17], v8 offset:0
    ds_read_b64_tr_b16 v[18:19], v8 offset:768
    ds_read_b128 v[28:31], v4 offset:0
    v_mfma_f32_32x32x16_bf16 v[96:111], v[44:47], v[52:55], v[96:111]
    ds_read_b128 v[32:35], v4 offset:4096
    ds_read_b64_tr_b16 v[20:21], v8 offset:32
    v_mfma_f32_32x32x16_bf16 v[112:127], v[44:47], v[56:59], v[112:127]
    ds_read_b64_tr_b16 v[22:23], v8 offset:800
    ds_read_b64_tr_b16 v[24:25], v8 offset:64
    v_mfma_f32_32x32x16_bf16 v[128:143], v[48:51], v[52:55], v[128:143]
    ds_read_b64_tr_b16 v[26:27], v8 offset:832
    v_mfma_f32_32x32x16_bf16 v[144:159], v[48:51], v[56:59], v[144:159]
    s_waitcnt lgkmcnt(5)
    v_mfma_f32_32x32x16_bf16 v[64:79], v[16:19], v[28:31], v[64:79]
    ds_read_b64_tr_b16 v[40:41], v8 offset:3072
    ds_read_b64_tr_b16 v[42:43], v8 offset:3840
    s_waitcnt lgkmcnt(6)
    v_mfma_f32_32x32x16_bf16 v[80:95], v[16:19], v[32:35], v[80:95]
    ds_read_b128 v[52:55], v5 offset:0
    ds_read_b128 v[56:59], v5 offset:4096
    s_waitcnt lgkmcnt(6)
    v_mfma_f32_32x32x16_bf16 v[96:111], v[20:23], v[28:31], v[96:111]
    ds_read_b64_tr_b16 v[44:45], v8 offset:3104
    ds_read_b64_tr_b16 v[46:47], v8 offset:3872
    v_mfma_f32_32x32x16_bf16 v[112:127], v[20:23], v[32:35], v[112:127]
    ds_read_b64_tr_b16 v[48:49], v8 offset:3136
    ds_read_b64_tr_b16 v[50:51], v8 offset:3904
    s_waitcnt lgkmcnt(8)
    v_mfma_f32_32x32x16_bf16 v[128:143], v[24:27], v[28:31], v[128:143]
    v_mfma_f32_32x32x16_bf16 v[144:159], v[24:27], v[32:35], v[144:159]
    s_waitcnt lgkmcnt(5)
    v_mfma_f32_32x32x16_bf16 v[64:79], v[40:43], v[52:55], v[64:79]
    ds_read_b64_tr_b16 v[16:17], v8 offset:6144
    ds_read_b64_tr_b16 v[18:19], v8 offset:6912
    s_waitcnt lgkmcnt(6)
    v_mfma_f32_32x32x16_bf16 v[80:95], v[40:43], v[56:59], v[80:95]
    ds_read_b128 v[28:31], v6 offset:0
    ds_read_b128 v[32:35], v6 offset:4096
    s_waitcnt lgkmcnt(6)
    v_mfma_f32_32x32x16_bf16 v[96:111], v[44:47], v[52:55], v[96:111]
    ds_read_b64_tr_b16 v[20:21], v8 offset:6176
    ds_read_b64_tr_b16 v[22:23], v8 offset:6944
    v_mfma_f32_32x32x16_bf16 v[112:127], v[44:47], v[56:59], v[112:127]
    ds_read_b64_tr_b16 v[24:25], v8 offset:6208
    ds_read_b64_tr_b16 v[26:27], v8 offset:6976
    s_waitcnt lgkmcnt(8)
    v_mfma_f32_32x32x16_bf16 v[128:143], v[48:51], v[52:55], v[128:143]
    v_mfma_f32_32x32x16_bf16 v[144:159], v[48:51], v[56:59], v[144:159]
    s_waitcnt lgkmcnt(5)
    v_mfma_f32_32x32x16_bf16 v[64:79], v[16:19], v[28:31], v[64:79]
    ds_read_b64_tr_b16 v[40:41], v8 offset:9216
    ds_read_b64_tr_b16 v[42:43], v8 offset:9984
    s_waitcnt lgkmcnt(6)
    v_mfma_f32_32x32x16_bf16 v[80:95], v[16:19], v[32:35], v[80:95]
    ds_read_b128 v[52:55], v7 offset:0
    ds_read_b128 v[56:59], v7 offset:4096
    s_waitcnt lgkmcnt(6)
    v_mfma_f32_32x32x16_bf16 v[96:111], v[20:23], v[28:31], v[96:111]
    ds_read_b64_tr_b16 v[44:45], v8 offset:9248
    ds_read_b64_tr_b16 v[46:47], v8 offset:10016
    v_mfma_f32_32x32x16_bf16 v[112:127], v[20:23], v[32:35], v[112:127]
    ds_read_b64_tr_b16 v[48:49], v8 offset:9280
    ds_read_b64_tr_b16 v[50:51], v8 offset:10048
    s_waitcnt lgkmcnt(8)
    v_mfma_f32_32x32x16_bf16 v[128:143], v[24:27], v[28:31], v[128:143]
    v_mfma_f32_32x32x16_bf16 v[144:159], v[24:27], v[32:35], v[144:159]
    s_waitcnt lgkmcnt(5)
    v_mfma_f32_32x32x16_bf16 v[64:79], v[40:43], v[52:55], v[64:79]
    s_waitcnt lgkmcnt(0)
    v_add_u32 v4, 0xfffebf00, v4
    v_add_u32 v5, 0xfffebf00, v5
    v_add_u32 v6, 0xfffebf00, v6
    v_add_u32 v7, 0xfffebf00, v7
    v_add_u32 v8, 0xfffebf00, v8
    s_barrier
    s_setprio 2
    v_mfma_f32_32x32x16_bf16 v[80:95], v[40:43], v[56:59], v[80:95]
    ds_read_b64_tr_b16 v[16:17], v8 offset:0
    ds_read_b64_tr_b16 v[18:19], v8 offset:768
    ds_read_b128 v[28:31], v4 offset:0
    v_mfma_f32_32x32x16_bf16 v[96:111], v[44:47], v[52:55], v[96:111]
    ds_read_b128 v[32:35], v4 offset:4096
    ds_read_b64_tr_b16 v[20:21], v8 offset:32
    v_mfma_f32_32x32x16_bf16 v[112:127], v[44:47], v[56:59], v[112:127]
    ds_read_b64_tr_b16 v[22:23], v8 offset:800
    ds_read_b64_tr_b16 v[24:25], v8 offset:64
    v_mfma_f32_32x32x16_bf16 v[128:143], v[48:51], v[52:55], v[128:143]
    ds_read_b64_tr_b16 v[26:27], v8 offset:832
    v_mfma_f32_32x32x16_bf16 v[144:159], v[48:51], v[56:59], v[144:159]
    s_waitcnt lgkmcnt(5)
    v_mfma_f32_32x32x16_bf16 v[64:79], v[16:19], v[28:31], v[64:79]
    ds_read_b64_tr_b16 v[40:41], v8 offset:3072
    ds_read_b64_tr_b16 v[42:43], v8 offset:3840
    s_waitcnt lgkmcnt(6)
    v_mfma_f32_32x32x16_bf16 v[80:95], v[16:19], v[32:35], v[80:95]
    ds_read_b128 v[52:55], v5 offset:0
    ds_read_b128 v[56:59], v5 offset:4096
    s_add_u32 s14, s86, 0
    buffer_load_dwordx4 v[160:163], v240, s[48:51], s14 offen offset:0 sc1
    s_waitcnt lgkmcnt(6)
    v_mfma_f32_32x32x16_bf16 v[96:111], v[20:23], v[28:31], v[96:111]
    ds_read_b64_tr_b16 v[44:45], v8 offset:3104
    ds_read_b64_tr_b16 v[46:47], v8 offset:3872
    buffer_load_dwordx4 v[164:167], v240, s[48:51], s14 offen offset:1024 sc1
    v_mfma_f32_32x32x16_bf16 v[112:127], v[20:23], v[32:35], v[112:127]
    ds_read_b64_tr_b16 v[48:49], v8 offset:3136
    ds_read_b64_tr_b16 v[50:51], v8 offset:3904
    buffer_load_dwordx4 v[168:171], v240, s[48:51], s14 offen offset:2048 sc1
    s_waitcnt lgkmcnt(8)
    v_mfma_f32_32x32x16_bf16 v[128:143], v[24:27], v[28:31], v[128:143]
    buffer_load_dwordx4 v[172:175], v240, s[48:51], s14 offen offset:3072 sc1
    v_mfma_f32_32x32x16_bf16 v[144:159], v[24:27], v[32:35], v[144:159]
    buffer_load_dwordx4 v[176:179], v241, s[48:51], s14 offen sc1
    s_waitcnt lgkmcnt(5)
    v_mfma_f32_32x32x16_bf16 v[64:79], v[40:43], v[52:55], v[64:79]
    ds_read_b64_tr_b16 v[16:17], v8 offset:6144
    ds_read_b64_tr_b16 v[18:19], v8 offset:6912
    s_add_u32 s14, s86, 5120
    buffer_load_dwordx4 v[180:183], v240, s[48:51], s14 offen offset:0 sc1
    s_waitcnt lgkmcnt(6)
    v_mfma_f32_32x32x16_bf16 v[80:95], v[40:43], v[56:59], v[80:95]
    ds_read_b128 v[28:31], v6 offset:0
    ds_read_b128 v[32:35], v6 offset:4096
    buffer_load_dwordx4 v[184:187], v240, s[48:51], s14 offen offset:1024 sc1
    s_waitcnt lgkmcnt(6)
    v_mfma_f32_32x32x16_bf16 v[96:111], v[44:47], v[52:55], v[96:111]
    ds_read_b64_tr_b16 v[20:21], v8 offset:6176
    ds_read_b64_tr_b16 v[22:23], v8 offset:6944
    buffer_load_dwordx4 v[188:191], v240, s[48:51], s14 offen offset:2048 sc1
    v_mfma_f32_32x32x16_bf16 v[112:127], v[44:47], v[56:59], v[112:127]
    ds_read_b64_tr_b16 v[24:25], v8 offset:6208
    ds_read_b64_tr_b16 v[26:27], v8 offset:6976
    buffer_load_dwordx4 v[192:195], v240, s[48:51], s14 offen offset:3072 sc1
    s_waitcnt lgkmcnt(8)
    v_mfma_f32_32x32x16_bf16 v[128:143], v[48:51], v[52:55], v[128:143]
    buffer_load_dwordx4 v[196:199], v241, s[48:51], s14 offen sc1
    v_mfma_f32_32x32x16_bf16 v[144:159], v[48:51], v[56:59], v[144:159]
    s_add_u32 s14, s86, 10240
    buffer_load_dwordx4 v[200:203], v240, s[48:51], s14 offen offset:0 sc1
    s_waitcnt lgkmcnt(5)
    v_mfma_f32_32x32x16_bf16 v[64:79], v[16:19], v[28:31], v[64:79]
    ds_read_b64_tr_b16 v[40:41], v8 offset:9216
    ds_read_b64_tr_b16 v[42:43], v8 offset:9984
    buffer_load_dwordx4 v[204:207], v240, s[48:51], s14 offen offset:1024 sc1
    s_waitcnt lgkmcnt(6)
    v_mfma_f32_32x32x16_bf16 v[80:95], v[16:19], v[32:35], v[80:95]
    ds_read_b128 v[52:55], v7 offset:0
    ds_read_b128 v[56:59], v7 offset:4096
    buffer_load_dwordx4 v[208:211], v240, s[48:51], s14 offen offset:2048 sc1
    s_waitcnt lgkmcnt(6)
    v_mfma_f32_32x32x16_bf16 v[96:111], v[20:23], v[28:31], v[96:111]
    ds_read_b64_tr_b16 v[44:45], v8 offset:9248
    ds_read_b64_tr_b16 v[46:47], v8 offset:10016
    buffer_load_dwordx4 v[212:215], v240, s[48:51], s14 offen offset:3072 sc1
    v_mfma_f32_32x32x16_bf16 v[112:127], v[20:23], v[32:35], v[112:127]
    ds_read_b64_tr_b16 v[48:49], v8 offset:9280
    ds_read_b64_tr_b16 v[50:51], v8 offset:10048
    buffer_load_dwordx4 v[216:219], v241, s[48:51], s14 offen sc1
    s_waitcnt lgkmcnt(8)
    v_mfma_f32_32x32x16_bf16 v[128:143], v[24:27], v[28:31], v[128:143]
    s_add_u32 s14, s86, 15360
    buffer_load_dwordx4 v[220:223], v240, s[48:51], s14 offen offset:0 sc1
    v_mfma_f32_32x32x16_bf16 v[144:159], v[24:27], v[32:35], v[144:159]
    buffer_load_dwordx4 v[224:227], v240, s[48:51], s14 offen offset:1024 sc1
    s_waitcnt lgkmcnt(5)
    v_mfma_f32_32x32x16_bf16 v[64:79], v[40:43], v[52:55], v[64:79]
    buffer_load_dwordx4 v[228:231], v240, s[48:51], s14 offen offset:2048 sc1
    s_waitcnt lgkmcnt(4)
    v_mfma_f32_32x32x16_bf16 v[80:95], v[40:43], v[56:59], v[80:95]
    buffer_load_dwordx4 v[232:235], v240, s[48:51], s14 offen offset:3072 sc1
    s_waitcnt lgkmcnt(2)
    v_mfma_f32_32x32x16_bf16 v[96:111], v[44:47], v[52:55], v[96:111]
    buffer_load_dwordx4 v[236:239], v241, s[48:51], s14 offen sc1
    v_mfma_f32_32x32x16_bf16 v[112:127], v[44:47], v[56:59], v[112:127]
    s_waitcnt lgkmcnt(0)
    v_mfma_f32_32x32x16_bf16 v[128:143], v[48:51], v[52:55], v[128:143]
    v_mfma_f32_32x32x16_bf16 v[144:159], v[48:51], v[56:59], v[144:159]
    s_nop 0
    v_mul_f32 v64, v64, v72
    v_mul_f32 v65, v65, v73
    v_mul_f32 v66, v66, v74
    v_mul_f32 v67, v67, v75
    v_mul_f32 v68, v68, v76
    v_mul_f32 v69, v69, v77
    v_mul_f32 v70, v70, v78
    v_mul_f32 v71, v71, v79
    v_cvt_pk_bf16_f32 v16, v64, v65
    v_cvt_pk_bf16_f32 v17, v66, v67
    v_cvt_pk_bf16_f32 v18, v68, v69
    v_cvt_pk_bf16_f32 v19, v70, v71
    buffer_store_dwordx4 v[16:19], v10, s[44:47], s76 offen offset:0 sc1
    v_mul_f32 v80, v80, v88
    v_mul_f32 v81, v81, v89
    v_mul_f32 v82, v82, v90
    v_mul_f32 v83, v83, v91
    v_mul_f32 v84, v84, v92
    v_mul_f32 v85, v85, v93
    v_mul_f32 v86, v86, v94
    v_mul_f32 v87, v87, v95
    v_cvt_pk_bf16_f32 v20, v80, v81
    v_cvt_pk_bf16_f32 v21, v82, v83
    v_cvt_pk_bf16_f32 v22, v84, v85
    v_cvt_pk_bf16_f32 v23, v86, v87
    buffer_store_dwordx4 v[20:23], v10, s[44:47], s76 offen offset:2048 sc1
    v_mul_f32 v96, v96, v104
    v_mul_f32 v97, v97, v105
    v_mul_f32 v98, v98, v106
    v_mul_f32 v99, v99, v107
    v_mul_f32 v100, v100, v108
    v_mul_f32 v101, v101, v109
    v_mul_f32 v102, v102, v110
    v_mul_f32 v103, v103, v111
    v_cvt_pk_bf16_f32 v24, v96, v97
    v_cvt_pk_bf16_f32 v25, v98, v99
    v_cvt_pk_bf16_f32 v26, v100, v101
    v_cvt_pk_bf16_f32 v27, v102, v103
    buffer_store_dwordx4 v[24:27], v10, s[44:47], s77 offen offset:0 sc1
    v_mul_f32 v112, v112, v120
    v_mul_f32 v113, v113, v121
    v_mul_f32 v114, v114, v122
    v_mul_f32 v115, v115, v123
    v_mul_f32 v116, v116, v124
    v_mul_f32 v117, v117, v125
    v_mul_f32 v118, v118, v126
    v_mul_f32 v119, v119, v127
    v_cvt_pk_bf16_f32 v28, v112, v113
    v_cvt_pk_bf16_f32 v29, v114, v115
    v_cvt_pk_bf16_f32 v30, v116, v117
    v_cvt_pk_bf16_f32 v31, v118, v119
    buffer_store_dwordx4 v[28:31], v10, s[44:47], s77 offen offset:2048 sc1
    v_mul_f32 v128, v128, v136
    v_mul_f32 v129, v129, v137
    v_mul_f32 v130, v130, v138
    v_mul_f32 v131, v131, v139
    v_mul_f32 v132, v132, v140
    v_mul_f32 v133, v133, v141
    v_mul_f32 v134, v134, v142
    v_mul_f32 v135, v135, v143
    v_cvt_pk_bf16_f32 v32, v128, v129
    v_cvt_pk_bf16_f32 v33, v130, v131
    v_cvt_pk_bf16_f32 v34, v132, v133
    v_cvt_pk_bf16_f32 v35, v134, v135
    buffer_store_dwordx4 v[32:35], v10, s[44:47], s78 offen offset:0 sc1
    v_mul_f32 v144, v144, v152
    v_mul_f32 v145, v145, v153
    v_mul_f32 v146, v146, v154
    v_mul_f32 v147, v147, v155
    v_mul_f32 v148, v148, v156
    v_mul_f32 v149, v149, v157
    v_mul_f32 v150, v150, v158
    v_mul_f32 v151, v151, v159
    v_cvt_pk_bf16_f32 v36, v144, v145
    v_cvt_pk_bf16_f32 v37, v146, v147
    v_cvt_pk_bf16_f32 v38, v148, v149
    v_cvt_pk_bf16_f32 v39, v150, v151
    buffer_store_dwordx4 v[36:39], v10, s[44:47], s78 offen offset:2048 sc1
LCjoin:
    v_readfirstlane_b32 s92, v250
    v_add_u32 v4, s88, v240
    v_add_u32 v7, 41088, v4
    v_mov_b32 v5, 160640
    v_mov_b32 v6, 1
    v_cmp_eq_u32 vcc, 0, v1
    s_nop 0
    s_and_saveexec_b64 s[90:91], vcc
    ds_add_u32 v5, v6
    s_mov_b64 exec, s[90:91]
    s_mov_b32 s94, 200000
Lcsync:
    ds_read_b32 v6, v5
    s_waitcnt lgkmcnt(0)
    v_readfirstlane_b32 s82, v6
    s_nop 0
    s_cmp_ge_u32 s82, 4
    s_cbranch_scc1 Lcsync_ok
    s_sleep 1
    s_sub_u32 s94, s94, 1
    s_cmp_lg_u32 s94, 0
    s_cbranch_scc1 Lcsync
Lcsync_ok:
    s_lshl_b32 s96, s3, 2
    s_add_u32 s96, s96, 160688
    v_mov_b32 v5, s96
    s_mov_b32 s94, 200000
Lwok:
    ds_read_b32 v6, v5
    s_waitcnt lgkmcnt(0)
    v_readfirstlane_b32 s96, v6
    s_nop 0
    s_cmp_eq_u32 s96, 1
    s_cbranch_scc1 Lwok_ok
    s_sleep 1
    s_sub_u32 s94, s94, 1
    s_cmp_lg_u32 s94, 0
    s_cbranch_scc1 Lwok
Lwok_ok:
    s_add_u32 s14, s86, 30720
    s_add_u32 m0, s88, 0
    s_nop 0
    buffer_load_dwordx4 v240, s[48:51], s14 offen offset:0 sc1 lds
    buffer_load_dwordx4 v240, s[48:51], s14 offen offset:1024 sc1 lds
    buffer_load_dwordx4 v240, s[48:51], s14 offen offset:2048 sc1 lds
    buffer_load_dwordx4 v240, s[48:51], s14 offen offset:3072 sc1 lds
    s_add_u32 m0, s88, 4096
    s_nop 0
    buffer_load_dwordx4 v241, s[48:51], s14 offen sc1 lds
    s_add_u32 s14, s86, 35840
    s_add_u32 m0, s88, 5120
    s_nop 0
    buffer_load_dwordx4 v240, s[48:51], s14 offen offset:0 sc1 lds
    buffer_load_dwordx4 v240, s[48:51], s14 offen offset:1024 sc1 lds
    buffer_load_dwordx4 v240, s[48:51], s14 offen offset:2048 sc1 lds
    buffer_load_dwordx4 v240, s[48:51], s14 offen offset:3072 sc1 lds
    s_add_u32 m0, s88, 9216
    s_nop 0
    buffer_load_dwordx4 v241, s[48:51], s14 offen sc1 lds
    s_waitcnt vmcnt(10)
    buffer_store_dword v250, v249, s[72:75], 0 offen sc1
    s_setprio 0
    s_add_u32 s14, s86, 40960
    s_add_u32 m0, s88, 41088
    s_nop 0
    buffer_load_dwordx4 v240, s[48:51], s14 offen offset:0 sc1 lds
    buffer_load_dwordx4 v240, s[48:51], s14 offen offset:1024 sc1 lds
    buffer_load_dwordx4 v240, s[48:51], s14 offen offset:2048 sc1 lds
    buffer_load_dwordx4 v240, s[48:51], s14 offen offset:3072 sc1 lds
    s_add_u32 m0, s88, 45184
    s_nop 0
    buffer_load_dwordx4 v241, s[48:51], s14 offen sc1 lds
    s_add_u32 s14, s86, 46080
    s_add_u32 m0, s88, 46208
    s_nop 0
    buffer_load_dwordx4 v240, s[48:51], s14 offen offset:0 sc1 lds
    buffer_load_dwordx4 v240, s[48:51], s14 offen offset:1024 sc1 lds
    buffer_load_dwordx4 v240, s[48:51], s14 offen offset:2048 sc1 lds
    buffer_load_dwordx4 v240, s[48:51], s14 offen offset:3072 sc1 lds
    s_add_u32 m0, s88, 50304
    s_nop 0
    buffer_load_dwordx4 v241, s[48:51], s14 offen sc1 lds
    s_add_u32 s14, s86, 51200
    s_add_u32 m0, s88, 82176
    s_nop 0
    buffer_load_dwordx4 v240, s[48:51], s14 offen offset:0 sc1 lds
    buffer_load_dwordx4 v240, s[48:51], s14 offen offset:1024 sc1 lds
    buffer_load_dwordx4 v240, s[48:51], s14 offen offset:2048 sc1 lds
    buffer_load_dwordx4 v240, s[48:51], s14 offen offset:3072 sc1 lds
    s_add_u32 m0, s88, 86272
    s_nop 0
    buffer_load_dwordx4 v241, s[48:51], s14 offen sc1 lds
    s_add_u32 s14, s86, 56320
    s_add_u32 m0, s88, 87296
    s_nop 0
    buffer_load_dwordx4 v240, s[48:51], s14 offen offset:0 sc1 lds
    buffer_load_dwordx4 v240, s[48:51], s14 offen offset:1024 sc1 lds
    buffer_load_dwordx4 v240, s[48:51], s14 offen offset:2048 sc1 lds
    buffer_load_dwordx4 v240, s[48:51], s14 offen offset:3072 sc1 lds
    s_add_u32 m0, s88, 91392
    s_nop 0
    buffer_load_dwordx4 v241, s[48:51], s14 offen sc1 lds
    buffer_load_dword v247, v246, s[72:75], s83 offen sc1
    s_waitcnt vmcnt(0)
    s_mov_b32 s94, 200000
Lp_23:
    v_cmp_ne_u32 vcc, s92, v247
    s_nop 1
    s_cbranch_vccz Lp_ok_24
    s_sleep 2
    buffer_load_dword v247, v246, s[72:75], s83 offen sc1
    s_waitcnt vmcnt(0)
    s_sub_u32 s94, s94, 1
    s_cmp_lg_u32 s94, 0
    s_cbranch_scc1 Lp_23
Lp_ok_24:
    s_add_u32 s15, s87, 0
    buffer_load_dwordx4 v[8:11], v240, s[44:47], s15 offen offset:0 sc1
    buffer_load_dwordx4 v[12:15], v240, s[44:47], s15 offen offset:1024 sc1
    buffer_load_dwordx4 v[16:19], v240, s[44:47], s15 offen offset:2048 sc1
    buffer_load_dwordx4 v[20:23], v240, s[44:47], s15 offen offset:3072 sc1
    s_add_u32 s15, s87, 4096
    buffer_load_dwordx4 v[24:27], v240, s[44:47], s15 offen offset:0 sc1
    buffer_load_dwordx4 v[28:31], v240, s[44:47], s15 offen offset:1024 sc1
    buffer_load_dwordx4 v[32:35], v240, s[44:47], s15 offen offset:2048 sc1
    buffer_load_dwordx4 v[36:39], v240, s[44:47], s15 offen offset:3072 sc1
    s_add_u32 s15, s87, 8192
    buffer_load_dwordx4 v[40:43], v240, s[44:47], s15 offen offset:0 sc1
    buffer_load_dwordx4 v[44:47], v240, s[44:47], s15 offen offset:1024 sc1
    buffer_load_dwordx4 v[48:51], v240, s[44:47], s15 offen offset:2048 sc1
    buffer_load_dwordx4 v[52:55], v240, s[44:47], s15 offen offset:3072 sc1
    s_add_u32 s15, s87, 12288
    buffer_load_dwordx4 v[56:59], v240, s[44:47], s15 offen offset:0 sc1
    buffer_load_dwordx4 v[60:63], v240, s[44:47], s15 offen offset:1024 sc1
    buffer_load_dwordx4 v[64:67], v240, s[44:47], s15 offen offset:2048 sc1
    buffer_load_dwordx4 v[68:71], v240, s[44:47], s15 offen offset:3072 sc1
    s_waitcnt vmcnt(15)
    v_mfma_f32_16x16x32_bf16 v[72:75], v[160:163], v[8:11], 0
    v_mfma_f32_16x16x32_bf16 v[76:79], v[164:167], v[8:11], 0
    v_mfma_f32_16x16x32_bf16 v[80:83], v[168:171], v[8:11], 0
    v_mfma_f32_16x16x32_bf16 v[84:87], v[172:175], v[8:11], 0
    v_mfma_f32_16x16x32_bf16 v[88:91], v[176:179], v[8:11], 0
    s_waitcnt vmcnt(14)
    v_mfma_f32_16x16x32_bf16 v[92:95], v[160:163], v[12:15], 0
    v_mfma_f32_16x16x32_bf16 v[96:99], v[164:167], v[12:15], 0
    v_mfma_f32_16x16x32_bf16 v[100:103], v[168:171], v[12:15], 0
    v_mfma_f32_16x16x32_bf16 v[104:107], v[172:175], v[12:15], 0
    v_mfma_f32_16x16x32_bf16 v[108:111], v[176:179], v[12:15], 0
    s_waitcnt vmcnt(13)
    v_mfma_f32_16x16x32_bf16 v[112:115], v[160:163], v[16:19], 0
    v_mfma_f32_16x16x32_bf16 v[116:119], v[164:167], v[16:19], 0
    v_mfma_f32_16x16x32_bf16 v[120:123], v[168:171], v[16:19], 0
    v_mfma_f32_16x16x32_bf16 v[124:127], v[172:175], v[16:19], 0
    v_mfma_f32_16x16x32_bf16 v[128:131], v[176:179], v[16:19], 0
    s_waitcnt vmcnt(12)
    v_mfma_f32_16x16x32_bf16 v[132:135], v[160:163], v[20:23], 0
    v_mfma_f32_16x16x32_bf16 v[136:139], v[164:167], v[20:23], 0
    v_mfma_f32_16x16x32_bf16 v[140:143], v[168:171], v[20:23], 0
    v_mfma_f32_16x16x32_bf16 v[144:147], v[172:175], v[20:23], 0
    v_mfma_f32_16x16x32_bf16 v[148:151], v[176:179], v[20:23], 0
    s_add_u32 s15, s87, 16384
    buffer_load_dwordx4 v[8:11], v240, s[44:47], s15 offen offset:0 sc1
    buffer_load_dwordx4 v[12:15], v240, s[44:47], s15 offen offset:1024 sc1
    buffer_load_dwordx4 v[16:19], v240, s[44:47], s15 offen offset:2048 sc1
    buffer_load_dwordx4 v[20:23], v240, s[44:47], s15 offen offset:3072 sc1
    s_add_u32 s14, s86, 20480
    buffer_load_dwordx4 v[160:163], v240, s[48:51], s14 offen offset:0 sc1
    buffer_load_dwordx4 v[164:167], v240, s[48:51], s14 offen offset:1024 sc1
    buffer_load_dwordx4 v[168:171], v240, s[48:51], s14 offen offset:2048 sc1
    buffer_load_dwordx4 v[172:175], v240, s[48:51], s14 offen offset:3072 sc1
    buffer_load_dwordx4 v[176:179], v241, s[48:51], s14 offen sc1
    s_waitcnt vmcnt(20)
    v_mfma_f32_16x16x32_bf16 v[72:75], v[180:183], v[24:27], v[72:75]
    v_mfma_f32_16x16x32_bf16 v[76:79], v[184:187], v[24:27], v[76:79]
    v_mfma_f32_16x16x32_bf16 v[80:83], v[188:191], v[24:27], v[80:83]
    v_mfma_f32_16x16x32_bf16 v[84:87], v[192:195], v[24:27], v[84:87]
    v_mfma_f32_16x16x32_bf16 v[88:91], v[196:199], v[24:27], v[88:91]
    s_waitcnt vmcnt(19)
    v_mfma_f32_16x16x32_bf16 v[92:95], v[180:183], v[28:31], v[92:95]
    v_mfma_f32_16x16x32_bf16 v[96:99], v[184:187], v[28:31], v[96:99]
    v_mfma_f32_16x16x32_bf16 v[100:103], v[188:191], v[28:31], v[100:103]
    v_mfma_f32_16x16x32_bf16 v[104:107], v[192:195], v[28:31], v[104:107]
    v_mfma_f32_16x16x32_bf16 v[108:111], v[196:199], v[28:31], v[108:111]
    s_waitcnt vmcnt(18)
    v_mfma_f32_16x16x32_bf16 v[112:115], v[180:183], v[32:35], v[112:115]
    v_mfma_f32_16x16x32_bf16 v[116:119], v[184:187], v[32:35], v[116:119]
    v_mfma_f32_16x16x32_bf16 v[120:123], v[188:191], v[32:35], v[120:123]
    v_mfma_f32_16x16x32_bf16 v[124:127], v[192:195], v[32:35], v[124:127]
    v_mfma_f32_16x16x32_bf16 v[128:131], v[196:199], v[32:35], v[128:131]
    s_waitcnt vmcnt(17)
    v_mfma_f32_16x16x32_bf16 v[132:135], v[180:183], v[36:39], v[132:135]
    v_mfma_f32_16x16x32_bf16 v[136:139], v[184:187], v[36:39], v[136:139]
    v_mfma_f32_16x16x32_bf16 v[140:143], v[188:191], v[36:39], v[140:143]
    v_mfma_f32_16x16x32_bf16 v[144:147], v[192:195], v[36:39], v[144:147]
    v_mfma_f32_16x16x32_bf16 v[148:151], v[196:199], v[36:39], v[148:151]
    s_add_u32 s15, s87, 20480
    buffer_load_dwordx4 v[24:27], v240, s[44:47], s15 offen offset:0 sc1
    buffer_load_dwordx4 v[28:31], v240, s[44:47], s15 offen offset:1024 sc1
    buffer_load_dwordx4 v[32:35], v240, s[44:47], s15 offen offset:2048 sc1
    buffer_load_dwordx4 v[36:39], v240, s[44:47], s15 offen offset:3072 sc1
    s_add_u32 s14, s86, 25600
    buffer_load_dwordx4 v[180:183], v240, s[48:51], s14 offen offset:0 sc1
    buffer_load_dwordx4 v[184:187], v240, s[48:51], s14 offen offset:1024 sc1
    buffer_load_dwordx4 v[188:191], v240, s[48:51], s14 offen offset:2048 sc1
    buffer_load_dwordx4 v[192:195], v240, s[48:51], s14 offen offset:3072 sc1
    buffer_load_dwordx4 v[196:199], v241, s[48:51], s14 offen sc1
    s_waitcnt vmcnt(25)
    v_mfma_f32_16x16x32_bf16 v[72:75], v[200:203], v[40:43], v[72:75]
    v_mfma_f32_16x16x32_bf16 v[76:79], v[204:207], v[40:43], v[76:79]
    v_mfma_f32_16x16x32_bf16 v[80:83], v[208:211], v[40:43], v[80:83]
    v_mfma_f32_16x16x32_bf16 v[84:87], v[212:215], v[40:43], v[84:87]
    v_mfma_f32_16x16x32_bf16 v[88:91], v[216:219], v[40:43], v[88:91]
    s_waitcnt vmcnt(24)
    v_mfma_f32_16x16x32_bf16 v[92:95], v[200:203], v[44:47], v[92:95]
    v_mfma_f32_16x16x32_bf16 v[96:99], v[204:207], v[44:47], v[96:99]
    v_mfma_f32_16x16x32_bf16 v[100:103], v[208:211], v[44:47], v[100:103]
    v_mfma_f32_16x16x32_bf16 v[104:107], v[212:215], v[44:47], v[104:107]
    v_mfma_f32_16x16x32_bf16 v[108:111], v[216:219], v[44:47], v[108:111]
    s_waitcnt vmcnt(23)
    v_mfma_f32_16x16x32_bf16 v[112:115], v[200:203], v[48:51], v[112:115]
    v_mfma_f32_16x16x32_bf16 v[116:119], v[204:207], v[48:51], v[116:119]
    v_mfma_f32_16x16x32_bf16 v[120:123], v[208:211], v[48:51], v[120:123]
    v_mfma_f32_16x16x32_bf16 v[124:127], v[212:215], v[48:51], v[124:127]
    v_mfma_f32_16x16x32_bf16 v[128:131], v[216:219], v[48:51], v[128:131]
    s_waitcnt vmcnt(22)
    v_mfma_f32_16x16x32_bf16 v[132:135], v[200:203], v[52:55], v[132:135]
    v_mfma_f32_16x16x32_bf16 v[136:139], v[204:207], v[52:55], v[136:139]
    v_mfma_f32_16x16x32_bf16 v[140:143], v[208:211], v[52:55], v[140:143]
    v_mfma_f32_16x16x32_bf16 v[144:147], v[212:215], v[52:55], v[144:147]
    v_mfma_f32_16x16x32_bf16 v[148:151], v[216:219], v[52:55], v[148:151]
    s_add_u32 s15, s87, 24576
    buffer_load_dwordx4 v[40:43], v240, s[44:47], s15 offen offset:0 sc1
    buffer_load_dwordx4 v[44:47], v240, s[44:47], s15 offen offset:1024 sc1
    buffer_load_dwordx4 v[48:51], v240, s[44:47], s15 offen offset:2048 sc1
    buffer_load_dwordx4 v[52:55], v240, s[44:47], s15 offen offset:3072 sc1
    ds_read_b128 v[200:203], v4 offset:0
    ds_read_b128 v[204:207], v4 offset:1024
    ds_read_b128 v[208:211], v4 offset:2048
    ds_read_b128 v[212:215], v4 offset:3072
    ds_read_b128 v[216:219], v4 offset:4096
    s_lshl_b32 s96, s3, 2
    s_add_u32 s96, s96, 160704
    v_mov_b32 v5, s96
    v_mov_b32 v6, 1
    ds_write_b32 v5, v6
    s_waitcnt vmcnt(25)
    v_mfma_f32_16x16x32_bf16 v[72:75], v[220:223], v[56:59], v[72:75]
    v_mfma_f32_16x16x32_bf16 v[76:79], v[224:227], v[56:59], v[76:79]
    v_mfma_f32_16x16x32_bf16 v[80:83], v[228:231], v[56:59], v[80:83]
    v_mfma_f32_16x16x32_bf16 v[84:87], v[232:235], v[56:59], v[84:87]
    v_mfma_f32_16x16x32_bf16 v[88:91], v[236:239], v[56:59], v[88:91]
    s_waitcnt vmcnt(24)
    v_mfma_f32_16x16x32_bf16 v[92:95], v[220:223], v[60:63], v[92:95]
    v_mfma_f32_16x16x32_bf16 v[96:99], v[224:227], v[60:63], v[96:99]
    v_mfma_f32_16x16x32_bf16 v[100:103], v[228:231], v[60:63], v[100:103]
    v_mfma_f32_16x16x32_bf16 v[104:107], v[232:235], v[60:63], v[104:107]
    v_mfma_f32_16x16x32_bf16 v[108:111], v[236:239], v[60:63], v[108:111]
    s_waitcnt vmcnt(23)
    v_mfma_f32_16x16x32_bf16 v[112:115], v[220:223], v[64:67], v[112:115]
    v_mfma_f32_16x16x32_bf16 v[116:119], v[224:227], v[64:67], v[116:119]
    v_mfma_f32_16x16x32_bf16 v[120:123], v[228:231], v[64:67], v[120:123]
    v_mfma_f32_16x16x32_bf16 v[124:127], v[232:235], v[64:67], v[124:127]
    v_mfma_f32_16x16x32_bf16 v[128:131], v[236:239], v[64:67], v[128:131]
    s_waitcnt vmcnt(22)
    v_mfma_f32_16x16x32_bf16 v[132:135], v[220:223], v[68:71], v[132:135]
    v_mfma_f32_16x16x32_bf16 v[136:139], v[224:227], v[68:71], v[136:139]
    v_mfma_f32_16x16x32_bf16 v[140:143], v[228:231], v[68:71], v[140:143]
    v_mfma_f32_16x16x32_bf16 v[144:147], v[232:235], v[68:71], v[144:147]
    v_mfma_f32_16x16x32_bf16 v[148:151], v[236:239], v[68:71], v[148:151]
    s_add_u32 s15, s87, 28672
    buffer_load_dwordx4 v[56:59], v240, s[44:47], s15 offen offset:0 sc1
    buffer_load_dwordx4 v[60:63], v240, s[44:47], s15 offen offset:1024 sc1
    buffer_load_dwordx4 v[64:67], v240, s[44:47], s15 offen offset:2048 sc1
    buffer_load_dwordx4 v[68:71], v240, s[44:47], s15 offen offset:3072 sc1
    ds_read_b128 v[220:223], v4 offset:5120
    ds_read_b128 v[224:227], v4 offset:6144
    ds_read_b128 v[228:231], v4 offset:7168
    ds_read_b128 v[232:235], v4 offset:8192
    ds_read_b128 v[236:239], v4 offset:9216
    s_waitcnt vmcnt(17)
    v_mfma_f32_16x16x32_bf16 v[72:75], v[160:163], v[8:11], v[72:75]
    v_mfma_f32_16x16x32_bf16 v[76:79], v[164:167], v[8:11], v[76:79]
    v_mfma_f32_16x16x32_bf16 v[80:83], v[168:171], v[8:11], v[80:83]
    v_mfma_f32_16x16x32_bf16 v[84:87], v[172:175], v[8:11], v[84:87]
    v_mfma_f32_16x16x32_bf16 v[88:91], v[176:179], v[8:11], v[88:91]
    v_mfma_f32_16x16x32_bf16 v[92:95], v[160:163], v[12:15], v[92:95]
    v_mfma_f32_16x16x32_bf16 v[96:99], v[164:167], v[12:15], v[96:99]
    v_mfma_f32_16x16x32_bf16 v[100:103], v[168:171], v[12:15], v[100:103]
    v_mfma_f32_16x16x32_bf16 v[104:107], v[172:175], v[12:15], v[104:107]
    v_mfma_f32_16x16x32_bf16 v[108:111], v[176:179], v[12:15], v[108:111]
    v_mfma_f32_16x16x32_bf16 v[112:115], v[160:163], v[16:19], v[112:115]
    v_mfma_f32_16x16x32_bf16 v[116:119], v[164:167], v[16:19], v[116:119]
    v_mfma_f32_16x16x32_bf16 v[120:123], v[168:171], v[16:19], v[120:123]
    v_mfma_f32_16x16x32_bf16 v[124:127], v[172:175], v[16:19], v[124:127]
    v_mfma_f32_16x16x32_bf16 v[128:131], v[176:179], v[16:19], v[128:131]
    v_mfma_f32_16x16x32_bf16 v[132:135], v[160:163], v[20:23], v[132:135]
    v_mfma_f32_16x16x32_bf16 v[136:139], v[164:167], v[20:23], v[136:139]
    v_mfma_f32_16x16x32_bf16 v[140:143], v[168:171], v[20:23], v[140:143]
    v_mfma_f32_16x16x32_bf16 v[144:147], v[172:175], v[20:23], v[144:147]
    v_mfma_f32_16x16x32_bf16 v[148:151], v[176:179], v[20:23], v[148:151]
    s_add_u32 s15, s87, 32768
    buffer_load_dwordx4 v[8:11], v240, s[44:47], s15 offen offset:0 sc1
    buffer_load_dwordx4 v[12:15], v240, s[44:47], s15 offen offset:1024 sc1
    buffer_load_dwordx4 v[16:19], v240, s[44:47], s15 offen offset:2048 sc1
    buffer_load_dwordx4 v[20:23], v240, s[44:47], s15 offen offset:3072 sc1
    ds_read_b128 v[160:163], v7 offset:0
    ds_read_b128 v[164:167], v7 offset:1024
    ds_read_b128 v[168:171], v7 offset:2048
    ds_read_b128 v[172:175], v7 offset:3072
    ds_read_b128 v[176:179], v7 offset:4096
    s_waitcnt vmcnt(12)
    v_mfma_f32_16x16x32_bf16 v[72:75], v[180:183], v[24:27], v[72:75]
    v_mfma_f32_16x16x32_bf16 v[76:79], v[184:187], v[24:27], v[76:79]
    v_mfma_f32_16x16x32_bf16 v[80:83], v[188:191], v[24:27], v[80:83]
    v_mfma_f32_16x16x32_bf16 v[84:87], v[192:195], v[24:27], v[84:87]
    v_mfma_f32_16x16x32_bf16 v[88:91], v[196:199], v[24:27], v[88:91]
    v_mfma_f32_16x16x32_bf16 v[92:95], v[180:183], v[28:31], v[92:95]
    v_mfma_f32_16x16x32_bf16 v[96:99], v[184:187], v[28:31], v[96:99]
    v_mfma_f32_16x16x32_bf16 v[100:103], v[188:191], v[28:31], v[100:103]
    v_mfma_f32_16x16x32_bf16 v[104:107], v[192:195], v[28:31], v[104:107]
    v_mfma_f32_16x16x32_bf16 v[108:111], v[196:199], v[28:31], v[108:111]
    v_mfma_f32_16x16x32_bf16 v[112:115], v[180:183], v[32:35], v[112:115]
    v_mfma_f32_16x16x32_bf16 v[116:119], v[184:187], v[32:35], v[116:119]
    v_mfma_f32_16x16x32_bf16 v[120:123], v[188:191], v[32:35], v[120:123]
    v_mfma_f32_16x16x32_bf16 v[124:127], v[192:195], v[32:35], v[124:127]
    v_mfma_f32_16x16x32_bf16 v[128:131], v[196:199], v[32:35], v[128:131]
    v_mfma_f32_16x16x32_bf16 v[132:135], v[180:183], v[36:39], v[132:135]
    v_mfma_f32_16x16x32_bf16 v[136:139], v[184:187], v[36:39], v[136:139]
    v_mfma_f32_16x16x32_bf16 v[140:143], v[188:191], v[36:39], v[140:143]
    v_mfma_f32_16x16x32_bf16 v[144:147], v[192:195], v[36:39], v[144:147]
    v_mfma_f32_16x16x32_bf16 v[148:151], v[196:199], v[36:39], v[148:151]
    s_add_u32 s15, s87, 36864
    buffer_load_dwordx4 v[24:27], v240, s[44:47], s15 offen offset:0 sc1
    buffer_load_dwordx4 v[28:31], v240, s[44:47], s15 offen offset:1024 sc1
    buffer_load_dwordx4 v[32:35], v240, s[44:47], s15 offen offset:2048 sc1
    buffer_load_dwordx4 v[36:39], v240, s[44:47], s15 offen offset:3072 sc1
    ds_read_b128 v[180:183], v7 offset:5120
    ds_read_b128 v[184:187], v7 offset:6144
    ds_read_b128 v[188:191], v7 offset:7168
    ds_read_b128 v[192:195], v7 offset:8192
    ds_read_b128 v[196:199], v7 offset:9216
    s_waitcnt lgkmcnt(15)
    s_waitcnt vmcnt(15)
    v_mfma_f32_16x16x32_bf16 v[72:75], v[200:203], v[40:43], v[72:75]
    v_mfma_f32_16x16x32_bf16 v[76:79], v[204:207], v[40:43], v[76:79]
    v_mfma_f32_16x16x32_bf16 v[80:83], v[208:211], v[40:43], v[80:83]
    v_mfma_f32_16x16x32_bf16 v[84:87], v[212:215], v[40:43], v[84:87]
    v_mfma_f32_16x16x32_bf16 v[88:91], v[216:219], v[40:43], v[88:91]
    s_waitcnt vmcnt(14)
    v_mfma_f32_16x16x32_bf16 v[92:95], v[200:203], v[44:47], v[92:95]
    v_mfma_f32_16x16x32_bf16 v[96:99], v[204:207], v[44:47], v[96:99]
    v_mfma_f32_16x16x32_bf16 v[100:103], v[208:211], v[44:47], v[100:103]
    v_mfma_f32_16x16x32_bf16 v[104:107], v[212:215], v[44:47], v[104:107]
    v_mfma_f32_16x16x32_bf16 v[108:111], v[216:219], v[44:47], v[108:111]
    s_waitcnt vmcnt(13)
    v_mfma_f32_16x16x32_bf16 v[112:115], v[200:203], v[48:51], v[112:115]
    v_mfma_f32_16x16x32_bf16 v[116:119], v[204:207], v[48:51], v[116:119]
    v_mfma_f32_16x16x32_bf16 v[120:123], v[208:211], v[48:51], v[120:123]
    v_mfma_f32_16x16x32_bf16 v[124:127], v[212:215], v[48:51], v[124:127]
    v_mfma_f32_16x16x32_bf16 v[128:131], v[216:219], v[48:51], v[128:131]
    s_waitcnt vmcnt(12)
    v_mfma_f32_16x16x32_bf16 v[132:135], v[200:203], v[52:55], v[132:135]
    v_mfma_f32_16x16x32_bf16 v[136:139], v[204:207], v[52:55], v[136:139]
    v_mfma_f32_16x16x32_bf16 v[140:143], v[208:211], v[52:55], v[140:143]
    v_mfma_f32_16x16x32_bf16 v[144:147], v[212:215], v[52:55], v[144:147]
    v_mfma_f32_16x16x32_bf16 v[148:151], v[216:219], v[52:55], v[148:151]
    s_add_u32 s15, s87, 40960
    buffer_load_dwordx4 v[40:43], v240, s[44:47], s15 offen offset:0 sc1
    buffer_load_dwordx4 v[44:47], v240, s[44:47], s15 offen offset:1024 sc1
    buffer_load_dwordx4 v[48:51], v240, s[44:47], s15 offen offset:2048 sc1
    buffer_load_dwordx4 v[52:55], v240, s[44:47], s15 offen offset:3072 sc1
    ds_read_b128 v[200:203], v7 offset:41088
    ds_read_b128 v[204:207], v7 offset:42112
    ds_read_b128 v[208:211], v7 offset:43136
    ds_read_b128 v[212:215], v7 offset:44160
    ds_read_b128 v[216:219], v7 offset:45184
    s_waitcnt lgkmcnt(15)
    s_waitcnt vmcnt(15)
    v_mfma_f32_16x16x32_bf16 v[72:75], v[220:223], v[56:59], v[72:75]
    v_mfma_f32_16x16x32_bf16 v[76:79], v[224:227], v[56:59], v[76:79]
    v_mfma_f32_16x16x32_bf16 v[80:83], v[228:231], v[56:59], v[80:83]
    v_mfma_f32_16x16x32_bf16 v[84:87], v[232:235], v[56:59], v[84:87]
    v_mfma_f32_16x16x32_bf16 v[88:91], v[236:239], v[56:59], v[88:91]
    s_waitcnt vmcnt(14)
    v_mfma_f32_16x16x32_bf16 v[92:95], v[220:223], v[60:63], v[92:95]
    v_mfma_f32_16x16x32_bf16 v[96:99], v[224:227], v[60:63], v[96:99]
    v_mfma_f32_16x16x32_bf16 v[100:103], v[228:231], v[60:63], v[100:103]
    v_mfma_f32_16x16x32_bf16 v[104:107], v[232:235], v[60:63], v[104:107]
    v_mfma_f32_16x16x32_bf16 v[108:111], v[236:239], v[60:63], v[108:111]
    s_waitcnt vmcnt(13)
    v_mfma_f32_16x16x32_bf16 v[112:115], v[220:223], v[64:67], v[112:115]
    v_mfma_f32_16x16x32_bf16 v[116:119], v[224:227], v[64:67], v[116:119]
    v_mfma_f32_16x16x32_bf16 v[120:123], v[228:231], v[64:67], v[120:123]
    v_mfma_f32_16x16x32_bf16 v[124:127], v[232:235], v[64:67], v[124:127]
    v_mfma_f32_16x16x32_bf16 v[128:131], v[236:239], v[64:67], v[128:131]
    s_waitcnt vmcnt(12)
    v_mfma_f32_16x16x32_bf16 v[132:135], v[220:223], v[68:71], v[132:135]
    v_mfma_f32_16x16x32_bf16 v[136:139], v[224:227], v[68:71], v[136:139]
    v_mfma_f32_16x16x32_bf16 v[140:143], v[228:231], v[68:71], v[140:143]
    v_mfma_f32_16x16x32_bf16 v[144:147], v[232:235], v[68:71], v[144:147]
    v_mfma_f32_16x16x32_bf16 v[148:151], v[236:239], v[68:71], v[148:151]
    s_add_u32 s15, s87, 45056
    buffer_load_dwordx4 v[56:59], v240, s[44:47], s15 offen offset:0 sc1
    buffer_load_dwordx4 v[60:63], v240, s[44:47], s15 offen offset:1024 sc1
    buffer_load_dwordx4 v[64:67], v240, s[44:47], s15 offen offset:2048 sc1
    buffer_load_dwordx4 v[68:71], v240, s[44:47], s15 offen offset:3072 sc1
    ds_read_b128 v[220:223], v7 offset:46208
    ds_read_b128 v[224:227], v7 offset:47232
    ds_read_b128 v[228:231], v7 offset:48256
    ds_read_b128 v[232:235], v7 offset:49280
    ds_read_b128 v[236:239], v7 offset:50304
    s_waitcnt lgkmcnt(15)
    s_waitcnt vmcnt(15)
    v_mfma_f32_16x16x32_bf16 v[72:75], v[160:163], v[8:11], v[72:75]
    v_mfma_f32_16x16x32_bf16 v[76:79], v[164:167], v[8:11], v[76:79]
    v_mfma_f32_16x16x32_bf16 v[80:83], v[168:171], v[8:11], v[80:83]
    v_mfma_f32_16x16x32_bf16 v[84:87], v[172:175], v[8:11], v[84:87]
    v_mfma_f32_16x16x32_bf16 v[88:91], v[176:179], v[8:11], v[88:91]
    s_waitcnt vmcnt(14)
    v_mfma_f32_16x16x32_bf16 v[92:95], v[160:163], v[12:15], v[92:95]
    v_mfma_f32_16x16x32_bf16 v[96:99], v[164:167], v[12:15], v[96:99]
    v_mfma_f32_16x16x32_bf16 v[100:103], v[168:171], v[12:15], v[100:103]
    v_mfma_f32_16x16x32_bf16 v[104:107], v[172:175], v[12:15], v[104:107]
    v_mfma_f32_16x16x32_bf16 v[108:111], v[176:179], v[12:15], v[108:111]
    s_waitcnt vmcnt(13)
    v_mfma_f32_16x16x32_bf16 v[112:115], v[160:163], v[16:19], v[112:115]
    v_mfma_f32_16x16x32_bf16 v[116:119], v[164:167], v[16:19], v[116:119]
    v_mfma_f32_16x16x32_bf16 v[120:123], v[168:171], v[16:19], v[120:123]
    v_mfma_f32_16x16x32_bf16 v[124:127], v[172:175], v[16:19], v[124:127]
    v_mfma_f32_16x16x32_bf16 v[128:131], v[176:179], v[16:19], v[128:131]
    s_waitcnt vmcnt(12)
    v_mfma_f32_16x16x32_bf16 v[132:135], v[160:163], v[20:23], v[132:135]
    v_mfma_f32_16x16x32_bf16 v[136:139], v[164:167], v[20:23], v[136:139]
    v_mfma_f32_16x16x32_bf16 v[140:143], v[168:171], v[20:23], v[140:143]
    v_mfma_f32_16x16x32_bf16 v[144:147], v[172:175], v[20:23], v[144:147]
    v_mfma_f32_16x16x32_bf16 v[148:151], v[176:179], v[20:23], v[148:151]
    s_waitcnt lgkmcnt(10)
    s_waitcnt vmcnt(11)
    v_mfma_f32_16x16x32_bf16 v[72:75], v[180:183], v[24:27], v[72:75]
    v_mfma_f32_16x16x32_bf16 v[76:79], v[184:187], v[24:27], v[76:79]
    v_mfma_f32_16x16x32_bf16 v[80:83], v[188:191], v[24:27], v[80:83]
    v_mfma_f32_16x16x32_bf16 v[84:87], v[192:195], v[24:27], v[84:87]
    v_mfma_f32_16x16x32_bf16 v[88:91], v[196:199], v[24:27], v[88:91]
    s_waitcnt vmcnt(10)
    v_mfma_f32_16x16x32_bf16 v[92:95], v[180:183], v[28:31], v[92:95]
    v_mfma_f32_16x16x32_bf16 v[96:99], v[184:187], v[28:31], v[96:99]
    v_mfma_f32_16x16x32_bf16 v[100:103], v[188:191], v[28:31], v[100:103]
    v_mfma_f32_16x16x32_bf16 v[104:107], v[192:195], v[28:31], v[104:107]
    v_mfma_f32_16x16x32_bf16 v[108:111], v[196:199], v[28:31], v[108:111]
    s_waitcnt vmcnt(9)
    v_mfma_f32_16x16x32_bf16 v[112:115], v[180:183], v[32:35], v[112:115]
    v_mfma_f32_16x16x32_bf16 v[116:119], v[184:187], v[32:35], v[116:119]
    v_mfma_f32_16x16x32_bf16 v[120:123], v[188:191], v[32:35], v[120:123]
    v_mfma_f32_16x16x32_bf16 v[124:127], v[192:195], v[32:35], v[124:127]
    v_mfma_f32_16x16x32_bf16 v[128:131], v[196:199], v[32:35], v[128:131]
    s_waitcnt vmcnt(8)
    v_mfma_f32_16x16x32_bf16 v[132:135], v[180:183], v[36:39], v[132:135]
    v_mfma_f32_16x16x32_bf16 v[136:139], v[184:187], v[36:39], v[136:139]
    v_mfma_f32_16x16x32_bf16 v[140:143], v[188:191], v[36:39], v[140:143]
    v_mfma_f32_16x16x32_bf16 v[144:147], v[192:195], v[36:39], v[144:147]
    v_mfma_f32_16x16x32_bf16 v[148:151], v[196:199], v[36:39], v[148:151]
    s_waitcnt lgkmcnt(5)
    s_waitcnt vmcnt(7)
    v_mfma_f32_16x16x32_bf16 v[72:75], v[200:203], v[40:43], v[72:75]
    v_mfma_f32_16x16x32_bf16 v[76:79], v[204:207], v[40:43], v[76:79]
    v_mfma_f32_16x16x32_bf16 v[80:83], v[208:211], v[40:43], v[80:83]
    v_mfma_f32_16x16x32_bf16 v[84:87], v[212:215], v[40:43], v[84:87]
    v_mfma_f32_16x16x32_bf16 v[88:91], v[216:219], v[40:43], v[88:91]
    s_waitcnt vmcnt(6)
    v_mfma_f32_16x16x32_bf16 v[92:95], v[200:203], v[44:47], v[92:95]
    v_mfma_f32_16x16x32_bf16 v[96:99], v[204:207], v[44:47], v[96:99]
    v_mfma_f32_16x16x32_bf16 v[100:103], v[208:211], v[44:47], v[100:103]
    v_mfma_f32_16x16x32_bf16 v[104:107], v[212:215], v[44:47], v[104:107]
    v_mfma_f32_16x16x32_bf16 v[108:111], v[216:219], v[44:47], v[108:111]
    s_waitcnt vmcnt(5)
    v_mfma_f32_16x16x32_bf16 v[112:115], v[200:203], v[48:51], v[112:115]
    v_mfma_f32_16x16x32_bf16 v[116:119], v[204:207], v[48:51], v[116:119]
    v_mfma_f32_16x16x32_bf16 v[120:123], v[208:211], v[48:51], v[120:123]
    v_mfma_f32_16x16x32_bf16 v[124:127], v[212:215], v[48:51], v[124:127]
    v_mfma_f32_16x16x32_bf16 v[128:131], v[216:219], v[48:51], v[128:131]
    s_waitcnt vmcnt(4)
    v_mfma_f32_16x16x32_bf16 v[132:135], v[200:203], v[52:55], v[132:135]
    v_mfma_f32_16x16x32_bf16 v[136:139], v[204:207], v[52:55], v[136:139]
    v_mfma_f32_16x16x32_bf16 v[140:143], v[208:211], v[52:55], v[140:143]
    v_mfma_f32_16x16x32_bf16 v[144:147], v[212:215], v[52:55], v[144:147]
    v_mfma_f32_16x16x32_bf16 v[148:151], v[216:219], v[52:55], v[148:151]
    v_add_u32 v7, 41088, v240
    v_add_u32 v4, 41088, v7
    s_waitcnt lgkmcnt(0)
    s_waitcnt vmcnt(0)
    s_cmp_eq_u32 s3, 1
    s_cbranch_scc1 Lfin1
    s_cmp_eq_u32 s3, 2
    s_cbranch_scc1 Lfin2
    s_cmp_eq_u32 s3, 3
    s_cbranch_scc1 Lfin3
Lfin0:
    v_mfma_f32_16x16x32_bf16 v[92:95], v[220:223], v[60:63], v[92:95]
    v_mfma_f32_16x16x32_bf16 v[96:99], v[224:227], v[60:63], v[96:99]
    v_mfma_f32_16x16x32_bf16 v[100:103], v[228:231], v[60:63], v[100:103]
    v_mfma_f32_16x16x32_bf16 v[104:107], v[232:235], v[60:63], v[104:107]
    v_mfma_f32_16x16x32_bf16 v[108:111], v[236:239], v[60:63], v[108:111]
    v_mfma_f32_16x16x32_bf16 v[112:115], v[220:223], v[64:67], v[112:115]
    v_mfma_f32_16x16x32_bf16 v[116:119], v[224:227], v[64:67], v[116:119]
    s_nop 1
    ds_write_b128 v7, v[92:95] offset:0
    v_mfma_f32_16x16x32_bf16 v[120:123], v[228:231], v[64:67], v[120:123]
    ds_write_b128 v7, v[96:99] offset:1024
    v_mfma_f32_16x16x32_bf16 v[124:127], v[232:235], v[64:67], v[124:127]
    ds_write_b128 v7, v[100:103] offset:2048
    v_mfma_f32_16x16x32_bf16 v[128:131], v[236:239], v[64:67], v[128:131]
    ds_write_b128 v7, v[104:107] offset:3072
    v_mfma_f32_16x16x32_bf16 v[132:135], v[220:223], v[68:71], v[132:135]
    ds_write_b128 v7, v[108:111] offset:4096
    v_mfma_f32_16x16x32_bf16 v[136:139], v[224:227], v[68:71], v[136:139]
    ds_write_b128 v7, v[112:115] offset:5120
    v_mfma_f32_16x16x32_bf16 v[140:143], v[228:231], v[68:71], v[140:143]
    ds_write_b128 v7, v[116:119] offset:6144
    v_mfma_f32_16x16x32_bf16 v[144:147], v[232:235], v[68:71], v[144:147]
    ds_write_b128 v7, v[120:123] offset:7168
    v_mfma_f32_16x16x32_bf16 v[148:151], v[236:239], v[68:71], v[148:151]
    ds_write_b128 v7, v[124:127] offset:8192
    v_mfma_f32_16x16x32_bf16 v[72:75], v[220:223], v[56:59], v[72:75]
    ds_write_b128 v7, v[128:131] offset:9216
    v_mfma_f32_16x16x32_bf16 v[76:79], v[224:227], v[56:59], v[76:79]
    ds_write_b128 v4, v[132:135] offset:0
    v_mfma_f32_16x16x32_bf16 v[80:83], v[228:231], v[56:59], v[80:83]
    ds_write_b128 v4, v[136:139] offset:1024
    v_mfma_f32_16x16x32_bf16 v[84:87], v[232:235], v[56:59], v[84:87]
    ds_write_b128 v4, v[140:143] offset:2048
    v_mfma_f32_16x16x32_bf16 v[88:91], v[236:239], v[56:59], v[88:91]
    ds_write_b128 v4, v[144:147] offset:3072
    ds_write_b128 v4, v[148:151] offset:4096
    v_lshlrev_b32 v5, 3, v1
    v_add_u32 v5, 125824, v5
    v_lshlrev_b32 v3, 2, v1
    v_add_u32 v3, 146816, v3
    v_and_b32 v2, 15, v1
    v_mul_u32_u24 v2, 160, v2
    v_lshrrev_b32 v8, 4, v1
    v_lshl_add_u32 v2, v8, 3, v2
    v_add_u32 v2, 123264, v2
    v_add_u32 v8, 123264, v240
    s_waitcnt lgkmcnt(0)
    s_barrier
    ds_read_b32 v6, v3
    ds_read_b128 v[160:163], v7 offset:10240
    ds_read_b128 v[164:167], v7 offset:20480
    ds_read_b128 v[168:171], v7 offset:30720
    ds_read_b64 v[174:175], v5 offset:0
    ds_read_b128 v[176:179], v7 offset:11264
    ds_read_b128 v[180:183], v7 offset:21504
    ds_read_b128 v[184:187], v7 offset:31744
    ds_read_b64 v[190:191], v5 offset:512
    ds_read_b128 v[192:195], v7 offset:12288
    ds_read_b128 v[196:199], v7 offset:22528
    ds_read_b128 v[200:203], v7 offset:32768
    ds_read_b64 v[206:207], v5 offset:1024
    ds_read_b128 v[208:211], v7 offset:13312
    ds_read_b128 v[212:215], v7 offset:23552
    ds_read_b128 v[216:219], v7 offset:33792
    ds_read_b64 v[222:223], v5 offset:1536
    ds_read_b128 v[224:227], v7 offset:14336
    ds_read_b128 v[228:231], v7 offset:24576
    ds_read_b128 v[232:235], v7 offset:34816
    ds_read_b64 v[238:239], v5 offset:2048
    s_waitcnt lgkmcnt(15)
    v_pk_add_f32 v[72:73], v[72:73], v[160:161]
    v_pk_add_f32 v[74:75], v[74:75], v[162:163]
    v_pk_add_f32 v[72:73], v[72:73], v[164:165]
    v_pk_add_f32 v[74:75], v[74:75], v[166:167]
    v_pk_add_f32 v[72:73], v[72:73], v[168:169]
    v_pk_add_f32 v[74:75], v[74:75], v[170:171]
    v_lshlrev_b32 v172, 16, v174
    v_and_b32 v173, 0xffff0000, v174
    v_lshlrev_b32 v174, 16, v175
    v_and_b32 v175, 0xffff0000, v175
    v_fma_f32 v72, v6, v72, v172
    v_fma_f32 v73, v6, v73, v173
    v_fma_f32 v74, v6, v74, v174
    v_fma_f32 v75, v6, v75, v175
    v_cvt_pk_bf16_f32 v12, v72, v73
    v_cvt_pk_bf16_f32 v13, v74, v75
    ds_write_b64 v2, v[12:13] offset:0
    v_pk_add_f32 v[76:77], v[76:77], v[176:177]
    v_pk_add_f32 v[78:79], v[78:79], v[178:179]
    s_waitcnt lgkmcnt(15)
    v_pk_add_f32 v[76:77], v[76:77], v[180:181]
    v_pk_add_f32 v[78:79], v[78:79], v[182:183]
    s_waitcnt lgkmcnt(14)
    v_pk_add_f32 v[76:77], v[76:77], v[184:185]
    v_pk_add_f32 v[78:79], v[78:79], v[186:187]
    s_waitcnt lgkmcnt(13)
    v_lshlrev_b32 v188, 16, v190
    v_and_b32 v189, 0xffff0000, v190
    v_lshlrev_b32 v190, 16, v191
    v_and_b32 v191, 0xffff0000, v191
    v_fma_f32 v76, v6, v76, v188
    v_fma_f32 v77, v6, v77, v189
    v_fma_f32 v78, v6, v78, v190
    v_fma_f32 v79, v6, v79, v191
    v_cvt_pk_bf16_f32 v16, v76, v77
    v_cvt_pk_bf16_f32 v17, v78, v79
    ds_write_b64 v2, v[16:17] offset:32
    s_waitcnt lgkmcnt(13)
    v_pk_add_f32 v[80:81], v[80:81], v[192:193]
    v_pk_add_f32 v[82:83], v[82:83], v[194:195]
    s_waitcnt lgkmcnt(12)
    v_pk_add_f32 v[80:81], v[80:81], v[196:197]
    v_pk_add_f32 v[82:83], v[82:83], v[198:199]
    s_waitcnt lgkmcnt(11)
    v_pk_add_f32 v[80:81], v[80:81], v[200:201]
    v_pk_add_f32 v[82:83], v[82:83], v[202:203]
    s_waitcnt lgkmcnt(10)
    v_lshlrev_b32 v204, 16, v206
    v_and_b32 v205, 0xffff0000, v206
    v_lshlrev_b32 v206, 16, v207
    v_and_b32 v207, 0xffff0000, v207
    v_fma_f32 v80, v6, v80, v204
    v_fma_f32 v81, v6, v81, v205
    v_fma_f32 v82, v6, v82, v206
    v_fma_f32 v83, v6, v83, v207
    v_cvt_pk_bf16_f32 v12, v80, v81
    v_cvt_pk_bf16_f32 v13, v82, v83
    ds_write_b64 v2, v[12:13] offset:64
    s_waitcnt lgkmcnt(10)
    v_pk_add_f32 v[84:85], v[84:85], v[208:209]
    v_pk_add_f32 v[86:87], v[86:87], v[210:211]
    s_waitcnt lgkmcnt(9)
    v_pk_add_f32 v[84:85], v[84:85], v[212:213]
    v_pk_add_f32 v[86:87], v[86:87], v[214:215]
    s_waitcnt lgkmcnt(8)
    v_pk_add_f32 v[84:85], v[84:85], v[216:217]
    v_pk_add_f32 v[86:87], v[86:87], v[218:219]
    s_waitcnt lgkmcnt(7)
    v_lshlrev_b32 v220, 16, v222
    v_and_b32 v221, 0xffff0000, v222
    v_lshlrev_b32 v222, 16, v223
    v_and_b32 v223, 0xffff0000, v223
    v_fma_f32 v84, v6, v84, v220
    v_fma_f32 v85, v6, v85, v221
    v_fma_f32 v86, v6, v86, v222
    v_fma_f32 v87, v6, v87, v223
    v_cvt_pk_bf16_f32 v16, v84, v85
    v_cvt_pk_bf16_f32 v17, v86, v87
    ds_write_b64 v2, v[16:17] offset:96
    s_waitcnt lgkmcnt(7)
    v_pk_add_f32 v[88:89], v[88:89], v[224:225]
    v_pk_add_f32 v[90:91], v[90:91], v[226:227]
    s_waitcnt lgkmcnt(6)
    v_pk_add_f32 v[88:89], v[88:89], v[228:229]
    v_pk_add_f32 v[90:91], v[90:91], v[230:231]
    s_waitcnt lgkmcnt(5)
    v_pk_add_f32 v[88:89], v[88:89], v[232:233]
    v_pk_add_f32 v[90:91], v[90:91], v[234:235]
    s_waitcnt lgkmcnt(4)
    v_lshlrev_b32 v236, 16, v238
    v_and_b32 v237, 0xffff0000, v238
    v_lshlrev_b32 v238, 16, v239
    v_and_b32 v239, 0xffff0000, v239
    v_fma_f32 v88, v6, v88, v236
    v_fma_f32 v89, v6, v89, v237
    v_fma_f32 v90, v6, v90, v238
    v_fma_f32 v91, v6, v91, v239
    v_cvt_pk_bf16_f32 v12, v88, v89
    v_cvt_pk_bf16_f32 v13, v90, v91
    ds_write_b64 v2, v[12:13] offset:128
    s_waitcnt lgkmcnt(0)
    ds_read_b128 v[24:27], v8 offset:0
    ds_read_b128 v[28:31], v8 offset:1024
    ds_read_b128 v[32:35], v8 offset:2048
    s_waitcnt lgkmcnt(2)
    buffer_store_dwordx4 v[24:27], v242, s[56:59], s89 offen sc1
    s_waitcnt lgkmcnt(1)
    buffer_store_dwordx4 v[28:31], v244, s[56:59], s89 offen sc1
    s_waitcnt lgkmcnt(0)
    buffer_store_dwordx4 v[32:35], v245, s[56:59], s89 offen sc1
    s_endpgm
Lfin1:
    v_mfma_f32_16x16x32_bf16 v[72:75], v[220:223], v[56:59], v[72:75]
    v_mfma_f32_16x16x32_bf16 v[76:79], v[224:227], v[56:59], v[76:79]
    v_mfma_f32_16x16x32_bf16 v[80:83], v[228:231], v[56:59], v[80:83]
    v_mfma_f32_16x16x32_bf16 v[84:87], v[232:235], v[56:59], v[84:87]
    v_mfma_f32_16x16x32_bf16 v[88:91], v[236:239], v[56:59], v[88:91]
    v_mfma_f32_16x16x32_bf16 v[112:115], v[220:223], v[64:67], v[112:115]
    v_mfma_f32_16x16x32_bf16 v[116:119], v[224:227], v[64:67], v[116:119]
    s_nop 1
    ds_write_b128 v7, v[72:75] offset:10240
    v_mfma_f32_16x16x32_bf16 v[120:123], v[228:231], v[64:67], v[120:123]
    ds_write_b128 v7, v[76:79] offset:11264
    v_mfma_f32_16x16x32_bf16 v[124:127], v[232:235], v[64:67], v[124:127]
    ds_write_b128 v7, v[80:83] offset:12288
    v_mfma_f32_16x16x32_bf16 v[128:131], v[236:239], v[64:67], v[128:131]
    ds_write_b128 v7, v[84:87] offset:13312
    v_mfma_f32_16x16x32_bf16 v[132:135], v[220:223], v[68:71], v[132:135]
    ds_write_b128 v7, v[88:91] offset:14336
    v_mfma_f32_16x16x32_bf16 v[136:139], v[224:227], v[68:71], v[136:139]
    ds_write_b128 v7, v[112:115] offset:15360
    v_mfma_f32_16x16x32_bf16 v[140:143], v[228:231], v[68:71], v[140:143]
    ds_write_b128 v7, v[116:119] offset:16384
    v_mfma_f32_16x16x32_bf16 v[144:147], v[232:235], v[68:71], v[144:147]
    ds_write_b128 v7, v[120:123] offset:17408
    v_mfma_f32_16x16x32_bf16 v[148:151], v[236:239], v[68:71], v[148:151]
    ds_write_b128 v7, v[124:127] offset:18432
    v_mfma_f32_16x16x32_bf16 v[92:95], v[220:223], v[60:63], v[92:95]
    ds_write_b128 v7, v[128:131] offset:19456
    v_mfma_f32_16x16x32_bf16 v[96:99], v[224:227], v[60:63], v[96:99]
    ds_write_b128 v4, v[132:135] offset:10240
    v_mfma_f32_16x16x32_bf16 v[100:103], v[228:231], v[60:63], v[100:103]
    ds_write_b128 v4, v[136:139] offset:11264
    v_mfma_f32_16x16x32_bf16 v[104:107], v[232:235], v[60:63], v[104:107]
    ds_write_b128 v4, v[140:143] offset:12288
    v_mfma_f32_16x16x32_bf16 v[108:111], v[236:239], v[60:63], v[108:111]
    ds_write_b128 v4, v[144:147] offset:13312
    ds_write_b128 v4, v[148:151] offset:14336
    v_lshlrev_b32 v5, 3, v1
    v_add_u32 v5, 130944, v5
    v_lshlrev_b32 v3, 2, v1
    v_add_u32 v3, 151040, v3
    v_and_b32 v2, 15, v1
    v_mul_u32_u24 v2, 160, v2
    v_lshrrev_b32 v8, 4, v1
    v_lshl_add_u32 v2, v8, 3, v2
    v_add_u32 v2, 128384, v2
    v_add_u32 v8, 128384, v240
    s_waitcnt lgkmcnt(0)
    s_barrier
    ds_read_b32 v6, v3
    ds_read_b128 v[160:163], v7 offset:0
    ds_read_b128 v[164:167], v7 offset:25600
    ds_read_b128 v[168:171], v7 offset:35840
    ds_read_b64 v[174:175], v5 offset:0
    ds_read_b128 v[176:179], v7 offset:1024
    ds_read_b128 v[180:183], v7 offset:26624
    ds_read_b128 v[184:187], v7 offset:36864
    ds_read_b64 v[190:191], v5 offset:512
    ds_read_b128 v[192:195], v7 offset:2048
    ds_read_b128 v[196:199], v7 offset:27648
    ds_read_b128 v[200:203], v7 offset:37888
    ds_read_b64 v[206:207], v5 offset:1024
    ds_read_b128 v[208:211], v7 offset:3072
    ds_read_b128 v[212:215], v7 offset:28672
    ds_read_b128 v[216:219], v7 offset:38912
    ds_read_b64 v[222:223], v5 offset:1536
    ds_read_b128 v[224:227], v7 offset:4096
    ds_read_b128 v[228:231], v7 offset:29696
    ds_read_b128 v[232:235], v7 offset:39936
    ds_read_b64 v[238:239], v5 offset:2048
    s_waitcnt lgkmcnt(15)
    v_pk_add_f32 v[92:93], v[92:93], v[160:161]
    v_pk_add_f32 v[94:95], v[94:95], v[162:163]
    v_pk_add_f32 v[92:93], v[92:93], v[164:165]
    v_pk_add_f32 v[94:95], v[94:95], v[166:167]
    v_pk_add_f32 v[92:93], v[92:93], v[168:169]
    v_pk_add_f32 v[94:95], v[94:95], v[170:171]
    v_lshlrev_b32 v172, 16, v174
    v_and_b32 v173, 0xffff0000, v174
    v_lshlrev_b32 v174, 16, v175
    v_and_b32 v175, 0xffff0000, v175
    v_fma_f32 v92, v6, v92, v172
    v_fma_f32 v93, v6, v93, v173
    v_fma_f32 v94, v6, v94, v174
    v_fma_f32 v95, v6, v95, v175
    v_cvt_pk_bf16_f32 v12, v92, v93
    v_cvt_pk_bf16_f32 v13, v94, v95
    ds_write_b64 v2, v[12:13] offset:0
    v_pk_add_f32 v[96:97], v[96:97], v[176:177]
    v_pk_add_f32 v[98:99], v[98:99], v[178:179]
    s_waitcnt lgkmcnt(15)
    v_pk_add_f32 v[96:97], v[96:97], v[180:181]
    v_pk_add_f32 v[98:99], v[98:99], v[182:183]
    s_waitcnt lgkmcnt(14)
    v_pk_add_f32 v[96:97], v[96:97], v[184:185]
    v_pk_add_f32 v[98:99], v[98:99], v[186:187]
    s_waitcnt lgkmcnt(13)
    v_lshlrev_b32 v188, 16, v190
    v_and_b32 v189, 0xffff0000, v190
    v_lshlrev_b32 v190, 16, v191
    v_and_b32 v191, 0xffff0000, v191
    v_fma_f32 v96, v6, v96, v188
    v_fma_f32 v97, v6, v97, v189
    v_fma_f32 v98, v6, v98, v190
    v_fma_f32 v99, v6, v99, v191
    v_cvt_pk_bf16_f32 v16, v96, v97
    v_cvt_pk_bf16_f32 v17, v98, v99
    ds_write_b64 v2, v[16:17] offset:32
    s_waitcnt lgkmcnt(13)
    v_pk_add_f32 v[100:101], v[100:101], v[192:193]
    v_pk_add_f32 v[102:103], v[102:103], v[194:195]
    s_waitcnt lgkmcnt(12)
    v_pk_add_f32 v[100:101], v[100:101], v[196:197]
    v_pk_add_f32 v[102:103], v[102:103], v[198:199]
    s_waitcnt lgkmcnt(11)
    v_pk_add_f32 v[100:101], v[100:101], v[200:201]
    v_pk_add_f32 v[102:103], v[102:103], v[202:203]
    s_waitcnt lgkmcnt(10)
    v_lshlrev_b32 v204, 16, v206
    v_and_b32 v205, 0xffff0000, v206
    v_lshlrev_b32 v206, 16, v207
    v_and_b32 v207, 0xffff0000, v207
    v_fma_f32 v100, v6, v100, v204
    v_fma_f32 v101, v6, v101, v205
    v_fma_f32 v102, v6, v102, v206
    v_fma_f32 v103, v6, v103, v207
    v_cvt_pk_bf16_f32 v12, v100, v101
    v_cvt_pk_bf16_f32 v13, v102, v103
    ds_write_b64 v2, v[12:13] offset:64
    s_waitcnt lgkmcnt(10)
    v_pk_add_f32 v[104:105], v[104:105], v[208:209]
    v_pk_add_f32 v[106:107], v[106:107], v[210:211]
    s_waitcnt lgkmcnt(9)
    v_pk_add_f32 v[104:105], v[104:105], v[212:213]
    v_pk_add_f32 v[106:107], v[106:107], v[214:215]
    s_waitcnt lgkmcnt(8)
    v_pk_add_f32 v[104:105], v[104:105], v[216:217]
    v_pk_add_f32 v[106:107], v[106:107], v[218:219]
    s_waitcnt lgkmcnt(7)
    v_lshlrev_b32 v220, 16, v222
    v_and_b32 v221, 0xffff0000, v222
    v_lshlrev_b32 v222, 16, v223
    v_and_b32 v223, 0xffff0000, v223
    v_fma_f32 v104, v6, v104, v220
    v_fma_f32 v105, v6, v105, v221
    v_fma_f32 v106, v6, v106, v222
    v_fma_f32 v107, v6, v107, v223
    v_cvt_pk_bf16_f32 v16, v104, v105
    v_cvt_pk_bf16_f32 v17, v106, v107
    ds_write_b64 v2, v[16:17] offset:96
    s_waitcnt lgkmcnt(7)
    v_pk_add_f32 v[108:109], v[108:109], v[224:225]
    v_pk_add_f32 v[110:111], v[110:111], v[226:227]
    s_waitcnt lgkmcnt(6)
    v_pk_add_f32 v[108:109], v[108:109], v[228:229]
    v_pk_add_f32 v[110:111], v[110:111], v[230:231]
    s_waitcnt lgkmcnt(5)
    v_pk_add_f32 v[108:109], v[108:109], v[232:233]
    v_pk_add_f32 v[110:111], v[110:111], v[234:235]
    s_waitcnt lgkmcnt(4)
    v_lshlrev_b32 v236, 16, v238
    v_and_b32 v237, 0xffff0000, v238
    v_lshlrev_b32 v238, 16, v239
    v_and_b32 v239, 0xffff0000, v239
    v_fma_f32 v108, v6, v108, v236
    v_fma_f32 v109, v6, v109, v237
    v_fma_f32 v110, v6, v110, v238
    v_fma_f32 v111, v6, v111, v239
    v_cvt_pk_bf16_f32 v12, v108, v109
    v_cvt_pk_bf16_f32 v13, v110, v111
    ds_write_b64 v2, v[12:13] offset:128
    s_waitcnt lgkmcnt(0)
    ds_read_b128 v[24:27], v8 offset:0
    ds_read_b128 v[28:31], v8 offset:1024
    ds_read_b128 v[32:35], v8 offset:2048
    s_waitcnt lgkmcnt(2)
    buffer_store_dwordx4 v[24:27], v242, s[56:59], s89 offen sc1
    s_waitcnt lgkmcnt(1)
    buffer_store_dwordx4 v[28:31], v244, s[56:59], s89 offen sc1
    s_waitcnt lgkmcnt(0)
    buffer_store_dwordx4 v[32:35], v245, s[56:59], s89 offen sc1
    s_endpgm
Lfin2:
    v_mfma_f32_16x16x32_bf16 v[72:75], v[220:223], v[56:59], v[72:75]
    v_mfma_f32_16x16x32_bf16 v[76:79], v[224:227], v[56:59], v[76:79]
    v_mfma_f32_16x16x32_bf16 v[80:83], v[228:231], v[56:59], v[80:83]
    v_mfma_f32_16x16x32_bf16 v[84:87], v[232:235], v[56:59], v[84:87]
    v_mfma_f32_16x16x32_bf16 v[88:91], v[236:239], v[56:59], v[88:91]
    v_mfma_f32_16x16x32_bf16 v[92:95], v[220:223], v[60:63], v[92:95]
    v_mfma_f32_16x16x32_bf16 v[96:99], v[224:227], v[60:63], v[96:99]
    s_nop 1
    ds_write_b128 v7, v[72:75] offset:20480
    v_mfma_f32_16x16x32_bf16 v[100:103], v[228:231], v[60:63], v[100:103]
    ds_write_b128 v7, v[76:79] offset:21504
    v_mfma_f32_16x16x32_bf16 v[104:107], v[232:235], v[60:63], v[104:107]
    ds_write_b128 v7, v[80:83] offset:22528
    v_mfma_f32_16x16x32_bf16 v[108:111], v[236:239], v[60:63], v[108:111]
    ds_write_b128 v7, v[84:87] offset:23552
    v_mfma_f32_16x16x32_bf16 v[132:135], v[220:223], v[68:71], v[132:135]
    ds_write_b128 v7, v[88:91] offset:24576
    v_mfma_f32_16x16x32_bf16 v[136:139], v[224:227], v[68:71], v[136:139]
    ds_write_b128 v7, v[92:95] offset:25600
    v_mfma_f32_16x16x32_bf16 v[140:143], v[228:231], v[68:71], v[140:143]
    ds_write_b128 v7, v[96:99] offset:26624
    v_mfma_f32_16x16x32_bf16 v[144:147], v[232:235], v[68:71], v[144:147]
    ds_write_b128 v7, v[100:103] offset:27648
    v_mfma_f32_16x16x32_bf16 v[148:151], v[236:239], v[68:71], v[148:151]
    ds_write_b128 v7, v[104:107] offset:28672
    v_mfma_f32_16x16x32_bf16 v[112:115], v[220:223], v[64:67], v[112:115]
    ds_write_b128 v7, v[108:111] offset:29696
    v_mfma_f32_16x16x32_bf16 v[116:119], v[224:227], v[64:67], v[116:119]
    ds_write_b128 v4, v[132:135] offset:20480
    v_mfma_f32_16x16x32_bf16 v[120:123], v[228:231], v[64:67], v[120:123]
    ds_write_b128 v4, v[136:139] offset:21504
    v_mfma_f32_16x16x32_bf16 v[124:127], v[232:235], v[64:67], v[124:127]
    ds_write_b128 v4, v[140:143] offset:22528
    v_mfma_f32_16x16x32_bf16 v[128:131], v[236:239], v[64:67], v[128:131]
    ds_write_b128 v4, v[144:147] offset:23552
    ds_write_b128 v4, v[148:151] offset:24576
    v_lshlrev_b32 v5, 3, v1
    v_add_u32 v5, 136064, v5
    v_lshlrev_b32 v3, 2, v1
    v_add_u32 v3, 155264, v3
    v_and_b32 v2, 15, v1
    v_mul_u32_u24 v2, 160, v2
    v_lshrrev_b32 v8, 4, v1
    v_lshl_add_u32 v2, v8, 3, v2
    v_add_u32 v2, 133504, v2
    v_add_u32 v8, 133504, v240
    s_waitcnt lgkmcnt(0)
    s_barrier
    ds_read_b32 v6, v3
    ds_read_b128 v[160:163], v7 offset:5120
    ds_read_b128 v[164:167], v7 offset:15360
    ds_read_b128 v[168:171], v4 offset:30720
    ds_read_b64 v[174:175], v5 offset:0
    ds_read_b128 v[176:179], v7 offset:6144
    ds_read_b128 v[180:183], v7 offset:16384
    ds_read_b128 v[184:187], v4 offset:31744
    ds_read_b64 v[190:191], v5 offset:512
    ds_read_b128 v[192:195], v7 offset:7168
    ds_read_b128 v[196:199], v7 offset:17408
    ds_read_b128 v[200:203], v4 offset:32768
    ds_read_b64 v[206:207], v5 offset:1024
    ds_read_b128 v[208:211], v7 offset:8192
    ds_read_b128 v[212:215], v7 offset:18432
    ds_read_b128 v[216:219], v4 offset:33792
    ds_read_b64 v[222:223], v5 offset:1536
    ds_read_b128 v[224:227], v7 offset:9216
    ds_read_b128 v[228:231], v7 offset:19456
    ds_read_b128 v[232:235], v4 offset:34816
    ds_read_b64 v[238:239], v5 offset:2048
    s_waitcnt lgkmcnt(15)
    v_pk_add_f32 v[112:113], v[112:113], v[160:161]
    v_pk_add_f32 v[114:115], v[114:115], v[162:163]
    v_pk_add_f32 v[112:113], v[112:113], v[164:165]
    v_pk_add_f32 v[114:115], v[114:115], v[166:167]
    v_pk_add_f32 v[112:113], v[112:113], v[168:169]
    v_pk_add_f32 v[114:115], v[114:115], v[170:171]
    v_lshlrev_b32 v172, 16, v174
    v_and_b32 v173, 0xffff0000, v174
    v_lshlrev_b32 v174, 16, v175
    v_and_b32 v175, 0xffff0000, v175
    v_fma_f32 v112, v6, v112, v172
    v_fma_f32 v113, v6, v113, v173
    v_fma_f32 v114, v6, v114, v174
    v_fma_f32 v115, v6, v115, v175
    v_cvt_pk_bf16_f32 v12, v112, v113
    v_cvt_pk_bf16_f32 v13, v114, v115
    ds_write_b64 v2, v[12:13] offset:0
    v_pk_add_f32 v[116:117], v[116:117], v[176:177]
    v_pk_add_f32 v[118:119], v[118:119], v[178:179]
    s_waitcnt lgkmcnt(15)
    v_pk_add_f32 v[116:117], v[116:117], v[180:181]
    v_pk_add_f32 v[118:119], v[118:119], v[182:183]
    s_waitcnt lgkmcnt(14)
    v_pk_add_f32 v[116:117], v[116:117], v[184:185]
    v_pk_add_f32 v[118:119], v[118:119], v[186:187]
    s_waitcnt lgkmcnt(13)
    v_lshlrev_b32 v188, 16, v190
    v_and_b32 v189, 0xffff0000, v190
    v_lshlrev_b32 v190, 16, v191
    v_and_b32 v191, 0xffff0000, v191
    v_fma_f32 v116, v6, v116, v188
    v_fma_f32 v117, v6, v117, v189
    v_fma_f32 v118, v6, v118, v190
    v_fma_f32 v119, v6, v119, v191
    v_cvt_pk_bf16_f32 v16, v116, v117
    v_cvt_pk_bf16_f32 v17, v118, v119
    ds_write_b64 v2, v[16:17] offset:32
    s_waitcnt lgkmcnt(13)
    v_pk_add_f32 v[120:121], v[120:121], v[192:193]
    v_pk_add_f32 v[122:123], v[122:123], v[194:195]
    s_waitcnt lgkmcnt(12)
    v_pk_add_f32 v[120:121], v[120:121], v[196:197]
    v_pk_add_f32 v[122:123], v[122:123], v[198:199]
    s_waitcnt lgkmcnt(11)
    v_pk_add_f32 v[120:121], v[120:121], v[200:201]
    v_pk_add_f32 v[122:123], v[122:123], v[202:203]
    s_waitcnt lgkmcnt(10)
    v_lshlrev_b32 v204, 16, v206
    v_and_b32 v205, 0xffff0000, v206
    v_lshlrev_b32 v206, 16, v207
    v_and_b32 v207, 0xffff0000, v207
    v_fma_f32 v120, v6, v120, v204
    v_fma_f32 v121, v6, v121, v205
    v_fma_f32 v122, v6, v122, v206
    v_fma_f32 v123, v6, v123, v207
    v_cvt_pk_bf16_f32 v12, v120, v121
    v_cvt_pk_bf16_f32 v13, v122, v123
    ds_write_b64 v2, v[12:13] offset:64
    s_waitcnt lgkmcnt(10)
    v_pk_add_f32 v[124:125], v[124:125], v[208:209]
    v_pk_add_f32 v[126:127], v[126:127], v[210:211]
    s_waitcnt lgkmcnt(9)
    v_pk_add_f32 v[124:125], v[124:125], v[212:213]
    v_pk_add_f32 v[126:127], v[126:127], v[214:215]
    s_waitcnt lgkmcnt(8)
    v_pk_add_f32 v[124:125], v[124:125], v[216:217]
    v_pk_add_f32 v[126:127], v[126:127], v[218:219]
    s_waitcnt lgkmcnt(7)
    v_lshlrev_b32 v220, 16, v222
    v_and_b32 v221, 0xffff0000, v222
    v_lshlrev_b32 v222, 16, v223
    v_and_b32 v223, 0xffff0000, v223
    v_fma_f32 v124, v6, v124, v220
    v_fma_f32 v125, v6, v125, v221
    v_fma_f32 v126, v6, v126, v222
    v_fma_f32 v127, v6, v127, v223
    v_cvt_pk_bf16_f32 v16, v124, v125
    v_cvt_pk_bf16_f32 v17, v126, v127
    ds_write_b64 v2, v[16:17] offset:96
    s_waitcnt lgkmcnt(7)
    v_pk_add_f32 v[128:129], v[128:129], v[224:225]
    v_pk_add_f32 v[130:131], v[130:131], v[226:227]
    s_waitcnt lgkmcnt(6)
    v_pk_add_f32 v[128:129], v[128:129], v[228:229]
    v_pk_add_f32 v[130:131], v[130:131], v[230:231]
    s_waitcnt lgkmcnt(5)
    v_pk_add_f32 v[128:129], v[128:129], v[232:233]
    v_pk_add_f32 v[130:131], v[130:131], v[234:235]
    s_waitcnt lgkmcnt(4)
    v_lshlrev_b32 v236, 16, v238
    v_and_b32 v237, 0xffff0000, v238
    v_lshlrev_b32 v238, 16, v239
    v_and_b32 v239, 0xffff0000, v239
    v_fma_f32 v128, v6, v128, v236
    v_fma_f32 v129, v6, v129, v237
    v_fma_f32 v130, v6, v130, v238
    v_fma_f32 v131, v6, v131, v239
    v_cvt_pk_bf16_f32 v12, v128, v129
    v_cvt_pk_bf16_f32 v13, v130, v131
    ds_write_b64 v2, v[12:13] offset:128
    s_waitcnt lgkmcnt(0)
    ds_read_b128 v[24:27], v8 offset:0
    ds_read_b128 v[28:31], v8 offset:1024
    ds_read_b128 v[32:35], v8 offset:2048
    s_waitcnt lgkmcnt(2)
    buffer_store_dwordx4 v[24:27], v242, s[56:59], s89 offen sc1
    s_waitcnt lgkmcnt(1)
    buffer_store_dwordx4 v[28:31], v244, s[56:59], s89 offen sc1
    s_waitcnt lgkmcnt(0)
    buffer_store_dwordx4 v[32:35], v245, s[56:59], s89 offen sc1
    s_endpgm
Lfin3:
    v_mfma_f32_16x16x32_bf16 v[72:75], v[220:223], v[56:59], v[72:75]
    v_mfma_f32_16x16x32_bf16 v[76:79], v[224:227], v[56:59], v[76:79]
    v_mfma_f32_16x16x32_bf16 v[80:83], v[228:231], v[56:59], v[80:83]
    v_mfma_f32_16x16x32_bf16 v[84:87], v[232:235], v[56:59], v[84:87]
    v_mfma_f32_16x16x32_bf16 v[88:91], v[236:239], v[56:59], v[88:91]
    v_mfma_f32_16x16x32_bf16 v[92:95], v[220:223], v[60:63], v[92:95]
    v_mfma_f32_16x16x32_bf16 v[96:99], v[224:227], v[60:63], v[96:99]
    s_nop 1
    ds_write_b128 v7, v[72:75] offset:30720
    v_mfma_f32_16x16x32_bf16 v[100:103], v[228:231], v[60:63], v[100:103]
    ds_write_b128 v7, v[76:79] offset:31744
    v_mfma_f32_16x16x32_bf16 v[104:107], v[232:235], v[60:63], v[104:107]
    ds_write_b128 v7, v[80:83] offset:32768
    v_mfma_f32_16x16x32_bf16 v[108:111], v[236:239], v[60:63], v[108:111]
    ds_write_b128 v7, v[84:87] offset:33792
    v_mfma_f32_16x16x32_bf16 v[112:115], v[220:223], v[64:67], v[112:115]
    ds_write_b128 v7, v[88:91] offset:34816
    v_mfma_f32_16x16x32_bf16 v[116:119], v[224:227], v[64:67], v[116:119]
    ds_write_b128 v7, v[92:95] offset:35840
    v_mfma_f32_16x16x32_bf16 v[120:123], v[228:231], v[64:67], v[120:123]
    ds_write_b128 v7, v[96:99] offset:36864
    v_mfma_f32_16x16x32_bf16 v[124:127], v[232:235], v[64:67], v[124:127]
    ds_write_b128 v7, v[100:103] offset:37888
    v_mfma_f32_16x16x32_bf16 v[128:131], v[236:239], v[64:67], v[128:131]
    ds_write_b128 v7, v[104:107] offset:38912
    v_mfma_f32_16x16x32_bf16 v[132:135], v[220:223], v[68:71], v[132:135]
    ds_write_b128 v7, v[108:111] offset:39936
    v_mfma_f32_16x16x32_bf16 v[136:139], v[224:227], v[68:71], v[136:139]
    ds_write_b128 v4, v[112:115] offset:30720
    v_mfma_f32_16x16x32_bf16 v[140:143], v[228:231], v[68:71], v[140:143]
    ds_write_b128 v4, v[116:119] offset:31744
    v_mfma_f32_16x16x32_bf16 v[144:147], v[232:235], v[68:71], v[144:147]
    ds_write_b128 v4, v[120:123] offset:32768
    v_mfma_f32_16x16x32_bf16 v[148:151], v[236:239], v[68:71], v[148:151]
    ds_write_b128 v4, v[124:127] offset:33792
    ds_write_b128 v4, v[128:131] offset:34816
    v_lshlrev_b32 v5, 3, v1
    v_add_u32 v5, 141184, v5
    v_lshlrev_b32 v3, 2, v1
    v_add_u32 v3, 159488, v3
    v_and_b32 v2, 15, v1
    v_mul_u32_u24 v2, 160, v2
    v_lshrrev_b32 v8, 4, v1
    v_lshl_add_u32 v2, v8, 3, v2
    v_add_u32 v2, 138624, v2
    v_add_u32 v8, 138624, v240
    s_waitcnt lgkmcnt(0)
    s_barrier
    ds_read_b32 v6, v3
    ds_read_b128 v[160:163], v4 offset:0
    ds_read_b128 v[164:167], v4 offset:10240
    ds_read_b128 v[168:171], v4 offset:20480
    ds_read_b64 v[174:175], v5 offset:0
    ds_read_b128 v[176:179], v4 offset:1024
    ds_read_b128 v[180:183], v4 offset:11264
    ds_read_b128 v[184:187], v4 offset:21504
    ds_read_b64 v[190:191], v5 offset:512
    ds_read_b128 v[192:195], v4 offset:2048
    ds_read_b128 v[196:199], v4 offset:12288
    ds_read_b128 v[200:203], v4 offset:22528
    ds_read_b64 v[206:207], v5 offset:1024
    ds_read_b128 v[208:211], v4 offset:3072
    ds_read_b128 v[212:215], v4 offset:13312
    ds_read_b128 v[216:219], v4 offset:23552
    ds_read_b64 v[222:223], v5 offset:1536
    ds_read_b128 v[224:227], v4 offset:4096
    ds_read_b128 v[228:231], v4 offset:14336
    ds_read_b128 v[232:235], v4 offset:24576
    ds_read_b64 v[238:239], v5 offset:2048
    s_waitcnt lgkmcnt(15)
    v_pk_add_f32 v[132:133], v[132:133], v[160:161]
    v_pk_add_f32 v[134:135], v[134:135], v[162:163]
    v_pk_add_f32 v[132:133], v[132:133], v[164:165]
    v_pk_add_f32 v[134:135], v[134:135], v[166:167]
    v_pk_add_f32 v[132:133], v[132:133], v[168:169]
    v_pk_add_f32 v[134:135], v[134:135], v[170:171]
    v_lshlrev_b32 v172, 16, v174
    v_and_b32 v173, 0xffff0000, v174
    v_lshlrev_b32 v174, 16, v175
    v_and_b32 v175, 0xffff0000, v175
    v_fma_f32 v132, v6, v132, v172
    v_fma_f32 v133, v6, v133, v173
    v_fma_f32 v134, v6, v134, v174
    v_fma_f32 v135, v6, v135, v175
    v_cvt_pk_bf16_f32 v12, v132, v133
    v_cvt_pk_bf16_f32 v13, v134, v135
    ds_write_b64 v2, v[12:13] offset:0
    v_pk_add_f32 v[136:137], v[136:137], v[176:177]
    v_pk_add_f32 v[138:139], v[138:139], v[178:179]
    s_waitcnt lgkmcnt(15)
    v_pk_add_f32 v[136:137], v[136:137], v[180:181]
    v_pk_add_f32 v[138:139], v[138:139], v[182:183]
    s_waitcnt lgkmcnt(14)
    v_pk_add_f32 v[136:137], v[136:137], v[184:185]
    v_pk_add_f32 v[138:139], v[138:139], v[186:187]
    s_waitcnt lgkmcnt(13)
    v_lshlrev_b32 v188, 16, v190
    v_and_b32 v189, 0xffff0000, v190
    v_lshlrev_b32 v190, 16, v191
    v_and_b32 v191, 0xffff0000, v191
    v_fma_f32 v136, v6, v136, v188
    v_fma_f32 v137, v6, v137, v189
    v_fma_f32 v138, v6, v138, v190
    v_fma_f32 v139, v6, v139, v191
    v_cvt_pk_bf16_f32 v16, v136, v137
    v_cvt_pk_bf16_f32 v17, v138, v139
    ds_write_b64 v2, v[16:17] offset:32
    s_waitcnt lgkmcnt(13)
    v_pk_add_f32 v[140:141], v[140:141], v[192:193]
    v_pk_add_f32 v[142:143], v[142:143], v[194:195]
    s_waitcnt lgkmcnt(12)
    v_pk_add_f32 v[140:141], v[140:141], v[196:197]
    v_pk_add_f32 v[142:143], v[142:143], v[198:199]
    s_waitcnt lgkmcnt(11)
    v_pk_add_f32 v[140:141], v[140:141], v[200:201]
    v_pk_add_f32 v[142:143], v[142:143], v[202:203]
    s_waitcnt lgkmcnt(10)
    v_lshlrev_b32 v204, 16, v206
    v_and_b32 v205, 0xffff0000, v206
    v_lshlrev_b32 v206, 16, v207
    v_and_b32 v207, 0xffff0000, v207
    v_fma_f32 v140, v6, v140, v204
    v_fma_f32 v141, v6, v141, v205
    v_fma_f32 v142, v6, v142, v206
    v_fma_f32 v143, v6, v143, v207
    v_cvt_pk_bf16_f32 v12, v140, v141
    v_cvt_pk_bf16_f32 v13, v142, v143
    ds_write_b64 v2, v[12:13] offset:64
    s_waitcnt lgkmcnt(10)
    v_pk_add_f32 v[144:145], v[144:145], v[208:209]
    v_pk_add_f32 v[146:147], v[146:147], v[210:211]
    s_waitcnt lgkmcnt(9)
    v_pk_add_f32 v[144:145], v[144:145], v[212:213]
    v_pk_add_f32 v[146:147], v[146:147], v[214:215]
    s_waitcnt lgkmcnt(8)
    v_pk_add_f32 v[144:145], v[144:145], v[216:217]
    v_pk_add_f32 v[146:147], v[146:147], v[218:219]
    s_waitcnt lgkmcnt(7)
    v_lshlrev_b32 v220, 16, v222
    v_and_b32 v221, 0xffff0000, v222
    v_lshlrev_b32 v222, 16, v223
    v_and_b32 v223, 0xffff0000, v223
    v_fma_f32 v144, v6, v144, v220
    v_fma_f32 v145, v6, v145, v221
    v_fma_f32 v146, v6, v146, v222
    v_fma_f32 v147, v6, v147, v223
    v_cvt_pk_bf16_f32 v16, v144, v145
    v_cvt_pk_bf16_f32 v17, v146, v147
    ds_write_b64 v2, v[16:17] offset:96
    s_waitcnt lgkmcnt(7)
    v_pk_add_f32 v[148:149], v[148:149], v[224:225]
    v_pk_add_f32 v[150:151], v[150:151], v[226:227]
    s_waitcnt lgkmcnt(6)
    v_pk_add_f32 v[148:149], v[148:149], v[228:229]
    v_pk_add_f32 v[150:151], v[150:151], v[230:231]
    s_waitcnt lgkmcnt(5)
    v_pk_add_f32 v[148:149], v[148:149], v[232:233]
    v_pk_add_f32 v[150:151], v[150:151], v[234:235]
    s_waitcnt lgkmcnt(4)
    v_lshlrev_b32 v236, 16, v238
    v_and_b32 v237, 0xffff0000, v238
    v_lshlrev_b32 v238, 16, v239
    v_and_b32 v239, 0xffff0000, v239
    v_fma_f32 v148, v6, v148, v236
    v_fma_f32 v149, v6, v149, v237
    v_fma_f32 v150, v6, v150, v238
    v_fma_f32 v151, v6, v151, v239
    v_cvt_pk_bf16_f32 v12, v148, v149
    v_cvt_pk_bf16_f32 v13, v150, v151
    ds_write_b64 v2, v[12:13] offset:128
    s_waitcnt lgkmcnt(0)
    ds_read_b128 v[24:27], v8 offset:0
    ds_read_b128 v[28:31], v8 offset:1024
    ds_read_b128 v[32:35], v8 offset:2048
    s_waitcnt lgkmcnt(2)
    buffer_store_dwordx4 v[24:27], v242, s[56:59], s89 offen sc1
    s_waitcnt lgkmcnt(1)
    buffer_store_dwordx4 v[28:31], v244, s[56:59], s89 offen sc1
    s_waitcnt lgkmcnt(0)
    buffer_store_dwordx4 v[32:35], v245, s[56:59], s89 offen sc1
    s_endpgm
CODE_END:
.section .rodata,"a"
.p2align 6
.amdhsa_kernel gated_mix__ssm_conv_h3__glu_gated_bilinear__prompt_kernel
  .amdhsa_next_free_vgpr 256
  .amdhsa_next_free_sgpr 102
  .amdhsa_accum_offset 256
  .amdhsa_group_segment_fixed_size 0
  .amdhsa_kernarg_size 112
  .amdhsa_user_sgpr_count 2
  .amdhsa_user_sgpr_kernarg_segment_ptr 1
  .amdhsa_system_sgpr_workgroup_id_x 1
  .amdhsa_float_denorm_mode_32 3
.end_amdhsa_kernel
```
